```python
import torch

def _softmax(x, axis=-1):
    return torch.softmax(x, dim=axis)
def _gelu(x):
    return torch.nn.functional.gelu(x, approximate="tanh")
def _silu(x):
    return torch.nn.functional.silu(x)
def _sigmoid(x):
    return torch.sigmoid(x)
def _layernorm(x, axis=-1, eps=1e-5):
    m = x.mean(dim=axis, keepdim=True)
    v = x.var(dim=axis, keepdim=True, unbiased=False)
    return (x - m) / torch.sqrt(v + eps)
def _scatter_add(tgt, idx, src, axis=0):
    return tgt.clone().index_add_(axis, idx, src)
def _segment_sum(src, seg, n):
    out = torch.zeros((n,) + src.shape[1:], dtype=src.dtype)
    return out.index_add_(0, seg, src)
def _pad(x, pw):
    flat = tuple(v for pair in reversed(pw) for v in pair)
    return torch.nn.functional.pad(x, flat)

kernel_name = 'recurrent_scan__linear_kernel_hedgehog__dense_activation_mish__prompt'

def setup_inputs():

    _w = (lambda a: (lambda t: t.to(torch.bfloat16) if t.is_floating_point() else t)(torch.as_tensor(a)))
    def _A_setup():
        B, S, D, H = 1, 2048, 512, 32
        Dh = D // H
        return {
            "x": _w((lambda *s: torch.randn(*s, dtype=torch.bfloat16) * 0.05)(B, S, D)),
            "wqkv": _w((lambda *s: torch.randn(*s, dtype=torch.bfloat16) * 0.4)(D, 3 * D)),
            "w_phi": _w((lambda *s: torch.randn(*s, dtype=torch.bfloat16) * 0.4)(H, Dh, Dh) * (Dh ** -0.5)),
            "wo": _w((lambda *s: torch.randn(*s, dtype=torch.bfloat16) * 0.2)(D, D)),
        }
    _A_in = _A_setup()

    def _B_setup():
        B, S, D, F = 1, 2048, 512, 1792
        return {
            "x": _w((lambda *s: torch.randn(*s, dtype=torch.bfloat16) * 0.05)(B, S, D)),
            "w1": _w((lambda *s: torch.randn(*s, dtype=torch.bfloat16) * 0.4)(D, F) * (D ** -0.5)),
            "b1": _w((lambda *s: torch.randn(*s, dtype=torch.bfloat16) * 0.1)(F)),
            "w2": _w((lambda *s: torch.randn(*s, dtype=torch.bfloat16) * 0.1)(F, D) * (F ** -0.5)),
        }
    _B_in = _B_setup()

    return {
        "A_x": _A_in["x"],
        "A_wqkv": _A_in["wqkv"],
        "A_w_phi": _A_in["w_phi"],
        "A_wo": _A_in["wo"],
        "B_x": _B_in["x"],
        "B_w1": _B_in["w1"],
        "B_b1": _B_in["b1"],
        "B_w2": _B_in["w2"],
    }

def reference(A_x, A_wqkv, A_w_phi, A_wo, B_x, B_w1, B_b1, B_w2):
    def _A_ref(x, wqkv, w_phi, wo):
        B, S, D = x.shape
        H = 32; Dh = D // H
        qkv = (lambda x, *d: x.permute(*d))((x @ wqkv).reshape(B, S, 3, H, Dh), 2, 0, 3, 1, 4)
        q, k, v = qkv[0], qkv[1], qkv[2]
        pq = torch.einsum("bhsd,hdf->bhsf", q, w_phi)
        pk = torch.einsum("bhsd,hdf->bhsf", k, w_phi)
        phi_q = torch.concatenate([_softmax(pq, axis=-1), _softmax(-pq, axis=-1)], axis=-1)
        phi_k = torch.concatenate([_softmax(pk, axis=-1), _softmax(-pk, axis=-1)], axis=-1)
        kv = torch.einsum("bhsf,bhsd->bhfd", phi_k, v)
        z  = torch.einsum("bhsf->bhf", phi_k)
        num = torch.einsum("bhqf,bhfd->bhqd", phi_q, kv)
        den = torch.einsum("bhqf,bhf->bhq", phi_q, z)[..., None] + 1e-6
        o = num / den
        return (lambda x, *d: x.permute(*d))(o, 0, 2, 1, 3).reshape(B, S, D) @ wo

    def _B_ref(x, w1, b1, w2):
        h = torch.einsum("bsd,df->bsf", x, w1) + b1
        sp = torch.log1p(torch.exp(-torch.abs(h))) + torch.where(h > 0, h, torch.zeros_like(h))
        act = h * torch.tanh(sp)
        return torch.einsum("bsf,fd->bsd", act, w2)

    x = A_x
    xn = _layernorm(x, axis=-1)
    s = _A_ref(xn, A_wqkv, A_w_phi, A_wo)
    g = _silu(_B_ref(xn, B_w1, B_b1, B_w2))
    return x + s * g
```

```asm
; @launch grid=(256,1,1) block=(512,1,1) lds=163840
.amdgcn_target "amdgcn-amd-amdhsa--gfx950"
.text
.globl recurrent_scan__linear_kernel_hedgehog__dense_activation_mish__prompt_kernel
.p2align 8
.type recurrent_scan__linear_kernel_hedgehog__dense_activation_mish__prompt_kernel,@function
recurrent_scan__linear_kernel_hedgehog__dense_activation_mish__prompt_kernel:
  s_load_dwordx2 s[64:65], s[0:1], 0
  s_load_dwordx8 s[68:75], s[0:1], 8
  s_load_dwordx8 s[76:83], s[0:1], 40
  s_load_dwordx2 s[84:85], s[0:1], 80
  s_load_dwordx2 s[66:67], s[0:1], 72
  s_cmp_ge_u32 s2, 256
  s_cbranch_scc1 L_end
  v_lshrrev_b32 v2, 6, v0
  v_and_b32 v0, 63, v0
  s_and_b32 s3, s2, 7
  s_lshr_b32 s87, s2, 3
  v_readfirstlane_b32 s48, v2
  v_lshrrev_b32 v33, 4, v0
  v_and_b32 v34, 15, v0
  s_cmp_lg_u32 s48, 0
  s_cbranch_scc1 L_nopw
  s_getpc_b64 s[90:91]
L_pc0:
  s_sub_u32 s90, s90, L_pc0-recurrent_scan__linear_kernel_hedgehog__dense_activation_mish__prompt_kernel
  s_subb_u32 s91, s91, 0
  s_lshl_b32 s5, s87, 11
  v_lshlrev_b32 v35, 7, v34
  v_add_u32 v35, s5, v35
  global_load_dword v26, v35, s[90:91]
L_nopw:
  s_and_b32 s5, s3, 1
  s_lshl_b32 s5, s5, 3
  s_and_b32 s51, s87, 7
  s_add_u32 s51, s51, s5
  s_and_b32 s57, s48, 1
  s_lshl_b32 s61, s48, 11
  s_lshl_b32 s5, s57, 3
  v_add_u32 v35, 0, v33
  v_add_u32 v36, s5, v35
  v_xor_b32 v36, v34, v36
  v_lshlrev_b32 v36, 4, v36
  v_lshl_add_u32 v72, v35, 10, v36
  v_add_u32 v35, 4, v33
  v_add_u32 v36, s5, v35
  v_xor_b32 v36, v34, v36
  v_lshlrev_b32 v36, 4, v36
  v_lshl_add_u32 v73, v35, 10, v36
  s_lshr_b32 s98, s3, 1
  s_lshl_b32 s99, s3, 1
  s_add_u32 s98, s98, s99
  s_add_u32 s99, s98, 1
  s_and_b32 s99, s99, 3
  s_add_u32 s100, s98, 2
  s_and_b32 s100, s100, 3
  s_add_u32 s101, s98, 3
  s_and_b32 s101, s101, 3
  s_and_b32 s98, s98, 3
  s_lshl_b32 s86, s51, 17
  s_lshl_b32 s5, s48, 13
  s_add_u32 s86, s86, s5
  s_mov_b32 s10, 2097152
  s_mov_b32 s11, 0x20000
  v_lshrrev_b32 v36, 3, v0
  v_and_b32 v37, 7, v0
  v_lshlrev_b32 v38, 1, v36
  v_and_b32 v38, 4, v38
  v_xor_b32 v37, v37, v38
  v_lshlrev_b32 v37, 4, v37
  s_waitcnt lgkmcnt(0)
  s_mov_b32 s8, s64
  s_and_b32 s9, s65, 0xffff
  s_mov_b32 s44, s84
  s_and_b32 s45, s85, 0xffff
  s_mov_b32 s46, 268435456
  s_mov_b32 s47, 0x20000
  v_lshlrev_b32 v1, 4, v0
  s_cmp_lg_u32 s3, 1
  s_cbranch_scc1 L_noinit
  v_mov_b32 v40, 0
  v_mov_b32 v41, 0
  v_mov_b32 v42, 0
  v_mov_b32 v43, 0
  s_lshl_b32 s5, s87, 13
  s_lshl_b32 s4, s48, 10
  s_add_u32 s5, s5, s4
  s_add_u32 s5, s5, 9437184
  buffer_store_dwordx4 v[40:43], v1, s[44:47], s5 offen sc1
  s_add_u32 s5, s5, 0x40000
  buffer_store_dwordx4 v[40:43], v1, s[44:47], s5 offen sc1
L_noinit:
  s_add_u32 m0, s61, 0x0
  s_mul_i32 s89, s98, 256
  s_add_u32 s89, s89, s86
  s_add_u32 s62, s89, 0x0
  buffer_load_dwordx4 v72, s[8:11], s62 offen lds
  s_add_u32 m0, s61, 0x400
  s_add_u32 s62, s89, 0x0
  buffer_load_dwordx4 v73, s[8:11], s62 offen lds
  s_add_u32 m0, s61, 0x4000
  s_add_u32 s62, s89, 0x10000
  buffer_load_dwordx4 v72, s[8:11], s62 offen lds
  s_add_u32 m0, s61, 0x4400
  s_add_u32 s62, s89, 0x10000
  buffer_load_dwordx4 v73, s[8:11], s62 offen lds
  v_mul_u32_u24 v2, 3072, v36
  v_add_u32 v2, v2, v37
  v_mul_u32_u24 v3, 3584, v36
  v_add_u32 v3, v3, v37
  s_lshr_b32 s5, s3, 1
  s_lshl_b32 s5, s5, 2
  s_lshr_b32 s6, s87, 3
  s_add_u32 s5, s5, s6
  s_lshr_b32 s52, s5, 1
  s_and_b32 s53, s5, 1
  s_lshl_b32 s54, s3, 2
  s_add_u32 s54, s54, s6
  s_and_b32 s55, s87, 7
  s_lshr_b32 s56, s48, 1
  s_and_b32 s49, s48, 3
  s_lshr_b32 s50, s48, 2
  s_mov_b32 s88, s2
  s_mov_b32 s12, s68
  s_and_b32 s13, s69, 0xffff
  s_mov_b32 s14, 1572864
  s_mov_b32 s15, 0x20000
  s_mov_b32 s16, s76
  s_and_b32 s17, s77, 0xffff
  s_mov_b32 s18, 1835008
  s_mov_b32 s19, 0x20000
  s_cmp_eq_u32 s53, 0
  s_cbranch_scc1 L1
  s_mul_i32 s3, s48, 49152
  s_lshl_b32 s4, s52, 7
  s_add_u32 s3, s3, s4
  s_mul_i32 s4, s52, 448
  s_and_b32 s5, s52, 1
  s_cmp_eq_u32 s5, 0
  s_cselect_b32 s5, 128, 64
  s_cselect_b32 s2, 384, 0
  s_add_u32 s5, s4, s5
  s_add_u32 s92, s4, s2
  s_mov_b32 s7, s3
  s_mul_i32 s63, s48, 57344
  s_add_u32 s63, s63, s5
  s_add_u32 s6, s63, 128
  s_mul_i32 s2, s49, 114688
  s_add_u32 s2, s2, s92
  s_lshl_b32 s3, s50, 6
  s_add_u32 s93, s5, s3
  s_add_u32 m0, s61, 0x10000
  s_mul_i32 s89, s98, 458752
  s_add_u32 s89, s89, s63
  s_add_u32 s62, s89, 0x0
  buffer_load_dwordx4 v3, s[16:19], s62 offen lds
  s_add_u32 m0, s61, 0x10400
  s_add_u32 s62, s89, 0x7000
  buffer_load_dwordx4 v3, s[16:19], s62 offen lds
  s_branch L2
L1:
  s_mul_i32 s3, s48, 49152
  s_lshl_b32 s4, s52, 7
  s_add_u32 s3, s3, s4
  s_mul_i32 s4, s52, 448
  s_and_b32 s5, s52, 1
  s_cmp_eq_u32 s5, 0
  s_cselect_b32 s5, 0, 320
  s_add_u32 s4, s4, s5
  s_add_u32 s63, s3, 1024
  s_add_u32 s6, s3, 2048
  s_mul_i32 s7, s48, 57344
  s_add_u32 s7, s7, s4
  s_lshl_b32 s5, s50, 6
  s_add_u32 s92, s4, s5
  s_add_u32 m0, s61, 0x10000
  s_mul_i32 s89, s98, 393216
  s_add_u32 s89, s89, s63
  s_add_u32 s62, s89, 0x0
  buffer_load_dwordx4 v2, s[12:15], s62 offen lds
  s_add_u32 m0, s61, 0x10400
  s_add_u32 s62, s89, 0x6000
  buffer_load_dwordx4 v2, s[12:15], s62 offen lds
L2:
  v_lshl_add_u32 v4, v36, 10, v37
  s_mov_b32 s28, s70
  s_and_b32 s29, s71, 0xffff
  s_mov_b32 s30, 16384
  s_mov_b32 s31, 0x20000
  s_mov_b32 s32, s78
  s_and_b32 s33, s79, 0xffff
  s_mov_b32 s34, 3584
  s_mov_b32 s35, 0x20000
  s_mov_b32 s20, s80
  s_and_b32 s21, s81, 0xffff
  s_mov_b32 s22, 1835008
  s_mov_b32 s23, 0x20000
  s_mov_b32 s24, s72
  s_and_b32 s25, s73, 0xffff
  s_mov_b32 s26, 524288
  s_mov_b32 s27, 0x20000
  s_mov_b32 s36, s82
  s_and_b32 s37, s83, 0xffff
  s_mov_b32 s38, 2097152
  s_mov_b32 s39, 0x20000
  s_mov_b32 s40, s66
  s_and_b32 s41, s67, 0xffff
  s_mov_b32 s42, 256
  s_mov_b32 s43, 0x20000
  s_mov_b32 s75, s88
  s_mov_b32 s60, 0x3f803f80
  v_lshrrev_b32 v36, 2, v0
  v_and_b32 v37, 3, v0
  v_lshlrev_b32 v37, 4, v37
  v_mul_u32_u24 v5, 3584, v36
  v_add_u32 v5, v5, v37
  v_and_b32 v30, 31, v0
  v_lshlrev_b32 v30, 2, v30
  v_mov_b32 v29, 0
  v_mov_b32 v28, 1073741824
  v_cmp_eq_u32 vcc, 0, v0
  s_nop 1
  v_cndmask_b32 v28, v28, 0, vcc
  v_bfe_u32 v36, v0, 2, 2
  v_and_b32 v37, 3, v0
  v_bfe_u32 v38, v0, 4, 1
  v_lshrrev_b32 v39, 5, v0
  v_lshlrev_b32 v40, 3, v37
  v_lshl_add_u32 v40, v38, 5, v40
  v_lshl_add_u32 v41, v39, 3, v36
  v_lshrrev_b32 v42, 1, v36
  v_xor_b32 v42, s50, v42
  v_lshlrev_b32 v42, 6, v42
  v_lshl_add_u32 v43, v41, 7, v40
  v_add_u32 v43, v43, v42
  s_xor_b32 s5, s49, 0
  s_lshl_b32 s5, s5, 12
  s_add_u32 s5, s5, 16384
  v_add_u32 v6, s5, v43
  v_add_u32 v10, 0x10000, v6
  s_xor_b32 s5, s49, 1
  s_lshl_b32 s5, s5, 12
  s_add_u32 s5, s5, 16384
  v_add_u32 v7, s5, v43
  v_add_u32 v11, 0x10000, v7
  s_xor_b32 s5, s49, 2
  s_lshl_b32 s5, s5, 12
  s_add_u32 s5, s5, 16384
  v_add_u32 v8, s5, v43
  v_add_u32 v12, 0x10000, v8
  s_xor_b32 s5, s49, 3
  s_lshl_b32 s5, s5, 12
  s_add_u32 s5, s5, 16384
  v_add_u32 v9, s5, v43
  v_add_u32 v13, 0x10000, v9
  v_and_b32 v44, 31, v0
  s_lshl_b32 s5, s49, 5
  v_add_u32 v45, s5, v44
  v_xor_b32 v46, v39, v34
  v_lshlrev_b32 v46, 4, v46
  v_lshl_add_u32 v64, v45, 8, v46
  s_lshl_b32 s5, s49, 6
  v_xor_b32 v64, s5, v64
  v_xor_b32 v65, 32, v64
  v_xor_b32 v66, 64, v64
  v_xor_b32 v67, 96, v64
  v_xor_b32 v68, 128, v64
  v_xor_b32 v69, 160, v64
  v_xor_b32 v70, 192, v64
  v_xor_b32 v71, 224, v64
  v_lshlrev_b32 v44, 2, v38
  v_cmp_eq_u32 vcc, v44, v34
  v_mov_b32 v44, s60
  s_nop 0
  v_cndmask_b32 v120, 0, v44, vcc
  v_mov_b32 v121, v120
  v_mov_b32 v122, v120
  v_mov_b32 v123, v120
  v_mov_b32 v20, 0
  v_mov_b32 v21, 0
  s_lshl_b32 s3, s51, 2
  s_add_u32 s3, s3, s49
  s_mul_i32 s64, s3, 147456
  s_mul_i32 s74, s52, 14336
  s_add_u32 s74, s74, s64
  s_lshl_b32 s65, s3, 2
  s_lshr_b32 s4, s52, 1
  s_add_u32 s65, s65, s4
  s_mul_i32 s65, s65, 640
  s_and_b32 s4, s52, 1
  s_lshl_b32 s4, s4, 3
  s_lshl_b32 s5, s50, 2
  s_add_u32 s4, s4, s5
  s_add_u32 s65, s65, s4
  s_add_u32 s65, s65, 9527296
  s_mul_i32 s66, s54, 294912
  s_lshl_b32 s3, s49, 10
  s_add_u32 s66, s66, s3
  s_mul_i32 s67, s54, 5120
  s_add_u32 s67, s67, 9527296
  s_mul_i32 s68, s50, 458752
  s_lshl_b32 s4, s49, 14
  s_lshl_b32 s5, s55, 7
  s_add_u32 s4, s4, s5
  s_add_u32 s68, s68, s4
  s_lshl_b32 s69, s50, 17
  s_add_u32 s69, s69, s4
  s_lshl_b32 s3, s52, 2
  s_add_u32 s3, s3, s56
  s_mul_i32 s70, s3, 2176
  s_add_u32 s70, s70, 9437184
  s_lshl_b32 s3, s52, 3
  s_add_u32 s3, s3, s48
  s_lshl_b32 s71, s3, 11
  s_add_u32 s71, s71, 9699328
  s_mul_i32 s3, s50, 28672
  s_add_u32 s0, s66, s3
  s_lshl_b32 s3, s50, 13
  s_add_u32 s1, s66, s3
  s_add_u32 s1, s1, 114688
  v_lshrrev_b32 v31, 1, v30
  s_add_u32 m0, s61, 0x8000
  s_mul_i32 s89, s99, 256
  s_add_u32 s89, s89, s86
  s_add_u32 s62, s89, 0x0
  buffer_load_dwordx4 v72, s[8:11], s62 offen lds
  s_add_u32 m0, s61, 0x8400
  s_add_u32 s62, s89, 0x0
  buffer_load_dwordx4 v73, s[8:11], s62 offen lds
  s_add_u32 m0, s61, 0xc000
  s_add_u32 s62, s89, 0x10000
  buffer_load_dwordx4 v72, s[8:11], s62 offen lds
  s_add_u32 m0, s61, 0xc400
  s_add_u32 s62, s89, 0x10000
  buffer_load_dwordx4 v73, s[8:11], s62 offen lds
  s_cmp_eq_u32 s53, 0
  s_cbranch_scc1 L3
  s_add_u32 m0, s61, 0x14000
  s_mul_i32 s89, s99, 458752
  s_add_u32 s89, s89, s63
  s_add_u32 s62, s89, 0x0
  buffer_load_dwordx4 v3, s[16:19], s62 offen lds
  s_add_u32 m0, s61, 0x14400
  s_add_u32 s62, s89, 0x7000
  buffer_load_dwordx4 v3, s[16:19], s62 offen lds
  s_branch L4
L3:
  s_add_u32 m0, s61, 0x14000
  s_mul_i32 s89, s99, 393216
  s_add_u32 s89, s89, s63
  s_add_u32 s62, s89, 0x0
  buffer_load_dwordx4 v2, s[12:15], s62 offen lds
  s_add_u32 m0, s61, 0x14400
  s_add_u32 s62, s89, 0x6000
  buffer_load_dwordx4 v2, s[12:15], s62 offen lds
L4:
  s_lshl_b32 s4, s88, 3
  s_add_u32 s4, s4, s48
  s_mov_b32 m0, 162816
  s_mul_i32 s5, s4, 896
  v_min_u32 v47, 6, v0
  v_lshlrev_b32 v47, 7, v47
  buffer_load_dword v47, s[16:19], s5 offen lds
  s_mul_i32 s5, s4, 768
  v_min_u32 v47, 5, v0
  v_lshlrev_b32 v47, 7, v47
  buffer_load_dword v47, s[12:15], s5 offen lds
  s_lshl_b32 s5, s53, 1
  s_add_u32 s5, s5, s50
  s_cmp_eq_u32 s5, 0
  s_cbranch_scc1 L_typeA0
  s_cmp_eq_u32 s5, 1
  s_cbranch_scc1 L_typeA1
  s_cmp_eq_u32 s5, 3
  s_cbranch_scc1 L_typeB1
L_typeB0:
  s_and_b32 s5, s52, 1
  s_cmp_eq_u32 s5, 0
  s_cselect_b32 s5, 4, 2
  s_cselect_b32 s4, 12288, 0
  s_lshl_b32 s5, s5, 10
  s_add_u32 s72, s74, s4
  s_add_u32 s5, s5, 0
  s_add_u32 s74, s74, s5
  s_waitcnt vmcnt(8)
  s_barrier
  s_and_b32 s3, s75, 7
  s_cmp_lg_u32 s3, 1
  s_cbranch_scc1 L5
  s_cmp_lg_u32 s48, 0
  s_cbranch_scc1 L5
  s_lshl_b32 s3, s87, 2
  buffer_store_dword v10, v28, s[40:43], s3 offen offset:128 sc1
L5:
  ds_read_b128 v[128:131], v64 offset:0
  ds_read_b128 v[132:135], v65 offset:0
  ds_read_b64_tr_b16 v[80:81], v6 offset:49152
  ds_read_b64_tr_b16 v[82:83], v6 offset:49664
  ds_read_b128 v[136:139], v66 offset:0
  ds_read_b128 v[140:143], v67 offset:0
  ds_read_b128 v[144:147], v68 offset:0
  ds_read_b64_tr_b16 v[84:85], v6 offset:51200
  ds_read_b64_tr_b16 v[86:87], v6 offset:51712
  ds_read_b128 v[148:151], v69 offset:0
  ds_read_b128 v[152:155], v70 offset:0
  ds_read_b128 v[156:159], v71 offset:0
  ds_read_b64_tr_b16 v[88:89], v7 offset:49152
  ds_read_b64_tr_b16 v[90:91], v7 offset:49664
  ds_read_b64_tr_b16 v[92:93], v7 offset:51200
  ds_read_b64_tr_b16 v[94:95], v7 offset:51712
  s_waitcnt lgkmcnt(12)
  v_mfma_f32_32x32x16_bf16 v[32:47], v[80:83], v[128:131], 0
  v_mfma_f32_16x16x32_bf16 v[124:127], v[120:123], v[80:83], 0
  s_waitcnt lgkmcnt(4)
  s_barrier
  ds_read_b64_tr_b16 v[80:81], v8 offset:49152
  ds_read_b64_tr_b16 v[82:83], v8 offset:49664
  s_add_u32 m0, s61, 0x0
  s_mul_i32 s89, s100, 256
  s_add_u32 s89, s89, s86
  s_add_u32 s62, s89, 0x0
  buffer_load_dwordx4 v72, s[8:11], s62 offen lds
  s_add_u32 m0, s61, 0x400
  s_add_u32 s62, s89, 0x0
  buffer_load_dwordx4 v73, s[8:11], s62 offen lds
  v_mfma_f32_32x32x16_bf16 v[32:47], v[84:87], v[132:135], v[32:47]
  v_mfma_f32_16x16x32_bf16 v[124:127], v[120:123], v[84:87], v[124:127]
  ds_read_b64_tr_b16 v[84:85], v8 offset:51200
  ds_read_b64_tr_b16 v[86:87], v8 offset:51712
  v_dot2_f32_bf16 v96, v128, s60, 0
  v_dot2_f32_bf16 v98, v128, v128, 0
  v_dot2_f32_bf16 v97, v129, s60, 0
  v_dot2_f32_bf16 v99, v129, v129, 0
  v_dot2_f32_bf16 v96, v130, s60, v96
  v_dot2_f32_bf16 v98, v130, v130, v98
  v_dot2_f32_bf16 v97, v131, s60, v97
  v_dot2_f32_bf16 v99, v131, v131, v99
  v_dot2_f32_bf16 v96, v136, s60, v96
  v_dot2_f32_bf16 v98, v136, v136, v98
  v_dot2_f32_bf16 v97, v137, s60, v97
  v_dot2_f32_bf16 v99, v137, v137, v99
  v_dot2_f32_bf16 v96, v138, s60, v96
  v_dot2_f32_bf16 v98, v138, v138, v98
  v_dot2_f32_bf16 v97, v139, s60, v97
  v_dot2_f32_bf16 v99, v139, v139, v99
  s_waitcnt lgkmcnt(6)
  v_mfma_f32_32x32x16_bf16 v[32:47], v[88:91], v[136:139], v[32:47]
  ds_read_b64_tr_b16 v[88:89], v9 offset:49152
  ds_read_b64_tr_b16 v[90:91], v9 offset:49664
  s_add_u32 m0, s61, 0x4000
  s_add_u32 s62, s89, 0x10000
  buffer_load_dwordx4 v72, s[8:11], s62 offen lds
  s_add_u32 m0, s61, 0x4400
  s_add_u32 s62, s89, 0x10000
  buffer_load_dwordx4 v73, s[8:11], s62 offen lds
  s_waitcnt lgkmcnt(6)
  v_mfma_f32_32x32x16_bf16 v[32:47], v[92:95], v[140:143], v[32:47]
  ds_read_b64_tr_b16 v[92:93], v9 offset:51200
  ds_read_b64_tr_b16 v[94:95], v9 offset:51712
  v_dot2_f32_bf16 v96, v144, s60, v96
  v_dot2_f32_bf16 v98, v144, v144, v98
  v_dot2_f32_bf16 v97, v145, s60, v97
  v_dot2_f32_bf16 v99, v145, v145, v99
  v_dot2_f32_bf16 v96, v146, s60, v96
  v_dot2_f32_bf16 v98, v146, v146, v98
  v_dot2_f32_bf16 v97, v147, s60, v97
  v_dot2_f32_bf16 v99, v147, v147, v99
  v_dot2_f32_bf16 v96, v152, s60, v96
  v_dot2_f32_bf16 v98, v152, v152, v98
  v_dot2_f32_bf16 v97, v153, s60, v97
  v_dot2_f32_bf16 v99, v153, v153, v99
  v_dot2_f32_bf16 v96, v154, s60, v96
  v_dot2_f32_bf16 v98, v154, v154, v98
  v_dot2_f32_bf16 v97, v155, s60, v97
  v_dot2_f32_bf16 v99, v155, v155, v99
  s_waitcnt lgkmcnt(6)
  v_mfma_f32_32x32x16_bf16 v[32:47], v[80:83], v[144:147], v[32:47]
  s_waitcnt vmcnt(6)
  s_barrier
  ds_read_b128 v[160:163], v64 offset:32768
  ds_read_b128 v[164:167], v65 offset:32768
  ds_read_b64_tr_b16 v[80:81], v10 offset:0
  ds_read_b64_tr_b16 v[82:83], v10 offset:512
  s_add_u32 m0, s61, 0x18000
  s_mul_i32 s89, s100, 458752
  s_add_u32 s89, s89, s63
  s_add_u32 s62, s89, 0x0
  buffer_load_dwordx4 v3, s[16:19], s62 offen lds
  s_add_u32 m0, s61, 0x18400
  s_add_u32 s62, s89, 0x7000
  buffer_load_dwordx4 v3, s[16:19], s62 offen lds
  s_waitcnt lgkmcnt(8)
  v_mfma_f32_32x32x16_bf16 v[32:47], v[84:87], v[148:151], v[32:47]
  ds_read_b128 v[168:171], v66 offset:32768
  ds_read_b128 v[172:175], v67 offset:32768
  ds_read_b128 v[176:179], v68 offset:32768
  ds_read_b64_tr_b16 v[84:85], v10 offset:2048
  ds_read_b64_tr_b16 v[86:87], v10 offset:2560
  s_waitcnt lgkmcnt(11)
  v_mfma_f32_32x32x16_bf16 v[32:47], v[88:91], v[152:155], v[32:47]
  ds_read_b128 v[180:183], v69 offset:32768
  ds_read_b128 v[184:187], v70 offset:32768
  ds_read_b128 v[188:191], v71 offset:32768
  ds_read_b64_tr_b16 v[88:89], v11 offset:0
  ds_read_b64_tr_b16 v[90:91], v11 offset:512
  s_add_u32 m0, s61, 0x1c000
  s_mul_i32 s89, s101, 458752
  s_add_u32 s89, s89, s63
  s_add_u32 s62, s89, 0x0
  buffer_load_dwordx4 v3, s[16:19], s62 offen lds
  s_add_u32 m0, s61, 0x1c400
  s_add_u32 s62, s89, 0x7000
  buffer_load_dwordx4 v3, s[16:19], s62 offen lds
  v_lshrrev_b32 v31, 1, v30
  buffer_load_ushort v25, v31, s[32:35], s92 offen
  buffer_load_ushort v23, v31, s[32:35], s93 offen
  buffer_load_ushort v24, v31, s[32:35], s93 offen offset:128
  s_lshl_b32 s3, s52, 11
  s_lshl_b32 s4, s57, 10
  s_add_u32 s3, s3, s4
  s_add_u32 m0, s4, 147456
  s_nop 0
  buffer_load_dwordx4 v1, s[28:31], s3 offen lds
  s_waitcnt lgkmcnt(14)
  v_mfma_f32_32x32x16_bf16 v[32:47], v[92:95], v[156:159], v[32:47]
  ds_read_b64_tr_b16 v[92:93], v11 offset:2048
  ds_read_b64_tr_b16 v[94:95], v11 offset:2560
  s_waitcnt lgkmcnt(12)
  v_mfma_f32_32x32x16_bf16 v[32:47], v[80:83], v[160:163], v[32:47]
  v_mfma_f32_16x16x32_bf16 v[124:127], v[120:123], v[80:83], v[124:127]
  s_waitcnt lgkmcnt(4)
  s_barrier
  ds_read_b64_tr_b16 v[80:81], v12 offset:0
  ds_read_b64_tr_b16 v[82:83], v12 offset:512
  s_add_u32 m0, s61, 0x8000
  s_mul_i32 s89, s101, 256
  s_add_u32 s89, s89, s86
  s_add_u32 s62, s89, 0x0
  buffer_load_dwordx4 v72, s[8:11], s62 offen lds
  s_add_u32 m0, s61, 0x8400
  s_add_u32 s62, s89, 0x0
  buffer_load_dwordx4 v73, s[8:11], s62 offen lds
  v_mfma_f32_32x32x16_bf16 v[32:47], v[84:87], v[164:167], v[32:47]
  v_mfma_f32_16x16x32_bf16 v[124:127], v[120:123], v[84:87], v[124:127]
  ds_read_b64_tr_b16 v[84:85], v12 offset:2048
  ds_read_b64_tr_b16 v[86:87], v12 offset:2560
  v_dot2_f32_bf16 v96, v160, s60, v96
  v_dot2_f32_bf16 v98, v160, v160, v98
  v_dot2_f32_bf16 v97, v161, s60, v97
  v_dot2_f32_bf16 v99, v161, v161, v99
  v_dot2_f32_bf16 v96, v162, s60, v96
  v_dot2_f32_bf16 v98, v162, v162, v98
  v_dot2_f32_bf16 v97, v163, s60, v97
  v_dot2_f32_bf16 v99, v163, v163, v99
  v_dot2_f32_bf16 v96, v168, s60, v96
  v_dot2_f32_bf16 v98, v168, v168, v98
  v_dot2_f32_bf16 v97, v169, s60, v97
  v_dot2_f32_bf16 v99, v169, v169, v99
  v_dot2_f32_bf16 v96, v170, s60, v96
  v_dot2_f32_bf16 v98, v170, v170, v98
  v_dot2_f32_bf16 v97, v171, s60, v97
  v_dot2_f32_bf16 v99, v171, v171, v99
  s_waitcnt lgkmcnt(6)
  v_mfma_f32_32x32x16_bf16 v[32:47], v[88:91], v[168:171], v[32:47]
  ds_read_b64_tr_b16 v[88:89], v13 offset:0
  ds_read_b64_tr_b16 v[90:91], v13 offset:512
  s_add_u32 m0, s61, 0xc000
  s_add_u32 s62, s89, 0x10000
  buffer_load_dwordx4 v72, s[8:11], s62 offen lds
  s_add_u32 m0, s61, 0xc400
  s_add_u32 s62, s89, 0x10000
  buffer_load_dwordx4 v73, s[8:11], s62 offen lds
  s_waitcnt lgkmcnt(6)
  v_mfma_f32_32x32x16_bf16 v[32:47], v[92:95], v[172:175], v[32:47]
  ds_read_b64_tr_b16 v[92:93], v13 offset:2048
  ds_read_b64_tr_b16 v[94:95], v13 offset:2560
  v_dot2_f32_bf16 v96, v176, s60, v96
  v_dot2_f32_bf16 v98, v176, v176, v98
  v_dot2_f32_bf16 v97, v177, s60, v97
  v_dot2_f32_bf16 v99, v177, v177, v99
  v_dot2_f32_bf16 v96, v178, s60, v96
  v_dot2_f32_bf16 v98, v178, v178, v98
  v_dot2_f32_bf16 v97, v179, s60, v97
  v_dot2_f32_bf16 v99, v179, v179, v99
  v_dot2_f32_bf16 v96, v184, s60, v96
  v_dot2_f32_bf16 v98, v184, v184, v98
  v_dot2_f32_bf16 v97, v185, s60, v97
  v_dot2_f32_bf16 v99, v185, v185, v99
  v_dot2_f32_bf16 v96, v186, s60, v96
  v_dot2_f32_bf16 v98, v186, v186, v98
  v_dot2_f32_bf16 v97, v187, s60, v97
  v_dot2_f32_bf16 v99, v187, v187, v99
  s_waitcnt lgkmcnt(6)
  v_mfma_f32_32x32x16_bf16 v[32:47], v[80:83], v[176:179], v[32:47]
  s_waitcnt vmcnt(10)
  s_barrier
  ds_read_b128 v[192:195], v64 offset:0
  ds_read_b128 v[196:199], v65 offset:0
  ds_read_b64_tr_b16 v[80:81], v10 offset:16384
  ds_read_b64_tr_b16 v[82:83], v10 offset:16896
  s_add_u32 m0, s61, 0x20000
  s_mul_i32 s89, s98, 458752
  s_add_u32 s89, s89, s6
  s_add_u32 s62, s89, 0x0
  buffer_load_dwordx4 v3, s[16:19], s62 offen lds
  s_add_u32 m0, s61, 0x20400
  s_add_u32 s62, s89, 0x7000
  buffer_load_dwordx4 v3, s[16:19], s62 offen lds
  s_waitcnt lgkmcnt(8)
  v_mfma_f32_32x32x16_bf16 v[32:47], v[84:87], v[180:183], v[32:47]
  ds_read_b128 v[200:203], v66 offset:0
  ds_read_b128 v[204:207], v67 offset:0
  ds_read_b128 v[208:211], v68 offset:0
  ds_read_b64_tr_b16 v[84:85], v10 offset:18432
  ds_read_b64_tr_b16 v[86:87], v10 offset:18944
  s_waitcnt lgkmcnt(11)
  v_mfma_f32_32x32x16_bf16 v[32:47], v[88:91], v[184:187], v[32:47]
  ds_read_b128 v[212:215], v69 offset:0
  ds_read_b128 v[216:219], v70 offset:0
  ds_read_b128 v[220:223], v71 offset:0
  ds_read_b64_tr_b16 v[88:89], v11 offset:16384
  ds_read_b64_tr_b16 v[90:91], v11 offset:16896
  s_add_u32 m0, s61, 0x10000
  s_mul_i32 s89, s99, 458752
  s_add_u32 s89, s89, s6
  s_add_u32 s62, s89, 0x0
  buffer_load_dwordx4 v3, s[16:19], s62 offen lds
  s_add_u32 m0, s61, 0x10400
  s_add_u32 s62, s89, 0x7000
  buffer_load_dwordx4 v3, s[16:19], s62 offen lds
  s_waitcnt lgkmcnt(14)
  v_mfma_f32_32x32x16_bf16 v[32:47], v[92:95], v[188:191], v[32:47]
  ds_read_b64_tr_b16 v[92:93], v11 offset:18432
  ds_read_b64_tr_b16 v[94:95], v11 offset:18944
  s_waitcnt lgkmcnt(12)
  v_mfma_f32_32x32x16_bf16 v[32:47], v[80:83], v[192:195], v[32:47]
  v_mfma_f32_16x16x32_bf16 v[124:127], v[120:123], v[80:83], v[124:127]
  ds_read_b64_tr_b16 v[80:81], v12 offset:16384
  ds_read_b64_tr_b16 v[82:83], v12 offset:16896
  s_waitcnt lgkmcnt(9)
  v_mfma_f32_32x32x16_bf16 v[32:47], v[84:87], v[196:199], v[32:47]
  v_mfma_f32_16x16x32_bf16 v[124:127], v[120:123], v[84:87], v[124:127]
  ds_read_b64_tr_b16 v[84:85], v12 offset:18432
  ds_read_b64_tr_b16 v[86:87], v12 offset:18944
  v_dot2_f32_bf16 v96, v192, s60, v96
  v_dot2_f32_bf16 v98, v192, v192, v98
  v_dot2_f32_bf16 v97, v193, s60, v97
  v_dot2_f32_bf16 v99, v193, v193, v99
  v_dot2_f32_bf16 v96, v194, s60, v96
  v_dot2_f32_bf16 v98, v194, v194, v98
  v_dot2_f32_bf16 v97, v195, s60, v97
  v_dot2_f32_bf16 v99, v195, v195, v99
  v_dot2_f32_bf16 v96, v200, s60, v96
  v_dot2_f32_bf16 v98, v200, v200, v98
  v_dot2_f32_bf16 v97, v201, s60, v97
  v_dot2_f32_bf16 v99, v201, v201, v99
  v_dot2_f32_bf16 v96, v202, s60, v96
  v_dot2_f32_bf16 v98, v202, v202, v98
  v_dot2_f32_bf16 v97, v203, s60, v97
  v_dot2_f32_bf16 v99, v203, v203, v99
  s_waitcnt lgkmcnt(6)
  v_mfma_f32_32x32x16_bf16 v[32:47], v[88:91], v[200:203], v[32:47]
  ds_read_b64_tr_b16 v[88:89], v13 offset:16384
  ds_read_b64_tr_b16 v[90:91], v13 offset:16896
  s_waitcnt lgkmcnt(6)
  v_mfma_f32_32x32x16_bf16 v[32:47], v[92:95], v[204:207], v[32:47]
  ds_read_b64_tr_b16 v[92:93], v13 offset:18432
  ds_read_b64_tr_b16 v[94:95], v13 offset:18944
  v_dot2_f32_bf16 v96, v208, s60, v96
  v_dot2_f32_bf16 v98, v208, v208, v98
  v_dot2_f32_bf16 v97, v209, s60, v97
  v_dot2_f32_bf16 v99, v209, v209, v99
  v_dot2_f32_bf16 v96, v210, s60, v96
  v_dot2_f32_bf16 v98, v210, v210, v98
  v_dot2_f32_bf16 v97, v211, s60, v97
  v_dot2_f32_bf16 v99, v211, v211, v99
  v_dot2_f32_bf16 v96, v216, s60, v96
  v_dot2_f32_bf16 v98, v216, v216, v98
  v_dot2_f32_bf16 v97, v217, s60, v97
  v_dot2_f32_bf16 v99, v217, v217, v99
  v_dot2_f32_bf16 v96, v218, s60, v96
  v_dot2_f32_bf16 v98, v218, v218, v98
  v_dot2_f32_bf16 v97, v219, s60, v97
  v_dot2_f32_bf16 v99, v219, v219, v99
  s_waitcnt lgkmcnt(6)
  v_mfma_f32_32x32x16_bf16 v[32:47], v[80:83], v[208:211], v[32:47]
  s_waitcnt vmcnt(8)
  s_waitcnt vmcnt(6)
  s_waitcnt vmcnt(4)
  s_waitcnt vmcnt(2)
  s_barrier
  ds_read_b128 v[224:227], v64 offset:32768
  ds_read_b128 v[228:231], v65 offset:32768
  ds_read_b64_tr_b16 v[80:81], v10 offset:32768
  ds_read_b64_tr_b16 v[82:83], v10 offset:33280
  s_add_u32 m0, s61, 0x14000
  s_mul_i32 s89, s100, 458752
  s_add_u32 s89, s89, s6
  s_add_u32 s62, s89, 0x0
  buffer_load_dwordx4 v3, s[16:19], s62 offen lds
  s_add_u32 m0, s61, 0x14400
  s_add_u32 s62, s89, 0x7000
  buffer_load_dwordx4 v3, s[16:19], s62 offen lds
  s_waitcnt lgkmcnt(8)
  v_mfma_f32_32x32x16_bf16 v[32:47], v[84:87], v[212:215], v[32:47]
  ds_read_b128 v[232:235], v66 offset:32768
  ds_read_b128 v[236:239], v67 offset:32768
  ds_read_b128 v[240:243], v68 offset:32768
  ds_read_b64_tr_b16 v[84:85], v10 offset:34816
  ds_read_b64_tr_b16 v[86:87], v10 offset:35328
  s_waitcnt lgkmcnt(11)
  v_mfma_f32_32x32x16_bf16 v[32:47], v[88:91], v[216:219], v[32:47]
  ds_read_b128 v[244:247], v69 offset:32768
  ds_read_b128 v[248:251], v70 offset:32768
  ds_read_b128 v[252:255], v71 offset:32768
  ds_read_b64_tr_b16 v[88:89], v11 offset:32768
  ds_read_b64_tr_b16 v[90:91], v11 offset:33280
  s_add_u32 m0, s61, 0x4000
  s_mul_i32 s89, s101, 458752
  s_add_u32 s89, s89, s6
  s_add_u32 s62, s89, 0x0
  buffer_load_dwordx4 v3, s[16:19], s62 offen lds
  s_add_u32 m0, s61, 0x4400
  s_add_u32 s62, s89, 0x7000
  buffer_load_dwordx4 v3, s[16:19], s62 offen lds
  s_waitcnt lgkmcnt(14)
  v_mfma_f32_32x32x16_bf16 v[32:47], v[92:95], v[220:223], v[32:47]
  ds_read_b64_tr_b16 v[92:93], v11 offset:34816
  ds_read_b64_tr_b16 v[94:95], v11 offset:35328
  s_waitcnt lgkmcnt(12)
  v_mfma_f32_32x32x16_bf16 v[32:47], v[80:83], v[224:227], v[32:47]
  v_mfma_f32_16x16x32_bf16 v[124:127], v[120:123], v[80:83], v[124:127]
  ds_read_b64_tr_b16 v[80:81], v12 offset:32768
  ds_read_b64_tr_b16 v[82:83], v12 offset:33280
  s_add_u32 m0, s61, 0x0
  s_mul_i32 s89, s98, 458752
  s_add_u32 s89, s89, s2
  s_add_u32 s62, s89, 0x0
  buffer_load_dwordx4 v5, s[16:19], s62 offen lds
  s_add_u32 m0, s61, 0x400
  s_add_u32 s62, s89, 0xe000
  buffer_load_dwordx4 v5, s[16:19], s62 offen lds
  s_waitcnt lgkmcnt(9)
  v_mfma_f32_32x32x16_bf16 v[32:47], v[84:87], v[228:231], v[32:47]
  v_mfma_f32_16x16x32_bf16 v[124:127], v[120:123], v[84:87], v[124:127]
  ds_read_b64_tr_b16 v[84:85], v12 offset:34816
  ds_read_b64_tr_b16 v[86:87], v12 offset:35328
  v_dot2_f32_bf16 v96, v224, s60, v96
  v_dot2_f32_bf16 v98, v224, v224, v98
  v_dot2_f32_bf16 v97, v225, s60, v97
  v_dot2_f32_bf16 v99, v225, v225, v99
  v_dot2_f32_bf16 v96, v226, s60, v96
  v_dot2_f32_bf16 v98, v226, v226, v98
  v_dot2_f32_bf16 v97, v227, s60, v97
  v_dot2_f32_bf16 v99, v227, v227, v99
  v_dot2_f32_bf16 v96, v232, s60, v96
  v_dot2_f32_bf16 v98, v232, v232, v98
  v_dot2_f32_bf16 v97, v233, s60, v97
  v_dot2_f32_bf16 v99, v233, v233, v99
  v_dot2_f32_bf16 v96, v234, s60, v96
  v_dot2_f32_bf16 v98, v234, v234, v98
  v_dot2_f32_bf16 v97, v235, s60, v97
  v_dot2_f32_bf16 v99, v235, v235, v99
  s_waitcnt lgkmcnt(6)
  v_mfma_f32_32x32x16_bf16 v[32:47], v[88:91], v[232:235], v[32:47]
  ds_read_b64_tr_b16 v[88:89], v13 offset:32768
  ds_read_b64_tr_b16 v[90:91], v13 offset:33280
  s_waitcnt lgkmcnt(6)
  v_mfma_f32_32x32x16_bf16 v[32:47], v[92:95], v[236:239], v[32:47]
  ds_read_b64_tr_b16 v[92:93], v13 offset:34816
  ds_read_b64_tr_b16 v[94:95], v13 offset:35328
  s_lshl_b32 s3, s49, 2
  s_add_u32 s3, s3, 154112
  v_add_u32 v125, s3, v1
  ds_write_b32 v125, v124
  v_dot2_f32_bf16 v96, v240, s60, v96
  v_dot2_f32_bf16 v98, v240, v240, v98
  v_dot2_f32_bf16 v97, v241, s60, v97
  v_dot2_f32_bf16 v99, v241, v241, v99
  v_dot2_f32_bf16 v96, v242, s60, v96
  v_dot2_f32_bf16 v98, v242, v242, v98
  v_dot2_f32_bf16 v97, v243, s60, v97
  v_dot2_f32_bf16 v99, v243, v243, v99
  v_dot2_f32_bf16 v96, v248, s60, v96
  v_dot2_f32_bf16 v98, v248, v248, v98
  v_dot2_f32_bf16 v97, v249, s60, v97
  v_dot2_f32_bf16 v99, v249, v249, v99
  v_dot2_f32_bf16 v96, v250, s60, v96
  v_dot2_f32_bf16 v98, v250, v250, v98
  v_dot2_f32_bf16 v97, v251, s60, v97
  v_dot2_f32_bf16 v99, v251, v251, v99
  s_nop 1
  v_add_f32 v96, v96, v97
  v_add_f32 v97, v98, v99
  v_lshrrev_b32 v98, 5, v0
  v_lshlrev_b32 v98, 3, v98
  v_lshl_add_u32 v98, v30, 3, v98
  s_lshl_b32 s3, s49, 10
  s_add_u32 s3, s3, 150016
  v_add_u32 v98, s3, v98
  ds_write_b64 v98, v[96:97]
  s_waitcnt lgkmcnt(8)
  v_mfma_f32_32x32x16_bf16 v[32:47], v[80:83], v[240:243], v[32:47]
  ds_read_b64_tr_b16 v[80:81], v10 offset:49152
  ds_read_b64_tr_b16 v[82:83], v10 offset:49664
  s_lshl_b32 s4, s75, 3
  s_add_u32 s4, s4, s48
  s_mul_i32 s5, s4, 896
  s_lshl_b32 s4, s4, 8
  s_mov_b32 m0, 162816
  v_min_u32 v31, 6, v0
  v_lshlrev_b32 v31, 7, v31
  buffer_load_dword v31, s[20:23], s5 offen lds
  v_min_u32 v31, 1, v0
  v_lshlrev_b32 v31, 7, v31
  buffer_load_dword v31, s[24:27], s4 offen lds
  s_waitcnt lgkmcnt(8)
  v_mfma_f32_32x32x16_bf16 v[32:47], v[84:87], v[244:247], v[32:47]
  ds_read_b64_tr_b16 v[84:85], v10 offset:51200
  ds_read_b64_tr_b16 v[86:87], v10 offset:51712
  s_waitcnt lgkmcnt(8)
  v_mfma_f32_32x32x16_bf16 v[32:47], v[88:91], v[248:251], v[32:47]
  ds_read_b64_tr_b16 v[88:89], v11 offset:49152
  ds_read_b64_tr_b16 v[90:91], v11 offset:49664
  s_cmp_lg_u32 s48, 0
  s_cbranch_scc1 L6
  s_mul_i32 s90, s87, 57344
  s_add_u32 s90, s90, 384
  s_mov_b32 m0, 162816
  v_min_u32 v127, 27, v0
  v_lshlrev_b32 v127, 10, v127
  buffer_load_dword v127, s[20:23], s90 offen lds
L6:
  s_waitcnt lgkmcnt(8)
  v_mfma_f32_32x32x16_bf16 v[32:47], v[92:95], v[252:255], v[32:47]
  ds_read_b64_tr_b16 v[92:93], v11 offset:51200
  ds_read_b64_tr_b16 v[94:95], v11 offset:51712
  s_waitcnt lgkmcnt(6)
  v_mfma_f32_32x32x16_bf16 v[48:63], v[80:83], v[128:131], 0
  v_mfma_f32_16x16x32_bf16 v[124:127], v[120:123], v[80:83], 0
  ds_read_b64_tr_b16 v[80:81], v12 offset:49152
  ds_read_b64_tr_b16 v[82:83], v12 offset:49664
  s_waitcnt lgkmcnt(6)
  v_mfma_f32_32x32x16_bf16 v[48:63], v[84:87], v[132:135], v[48:63]
  v_mfma_f32_16x16x32_bf16 v[124:127], v[120:123], v[84:87], v[124:127]
  ds_read_b64_tr_b16 v[84:85], v12 offset:51200
  ds_read_b64_tr_b16 v[86:87], v12 offset:51712
  s_waitcnt lgkmcnt(6)
  v_mfma_f32_32x32x16_bf16 v[48:63], v[88:91], v[136:139], v[48:63]
  s_waitcnt vmcnt(8)
  s_waitcnt vmcnt(6)
  s_barrier
  ds_read_b64_tr_b16 v[88:89], v13 offset:49152
  ds_read_b64_tr_b16 v[90:91], v13 offset:49664
  s_add_u32 m0, s61, 0x1c000
  s_mul_i32 s89, s100, 458752
  s_add_u32 s89, s89, s2
  s_add_u32 s62, s89, 0x0
  buffer_load_dwordx4 v5, s[16:19], s62 offen lds
  s_lshl_b32 s4, s49, 10
  s_add_u32 s4, s4, 150016
  v_lshlrev_b32 v31, 3, v30
  v_add_u32 v31, s4, v31
  ds_read_b128 v[96:99], v31
  ds_read_b128 v[100:103], v31 offset:16
  v_lshlrev_b32 v104, 2, v30
  v_add_u32 v104, 154112, v104
  ds_read_b128 v[104:107], v104
  s_lshl_b32 s4, s49, 7
  s_add_u32 s4, s4, 149504
  v_add_u32 v31, s4, v30
  v_cmp_gt_u32 s[94:95], 32, v0
  s_waitcnt lgkmcnt(9)
  v_mfma_f32_32x32x16_bf16 v[48:63], v[92:95], v[140:143], v[48:63]
  ds_read_b64_tr_b16 v[92:93], v13 offset:51200
  ds_read_b64_tr_b16 v[94:95], v13 offset:51712
  s_waitcnt lgkmcnt(9)
  v_mfma_f32_32x32x16_bf16 v[48:63], v[80:83], v[144:147], v[48:63]
  ds_read_b64_tr_b16 v[80:81], v6 offset:49152
  ds_read_b64_tr_b16 v[82:83], v6 offset:49664
  s_cmp_lg_u32 s48, 1
  s_cbranch_scc1 L7
  s_mul_i32 s90, s87, 57344
  s_add_u32 s90, s90, 29056
  s_mov_b32 m0, 162816
  v_min_u32 v127, 27, v0
  v_lshlrev_b32 v127, 10, v127
  buffer_load_dword v127, s[20:23], s90 offen lds
L7:
  s_waitcnt lgkmcnt(6)
  v_add_f32 v96, v96, v98
  v_add_f32 v97, v97, v99
  s_waitcnt lgkmcnt(4)
  v_add_f32 v104, v104, v105
  v_add_f32 v100, v100, v102
  v_add_f32 v101, v101, v103
  v_add_f32 v106, v106, v107
  v_add_f32 v96, v96, v100
  v_add_f32 v97, v97, v101
  v_add_f32 v104, v104, v106
  v_mul_f32 v96, 0xbb000000, v96
  v_mul_f32 v97, 0x3b000000, v97
  v_cvt_pk_bf16_f32 v105, v104, v104
  v_mfma_f32_32x32x16_bf16 v[48:63], v[84:87], v[148:151], v[48:63]
  ds_read_b64_tr_b16 v[84:85], v6 offset:51200
  ds_read_b64_tr_b16 v[86:87], v6 offset:51712
  v_fma_f32 v97, -v96, v96, v97
  v_max_f32 v97, 0, v97
  v_and_b32 v16, 0xffff0000, v105
  v_cvt_pk_bf16_f32 v97, v97, v97
  v_lshlrev_b32 v97, 16, v97
  v_sub_f32 v104, v104, v16
  v_mfma_f32_32x32x16_bf16 v[48:63], v[88:91], v[152:155], v[48:63]
  ds_read_b64_tr_b16 v[88:89], v7 offset:49152
  ds_read_b64_tr_b16 v[90:91], v7 offset:49664
  s_add_u32 m0, s61, 0x1c400
  s_add_u32 s62, s89, 0xe000
  buffer_load_dwordx4 v5, s[16:19], s62 offen lds
  s_cmp_lg_u32 s48, 2
  s_cbranch_scc1 L8
  s_mul_i32 s90, s87, 16384
  s_add_u32 s90, s90, 384
  s_mov_b32 m0, 162816
  v_min_u32 v127, 15, v0
  v_lshlrev_b32 v127, 10, v127
  buffer_load_dword v127, s[24:27], s90 offen lds
L8:
  v_add_f32 v97, 0x3727c5ac, v97
  v_cvt_pk_bf16_f32 v97, v97, v97
  v_cvt_pk_bf16_f32 v17, v104, v104
  v_lshlrev_b32 v97, 16, v97
  v_sqrt_f32 v97, v97
  s_waitcnt lgkmcnt(6)
  v_mfma_f32_32x32x16_bf16 v[48:63], v[92:95], v[156:159], v[48:63]
  ds_read_b64_tr_b16 v[92:93], v7 offset:51200
  ds_read_b64_tr_b16 v[94:95], v7 offset:51712
  v_or_b32 v16, v16, v23
  v_cvt_pk_bf16_f32 v97, v97, v96
  v_lshlrev_b32 v14, 16, v97
  v_rcp_f32 v14, v14
  v_cndmask_b32 v18, 0, v97, s[94:95]
  s_waitcnt lgkmcnt(6)
  v_mfma_f32_32x32x16_bf16 v[48:63], v[80:83], v[160:163], v[48:63]
  v_mfma_f32_16x16x32_bf16 v[124:127], v[120:123], v[80:83], v[124:127]
  ds_read_b64_tr_b16 v[80:81], v8 offset:49152
  ds_read_b64_tr_b16 v[82:83], v8 offset:49664
  s_add_u32 m0, s61, 0x8000
  s_mul_i32 s89, s98, 393216
  s_add_u32 s89, s89, s7
  s_add_u32 s62, s89, 0x0
  buffer_load_dwordx4 v2, s[12:15], s62 offen lds
  v_lshrrev_b32 v19, 16, v18
  v_mul_f32 v15, 0x3fb8aa3b, v14
  v_mul_f32 v22, -2.0, v14
  ds_write_b32 v31, v14
  v_mfma_f32_32x32x16_bf16 v[32:47], v[16:19], v[18:21], v[32:47]
  s_waitcnt lgkmcnt(7)
  v_mfma_f32_32x32x16_bf16 v[48:63], v[84:87], v[164:167], v[48:63]
  v_mfma_f32_16x16x32_bf16 v[124:127], v[120:123], v[84:87], v[124:127]
  ds_read_b64_tr_b16 v[84:85], v8 offset:51200
  ds_read_b64_tr_b16 v[86:87], v8 offset:51712
  s_waitcnt lgkmcnt(7)
  v_mfma_f32_32x32x16_bf16 v[48:63], v[88:91], v[168:171], v[48:63]
  ds_read_b64_tr_b16 v[88:89], v9 offset:49152
  ds_read_b64_tr_b16 v[90:91], v9 offset:49664
  s_add_u32 m0, s61, 0x8400
  s_add_u32 s62, s89, 0x6000
  buffer_load_dwordx4 v2, s[12:15], s62 offen lds
  s_waitcnt lgkmcnt(7)
  v_mfma_f32_32x32x16_bf16 v[48:63], v[92:95], v[172:175], v[48:63]
  ds_read_b64_tr_b16 v[92:93], v9 offset:51200
  ds_read_b64_tr_b16 v[94:95], v9 offset:51712
  v_mul_f32 v96, v32, v15
  v_mul_f32 v97, v33, v15
  v_mul_f32 v98, v34, v15
  v_mul_f32 v99, v35, v15
  v_mul_f32 v100, v36, v15
  v_mul_f32 v101, v37, v15
  s_waitcnt lgkmcnt(7)
  v_mfma_f32_32x32x16_bf16 v[48:63], v[80:83], v[176:179], v[48:63]
  ds_read_b64_tr_b16 v[80:81], v10 offset:0
  ds_read_b64_tr_b16 v[82:83], v10 offset:512
  s_add_u32 m0, s61, 0xc000
  s_mul_i32 s89, s99, 393216
  s_add_u32 s89, s89, s7
  s_add_u32 s62, s89, 0x0
  buffer_load_dwordx4 v2, s[12:15], s62 offen lds
  v_mul_f32 v102, v38, v15
  v_mul_f32 v103, v39, v15
  v_exp_f32 v96, v96
  v_exp_f32 v97, v97
  s_waitcnt lgkmcnt(6)
  v_mfma_f32_32x32x16_bf16 v[48:63], v[84:87], v[180:183], v[48:63]
  ds_read_b64_tr_b16 v[84:85], v10 offset:2048
  ds_read_b64_tr_b16 v[86:87], v10 offset:2560
  v_exp_f32 v98, v98
  v_exp_f32 v99, v99
  v_exp_f32 v100, v100
  s_waitcnt lgkmcnt(6)
  v_mfma_f32_32x32x16_bf16 v[48:63], v[88:91], v[184:187], v[48:63]
  ds_read_b64_tr_b16 v[88:89], v11 offset:0
  ds_read_b64_tr_b16 v[90:91], v11 offset:512
  s_add_u32 m0, s61, 0xc400
  s_add_u32 s62, s89, 0x6000
  buffer_load_dwordx4 v2, s[12:15], s62 offen lds
  v_exp_f32 v101, v101
  v_exp_f32 v102, v102
  v_exp_f32 v103, v103
  s_waitcnt lgkmcnt(6)
  v_mfma_f32_32x32x16_bf16 v[48:63], v[92:95], v[188:191], v[48:63]
  ds_read_b64_tr_b16 v[92:93], v11 offset:2048
  ds_read_b64_tr_b16 v[94:95], v11 offset:2560
  v_add_f32 v96, 1.0, v96
  v_add_f32 v97, 1.0, v97
  v_add_f32 v98, 1.0, v98
  v_add_f32 v99, 1.0, v99
  v_add_f32 v100, 1.0, v100
  v_add_f32 v101, 1.0, v101
  s_waitcnt lgkmcnt(6)
  v_mfma_f32_32x32x16_bf16 v[48:63], v[80:83], v[192:195], v[48:63]
  v_mfma_f32_16x16x32_bf16 v[124:127], v[120:123], v[80:83], v[124:127]
  ds_read_b64_tr_b16 v[80:81], v12 offset:0
  ds_read_b64_tr_b16 v[82:83], v12 offset:512
  v_add_f32 v102, 1.0, v102
  v_add_f32 v103, 1.0, v103
  v_fma_f32 v96, v96, v96, 1.0
  v_fma_f32 v97, v97, v97, 1.0
  v_fma_f32 v98, v98, v98, 1.0
  v_fma_f32 v99, v99, v99, 1.0
  s_waitcnt lgkmcnt(6)
  v_mfma_f32_32x32x16_bf16 v[48:63], v[84:87], v[196:199], v[48:63]
  v_mfma_f32_16x16x32_bf16 v[124:127], v[120:123], v[84:87], v[124:127]
  ds_read_b64_tr_b16 v[84:85], v12 offset:2048
  ds_read_b64_tr_b16 v[86:87], v12 offset:2560
  v_fma_f32 v100, v100, v100, 1.0
  v_fma_f32 v101, v101, v101, 1.0
  v_fma_f32 v102, v102, v102, 1.0
  v_fma_f32 v103, v103, v103, 1.0
  v_rcp_f32 v96, v96
  s_waitcnt lgkmcnt(6)
  v_mfma_f32_32x32x16_bf16 v[48:63], v[88:91], v[200:203], v[48:63]
  s_waitcnt vmcnt(10)
  s_waitcnt vmcnt(8)
  s_barrier
  ds_read_b64_tr_b16 v[88:89], v13 offset:0
  ds_read_b64_tr_b16 v[90:91], v13 offset:512
  s_add_u32 m0, s61, 0x18000
  s_mul_i32 s89, s100, 393216
  s_add_u32 s89, s89, s7
  s_add_u32 s62, s89, 0x0
  buffer_load_dwordx4 v2, s[12:15], s62 offen lds
  v_rcp_f32 v97, v97
  v_rcp_f32 v98, v98
  v_rcp_f32 v99, v99
  s_waitcnt lgkmcnt(6)
  v_mfma_f32_32x32x16_bf16 v[48:63], v[92:95], v[204:207], v[48:63]
  ds_read_b64_tr_b16 v[92:93], v13 offset:2048
  ds_read_b64_tr_b16 v[94:95], v13 offset:2560
  v_rcp_f32 v100, v100
  v_rcp_f32 v101, v101
  v_rcp_f32 v102, v102
  s_waitcnt lgkmcnt(6)
  v_mfma_f32_32x32x16_bf16 v[48:63], v[80:83], v[208:211], v[48:63]
  ds_read_b64_tr_b16 v[80:81], v6 offset:0
  ds_read_b64_tr_b16 v[82:83], v6 offset:512
  s_add_u32 m0, s61, 0x18400
  s_add_u32 s62, s89, 0x6000
  buffer_load_dwordx4 v2, s[12:15], s62 offen lds
  v_rcp_f32 v103, v103
  v_fma_f32 v96, v96, v22, v14
  v_fma_f32 v97, v97, v22, v14
  v_fma_f32 v98, v98, v22, v14
  v_fma_f32 v99, v99, v22, v14
  s_waitcnt lgkmcnt(6)
  v_mfma_f32_32x32x16_bf16 v[48:63], v[84:87], v[212:215], v[48:63]
  ds_read_b64_tr_b16 v[84:85], v6 offset:2048
  ds_read_b64_tr_b16 v[86:87], v6 offset:2560
  v_fma_f32 v100, v100, v22, v14
  v_fma_f32 v101, v101, v22, v14
  v_fma_f32 v102, v102, v22, v14
  v_fma_f32 v103, v103, v22, v14
  v_mul_f32 v96, v32, v96
  v_mul_f32 v97, v33, v97
  s_waitcnt lgkmcnt(6)
  v_mfma_f32_32x32x16_bf16 v[48:63], v[88:91], v[216:219], v[48:63]
  ds_read_b64_tr_b16 v[88:89], v7 offset:0
  ds_read_b64_tr_b16 v[90:91], v7 offset:512
  s_add_u32 m0, s61, 0x20000
  s_mul_i32 s89, s101, 393216
  s_add_u32 s89, s89, s7
  s_add_u32 s62, s89, 0x0
  buffer_load_dwordx4 v2, s[12:15], s62 offen lds
  v_mul_f32 v98, v34, v98
  v_mul_f32 v99, v35, v99
  v_mul_f32 v100, v36, v100
  v_mul_f32 v101, v37, v101
  v_mul_f32 v102, v38, v102
  v_mul_f32 v103, v39, v103
  s_waitcnt lgkmcnt(6)
  v_mfma_f32_32x32x16_bf16 v[48:63], v[92:95], v[220:223], v[48:63]
  ds_read_b64_tr_b16 v[92:93], v7 offset:2048
  ds_read_b64_tr_b16 v[94:95], v7 offset:2560
  v_cvt_pk_bf16_f32 v32, v96, v97
  v_cvt_pk_bf16_f32 v33, v98, v99
  v_cvt_pk_bf16_f32 v34, v100, v101
  v_cvt_pk_bf16_f32 v35, v102, v103
  buffer_store_dwordx4 v[32:35], v1, s[44:47], s74 offen offset:0 sc1
  v_mul_f32 v96, v40, v15
  v_mul_f32 v97, v41, v15
  s_waitcnt lgkmcnt(6)
  v_mfma_f32_32x32x16_bf16 v[48:63], v[80:83], v[224:227], v[48:63]
  v_mfma_f32_16x16x32_bf16 v[124:127], v[120:123], v[80:83], v[124:127]
  ds_read_b64_tr_b16 v[80:81], v8 offset:0
  ds_read_b64_tr_b16 v[82:83], v8 offset:512
  s_add_u32 m0, s61, 0x20400
  s_add_u32 s62, s89, 0x6000
  buffer_load_dwordx4 v2, s[12:15], s62 offen lds
  v_mul_f32 v98, v42, v15
  v_mul_f32 v99, v43, v15
  v_mul_f32 v100, v44, v15
  v_mul_f32 v101, v45, v15
  v_mul_f32 v102, v46, v15
  v_mul_f32 v103, v47, v15
  s_waitcnt lgkmcnt(6)
  v_mfma_f32_32x32x16_bf16 v[48:63], v[84:87], v[228:231], v[48:63]
  v_mfma_f32_16x16x32_bf16 v[124:127], v[120:123], v[84:87], v[124:127]
  ds_read_b64_tr_b16 v[84:85], v8 offset:2048
  ds_read_b64_tr_b16 v[86:87], v8 offset:2560
  v_exp_f32 v96, v96
  v_exp_f32 v97, v97
  v_exp_f32 v98, v98
  s_waitcnt lgkmcnt(6)
  v_mfma_f32_32x32x16_bf16 v[48:63], v[88:91], v[232:235], v[48:63]
  ds_read_b64_tr_b16 v[88:89], v9 offset:0
  ds_read_b64_tr_b16 v[90:91], v9 offset:512
  s_add_u32 m0, s61, 0x10000
  s_add_u32 s62, s68, 0x10000
  buffer_load_dwordx4 v4, s[20:23], s62 offen lds
  v_exp_f32 v99, v99
  v_exp_f32 v100, v100
  v_exp_f32 v101, v101
  s_waitcnt lgkmcnt(6)
  v_mfma_f32_32x32x16_bf16 v[48:63], v[92:95], v[236:239], v[48:63]
  ds_read_b64_tr_b16 v[92:93], v9 offset:2048
  ds_read_b64_tr_b16 v[94:95], v9 offset:2560
  s_lshl_b32 s3, s49, 2
  s_add_u32 s3, s3, 156160
  v_add_u32 v125, s3, v1
  ds_write_b32 v125, v124
  v_exp_f32 v102, v102
  v_exp_f32 v103, v103
  v_add_f32 v96, 1.0, v96
  v_add_f32 v97, 1.0, v97
  s_waitcnt lgkmcnt(7)
  v_mfma_f32_32x32x16_bf16 v[48:63], v[80:83], v[240:243], v[48:63]
  v_bfe_u32 v116, v0, 2, 2
  v_lshrrev_b32 v117, 5, v0
  v_lshl_add_u32 v116, v117, 3, v116
  v_lshlrev_b32 v116, 6, v116
  v_bfe_u32 v117, v0, 4, 1
  v_lshl_add_u32 v116, v117, 5, v116
  v_and_b32 v117, 3, v0
  v_lshl_add_u32 v116, v117, 3, v116
  s_xor_b32 s3, s49, 0
  s_lshl_b32 s3, s3, 11
  s_add_u32 s3, s3, 0
  v_add_u32 v112, s3, v116
  s_xor_b32 s3, s49, 1
  s_lshl_b32 s3, s3, 11
  s_add_u32 s3, s3, 0
  v_add_u32 v113, s3, v116
  s_xor_b32 s3, s49, 2
  s_lshl_b32 s3, s3, 11
  s_add_u32 s3, s3, 0
  v_add_u32 v114, s3, v116
  s_xor_b32 s3, s49, 3
  s_lshl_b32 s3, s3, 11
  s_add_u32 s3, s3, 0
  v_add_u32 v115, s3, v116
  ds_read_b64_tr_b16 v[80:81], v112 offset:0
  ds_read_b64_tr_b16 v[82:83], v112 offset:256
  buffer_load_dword v27, v30, s[40:43], 0 offen offset:128 sc1
  v_add_f32 v98, 1.0, v98
  v_add_f32 v99, 1.0, v99
  v_add_f32 v100, 1.0, v100
  v_add_f32 v101, 1.0, v101
  v_add_f32 v102, 1.0, v102
  v_add_f32 v103, 1.0, v103
  s_waitcnt lgkmcnt(7)
  v_mfma_f32_32x32x16_bf16 v[48:63], v[84:87], v[244:247], v[48:63]
  ds_read_b64_tr_b16 v[84:85], v112 offset:1024
  ds_read_b64_tr_b16 v[86:87], v112 offset:1280
  v_fma_f32 v96, v96, v96, 1.0
  v_fma_f32 v97, v97, v97, 1.0
  v_fma_f32 v98, v98, v98, 1.0
  v_fma_f32 v99, v99, v99, 1.0
  v_fma_f32 v100, v100, v100, 1.0
  v_fma_f32 v101, v101, v101, 1.0
  s_waitcnt lgkmcnt(7)
  v_mfma_f32_32x32x16_bf16 v[48:63], v[88:91], v[248:251], v[48:63]
  ds_read_b64_tr_b16 v[88:89], v113 offset:0
  ds_read_b64_tr_b16 v[90:91], v113 offset:256
  s_add_u32 m0, s61, 0x10400
  s_add_u32 s62, s68, 0x12000
  buffer_load_dwordx4 v4, s[20:23], s62 offen lds
  v_fma_f32 v102, v102, v102, 1.0
  v_fma_f32 v103, v103, v103, 1.0
  v_rcp_f32 v96, v96
  v_rcp_f32 v97, v97
  s_waitcnt lgkmcnt(7)
  v_mfma_f32_32x32x16_bf16 v[48:63], v[92:95], v[252:255], v[48:63]
  ds_read_b64_tr_b16 v[92:93], v113 offset:1024
  ds_read_b64_tr_b16 v[94:95], v113 offset:1280
  v_rcp_f32 v98, v98
  v_rcp_f32 v99, v99
  v_rcp_f32 v100, v100
  s_waitcnt lgkmcnt(6)
  v_mfma_f32_32x32x16_bf16 v[64:79], v[80:83], v[128:131], 0
  v_mfma_f32_16x16x32_bf16 v[124:127], v[120:123], v[80:83], 0
  ds_read_b64_tr_b16 v[80:81], v114 offset:0
  ds_read_b64_tr_b16 v[82:83], v114 offset:256
  v_rcp_f32 v101, v101
  v_rcp_f32 v102, v102
  v_rcp_f32 v103, v103
  s_waitcnt lgkmcnt(6)
  v_mfma_f32_32x32x16_bf16 v[64:79], v[84:87], v[132:135], v[64:79]
  v_mfma_f32_16x16x32_bf16 v[124:127], v[120:123], v[84:87], v[124:127]
  ds_read_b64_tr_b16 v[84:85], v114 offset:1024
  ds_read_b64_tr_b16 v[86:87], v114 offset:1280
  v_fma_f32 v96, v96, v22, v14
  v_fma_f32 v97, v97, v22, v14
  v_fma_f32 v98, v98, v22, v14
  v_fma_f32 v99, v99, v22, v14
  v_fma_f32 v100, v100, v22, v14
  s_waitcnt lgkmcnt(6)
  v_mfma_f32_32x32x16_bf16 v[64:79], v[88:91], v[136:139], v[64:79]
  s_waitcnt vmcnt(12)
  s_waitcnt vmcnt(10)
  s_barrier
  ds_read_b64_tr_b16 v[88:89], v115 offset:0
  ds_read_b64_tr_b16 v[90:91], v115 offset:256
  v_fma_f32 v101, v101, v22, v14
  v_fma_f32 v102, v102, v22, v14
  v_fma_f32 v103, v103, v22, v14
  v_mul_f32 v96, v40, v96
  v_mul_f32 v97, v41, v97
  s_waitcnt lgkmcnt(6)
  v_mfma_f32_32x32x16_bf16 v[64:79], v[92:95], v[140:143], v[64:79]
  ds_read_b64_tr_b16 v[92:93], v115 offset:1024
  ds_read_b64_tr_b16 v[94:95], v115 offset:1280
  v_mul_f32 v98, v42, v98
  v_mul_f32 v99, v43, v99
  v_mul_f32 v100, v44, v100
  v_mul_f32 v101, v45, v101
  v_mul_f32 v102, v46, v102
  s_waitcnt lgkmcnt(6)
  v_mfma_f32_32x32x16_bf16 v[64:79], v[80:83], v[144:147], v[64:79]
  ds_read_b64_tr_b16 v[80:81], v112 offset:8192
  ds_read_b64_tr_b16 v[82:83], v112 offset:8448
  v_mul_f32 v103, v47, v103
  v_cvt_pk_bf16_f32 v40, v96, v97
  v_cvt_pk_bf16_f32 v41, v98, v99
  v_cvt_pk_bf16_f32 v42, v100, v101
  v_cvt_pk_bf16_f32 v43, v102, v103
  s_waitcnt lgkmcnt(6)
  v_mfma_f32_32x32x16_bf16 v[64:79], v[84:87], v[148:151], v[64:79]
  ds_read_b64_tr_b16 v[84:85], v112 offset:9216
  ds_read_b64_tr_b16 v[86:87], v112 offset:9472
  buffer_store_dwordx4 v[40:43], v1, s[44:47], s74 offen offset:1024 sc1
  s_add_u32 s74, s74, 4096
  v_lshlrev_b32 v104, 2, v30
  v_add_u32 v104, 156160, v104
  ds_read_b128 v[104:107], v104
  s_waitcnt lgkmcnt(7)
  v_mfma_f32_32x32x16_bf16 v[64:79], v[88:91], v[152:155], v[64:79]
  ds_read_b64_tr_b16 v[88:89], v113 offset:8192
  ds_read_b64_tr_b16 v[90:91], v113 offset:8448
  s_waitcnt lgkmcnt(7)
  v_mfma_f32_32x32x16_bf16 v[64:79], v[92:95], v[156:159], v[64:79]
  ds_read_b64_tr_b16 v[92:93], v113 offset:9216
  ds_read_b64_tr_b16 v[94:95], v113 offset:9472
  s_waitcnt lgkmcnt(7)
  v_mfma_f32_32x32x16_bf16 v[64:79], v[80:83], v[160:163], v[64:79]
  v_mfma_f32_16x16x32_bf16 v[124:127], v[120:123], v[80:83], v[124:127]
  ds_read_b64_tr_b16 v[80:81], v114 offset:8192
  ds_read_b64_tr_b16 v[82:83], v114 offset:8448
  s_waitcnt lgkmcnt(7)
  v_mfma_f32_32x32x16_bf16 v[64:79], v[84:87], v[164:167], v[64:79]
  v_mfma_f32_16x16x32_bf16 v[124:127], v[120:123], v[84:87], v[124:127]
  ds_read_b64_tr_b16 v[84:85], v114 offset:9216
  ds_read_b64_tr_b16 v[86:87], v114 offset:9472
  s_waitcnt lgkmcnt(8)
  v_add_f32 v104, v104, v105
  v_add_f32 v106, v106, v107
  v_add_f32 v104, v104, v106
  v_cvt_pk_bf16_f32 v105, v104, v104
  v_and_b32 v16, 0xffff0000, v105
  v_sub_f32 v104, v104, v16
  v_cvt_pk_bf16_f32 v17, v104, v104
  v_or_b32 v16, v16, v24
  s_waitcnt lgkmcnt(6)
  v_mfma_f32_32x32x16_bf16 v[64:79], v[88:91], v[168:171], v[64:79]
  ds_read_b64_tr_b16 v[88:89], v115 offset:8192
  ds_read_b64_tr_b16 v[90:91], v115 offset:8448
  v_mfma_f32_32x32x16_bf16 v[48:63], v[16:19], v[18:21], v[48:63]
  s_waitcnt lgkmcnt(6)
  v_mfma_f32_32x32x16_bf16 v[64:79], v[92:95], v[172:175], v[64:79]
  ds_read_b64_tr_b16 v[92:93], v115 offset:9216
  ds_read_b64_tr_b16 v[94:95], v115 offset:9472
  s_waitcnt lgkmcnt(6)
  v_mfma_f32_32x32x16_bf16 v[64:79], v[80:83], v[176:179], v[64:79]
  v_add_u32 v112, 0x1c000, v112
  v_add_u32 v113, 0x1c000, v113
  v_add_u32 v114, 0x1c000, v114
  v_add_u32 v115, 0x1c000, v115
  ds_read_b64_tr_b16 v[80:81], v112 offset:0
  ds_read_b64_tr_b16 v[82:83], v112 offset:256
  s_waitcnt lgkmcnt(6)
  v_mfma_f32_32x32x16_bf16 v[64:79], v[84:87], v[180:183], v[64:79]
  ds_read_b64_tr_b16 v[84:85], v112 offset:1024
  ds_read_b64_tr_b16 v[86:87], v112 offset:1280
  v_mul_f32 v96, v48, v15
  v_mul_f32 v97, v49, v15
  v_mul_f32 v98, v50, v15
  v_mul_f32 v99, v51, v15
  v_mul_f32 v100, v52, v15
  s_waitcnt lgkmcnt(6)
  v_mfma_f32_32x32x16_bf16 v[64:79], v[88:91], v[184:187], v[64:79]
  ds_read_b64_tr_b16 v[88:89], v113 offset:0
  ds_read_b64_tr_b16 v[90:91], v113 offset:256
  v_mul_f32 v101, v53, v15
  v_mul_f32 v102, v54, v15
  v_mul_f32 v103, v55, v15
  v_exp_f32 v96, v96
  s_waitcnt lgkmcnt(6)
  v_mfma_f32_32x32x16_bf16 v[64:79], v[92:95], v[188:191], v[64:79]
  ds_read_b64_tr_b16 v[92:93], v113 offset:1024
  ds_read_b64_tr_b16 v[94:95], v113 offset:1280
  v_exp_f32 v97, v97
  v_exp_f32 v98, v98
  v_exp_f32 v99, v99
  s_waitcnt lgkmcnt(6)
  v_mfma_f32_32x32x16_bf16 v[64:79], v[80:83], v[192:195], v[64:79]
  v_mfma_f32_16x16x32_bf16 v[124:127], v[120:123], v[80:83], v[124:127]
  ds_read_b64_tr_b16 v[80:81], v114 offset:0
  ds_read_b64_tr_b16 v[82:83], v114 offset:256
  v_exp_f32 v100, v100
  v_exp_f32 v101, v101
  v_exp_f32 v102, v102
  s_waitcnt lgkmcnt(6)
  v_mfma_f32_32x32x16_bf16 v[64:79], v[84:87], v[196:199], v[64:79]
  v_mfma_f32_16x16x32_bf16 v[124:127], v[120:123], v[84:87], v[124:127]
  ds_read_b64_tr_b16 v[84:85], v114 offset:1024
  ds_read_b64_tr_b16 v[86:87], v114 offset:1280
  v_exp_f32 v103, v103
  v_add_f32 v96, 1.0, v96
  v_add_f32 v97, 1.0, v97
  v_add_f32 v98, 1.0, v98
  s_waitcnt lgkmcnt(6)
  v_mfma_f32_32x32x16_bf16 v[64:79], v[88:91], v[200:203], v[64:79]
  ds_read_b64_tr_b16 v[88:89], v115 offset:0
  ds_read_b64_tr_b16 v[90:91], v115 offset:256
  v_add_f32 v99, 1.0, v99
  v_add_f32 v100, 1.0, v100
  v_add_f32 v101, 1.0, v101
  v_add_f32 v102, 1.0, v102
  v_add_f32 v103, 1.0, v103
  s_waitcnt lgkmcnt(6)
  v_mfma_f32_32x32x16_bf16 v[64:79], v[92:95], v[204:207], v[64:79]
  ds_read_b64_tr_b16 v[92:93], v115 offset:1024
  ds_read_b64_tr_b16 v[94:95], v115 offset:1280
  v_fma_f32 v96, v96, v96, 1.0
  v_fma_f32 v97, v97, v97, 1.0
  v_fma_f32 v98, v98, v98, 1.0
  v_fma_f32 v99, v99, v99, 1.0
  v_fma_f32 v100, v100, v100, 1.0
  s_waitcnt lgkmcnt(6)
  v_mfma_f32_32x32x16_bf16 v[64:79], v[80:83], v[208:211], v[64:79]
  ds_read_b64_tr_b16 v[80:81], v112 offset:8192
  ds_read_b64_tr_b16 v[82:83], v112 offset:8448
  v_fma_f32 v101, v101, v101, 1.0
  v_fma_f32 v102, v102, v102, 1.0
  v_fma_f32 v103, v103, v103, 1.0
  v_rcp_f32 v96, v96
  s_waitcnt lgkmcnt(6)
  v_mfma_f32_32x32x16_bf16 v[64:79], v[84:87], v[212:215], v[64:79]
  ds_read_b64_tr_b16 v[84:85], v112 offset:9216
  ds_read_b64_tr_b16 v[86:87], v112 offset:9472
  v_rcp_f32 v97, v97
  v_rcp_f32 v98, v98
  v_rcp_f32 v99, v99
  s_waitcnt lgkmcnt(6)
  v_mfma_f32_32x32x16_bf16 v[64:79], v[88:91], v[216:219], v[64:79]
  ds_read_b64_tr_b16 v[88:89], v113 offset:8192
  ds_read_b64_tr_b16 v[90:91], v113 offset:8448
  v_rcp_f32 v100, v100
  v_rcp_f32 v101, v101
  v_rcp_f32 v102, v102
  s_waitcnt lgkmcnt(6)
  v_mfma_f32_32x32x16_bf16 v[64:79], v[92:95], v[220:223], v[64:79]
  ds_read_b64_tr_b16 v[92:93], v113 offset:9216
  ds_read_b64_tr_b16 v[94:95], v113 offset:9472
  v_rcp_f32 v103, v103
  v_fma_f32 v96, v96, v22, v14
  v_fma_f32 v97, v97, v22, v14
  v_fma_f32 v98, v98, v22, v14
  s_waitcnt lgkmcnt(6)
  v_mfma_f32_32x32x16_bf16 v[64:79], v[80:83], v[224:227], v[64:79]
  v_mfma_f32_16x16x32_bf16 v[124:127], v[120:123], v[80:83], v[124:127]
  ds_read_b64_tr_b16 v[80:81], v114 offset:8192
  ds_read_b64_tr_b16 v[82:83], v114 offset:8448
  v_fma_f32 v99, v99, v22, v14
  v_fma_f32 v100, v100, v22, v14
  v_fma_f32 v101, v101, v22, v14
  v_fma_f32 v102, v102, v22, v14
  v_fma_f32 v103, v103, v22, v14
  s_waitcnt lgkmcnt(6)
  v_mfma_f32_32x32x16_bf16 v[64:79], v[84:87], v[228:231], v[64:79]
  v_mfma_f32_16x16x32_bf16 v[124:127], v[120:123], v[84:87], v[124:127]
  ds_read_b64_tr_b16 v[84:85], v114 offset:9216
  ds_read_b64_tr_b16 v[86:87], v114 offset:9472
  v_mul_f32 v96, v48, v96
  v_mul_f32 v97, v49, v97
  v_mul_f32 v98, v50, v98
  v_mul_f32 v99, v51, v99
  v_mul_f32 v100, v52, v100
  s_waitcnt lgkmcnt(6)
  v_mfma_f32_32x32x16_bf16 v[64:79], v[88:91], v[232:235], v[64:79]
  ds_read_b64_tr_b16 v[88:89], v115 offset:8192
  ds_read_b64_tr_b16 v[90:91], v115 offset:8448
  v_mul_f32 v101, v53, v101
  v_mul_f32 v102, v54, v102
  v_mul_f32 v103, v55, v103
  v_cvt_pk_bf16_f32 v48, v96, v97
  v_cvt_pk_bf16_f32 v49, v98, v99
  s_waitcnt lgkmcnt(6)
  v_mfma_f32_32x32x16_bf16 v[64:79], v[92:95], v[236:239], v[64:79]
  ds_read_b64_tr_b16 v[92:93], v115 offset:9216
  ds_read_b64_tr_b16 v[94:95], v115 offset:9472
  s_lshl_b32 s3, s49, 2
  s_add_u32 s3, s3, 154112
  v_add_u32 v125, s3, v1
  ds_write_b32 v125, v124
  v_cvt_pk_bf16_f32 v50, v100, v101
  v_cvt_pk_bf16_f32 v51, v102, v103
  buffer_store_dwordx4 v[48:51], v1, s[44:47], s74 offen offset:0 sc1
  v_mul_f32 v96, v56, v15
  v_mul_f32 v97, v57, v15
  v_mul_f32 v98, v58, v15
  s_waitcnt lgkmcnt(7)
  v_mfma_f32_32x32x16_bf16 v[64:79], v[80:83], v[240:243], v[64:79]
  ds_read_b64_tr_b16 v[80:81], v6 offset:16384
  ds_read_b64_tr_b16 v[82:83], v6 offset:16896
  v_mul_f32 v99, v59, v15
  v_mul_f32 v100, v60, v15
  v_mul_f32 v101, v61, v15
  s_waitcnt vmcnt(3)
  v_cmp_ne_u32 vcc, 0, v27
  s_nop 0
  s_andn2_b32 s3, 0xffffffff, vcc_lo
  s_cbranch_scc1 L9
L10:
  s_waitcnt vmcnt(1)
  buffer_store_dword v10, v28, s[44:47], s65 offen offset:0 sc1
  s_waitcnt lgkmcnt(7)
  v_mfma_f32_32x32x16_bf16 v[64:79], v[84:87], v[244:247], v[64:79]
  ds_read_b64_tr_b16 v[84:85], v6 offset:18432
  ds_read_b64_tr_b16 v[86:87], v6 offset:18944
  v_mul_f32 v102, v62, v15
  v_mul_f32 v103, v63, v15
  v_exp_f32 v96, v96
  v_exp_f32 v97, v97
  s_waitcnt lgkmcnt(7)
  v_mfma_f32_32x32x16_bf16 v[64:79], v[88:91], v[248:251], v[64:79]
  ds_read_b64_tr_b16 v[88:89], v7 offset:16384
  ds_read_b64_tr_b16 v[90:91], v7 offset:16896
  v_exp_f32 v98, v98
  v_exp_f32 v99, v99
  v_exp_f32 v100, v100
  s_waitcnt lgkmcnt(7)
  v_mfma_f32_32x32x16_bf16 v[64:79], v[92:95], v[252:255], v[64:79]
  ds_read_b64_tr_b16 v[92:93], v7 offset:18432
  ds_read_b64_tr_b16 v[94:95], v7 offset:18944
  v_exp_f32 v101, v101
  v_exp_f32 v102, v102
  v_exp_f32 v103, v103
  s_waitcnt lgkmcnt(6)
  v_mfma_f32_32x32x16_bf16 v[32:47], v[80:83], v[128:131], 0
  v_mfma_f32_16x16x32_bf16 v[124:127], v[120:123], v[80:83], 0
  ds_read_b64_tr_b16 v[80:81], v8 offset:16384
  ds_read_b64_tr_b16 v[82:83], v8 offset:16896
  v_add_f32 v96, 1.0, v96
  v_add_f32 v97, 1.0, v97
  v_add_f32 v98, 1.0, v98
  v_add_f32 v99, 1.0, v99
  v_add_f32 v100, 1.0, v100
  v_add_f32 v101, 1.0, v101
  v_add_f32 v102, 1.0, v102
  v_add_f32 v103, 1.0, v103
  v_fma_f32 v96, v96, v96, 1.0
  s_waitcnt lgkmcnt(6)
  v_mfma_f32_32x32x16_bf16 v[32:47], v[84:87], v[132:135], v[32:47]
  v_mfma_f32_16x16x32_bf16 v[124:127], v[120:123], v[84:87], v[124:127]
  ds_read_b64_tr_b16 v[84:85], v8 offset:18432
  ds_read_b64_tr_b16 v[86:87], v8 offset:18944
  v_fma_f32 v97, v97, v97, 1.0
  v_fma_f32 v98, v98, v98, 1.0
  v_fma_f32 v99, v99, v99, 1.0
  v_fma_f32 v100, v100, v100, 1.0
  v_fma_f32 v101, v101, v101, 1.0
  v_fma_f32 v102, v102, v102, 1.0
  v_fma_f32 v103, v103, v103, 1.0
  v_rcp_f32 v96, v96
  s_waitcnt lgkmcnt(6)
  v_mfma_f32_32x32x16_bf16 v[32:47], v[88:91], v[136:139], v[32:47]
  s_barrier
  ds_read_b64_tr_b16 v[88:89], v9 offset:16384
  ds_read_b64_tr_b16 v[90:91], v9 offset:16896
  s_add_u32 m0, s61, 0x0
  s_add_u32 s62, s68, 0x120000
  buffer_load_dwordx4 v4, s[20:23], s62 offen lds
  s_add_u32 m0, s61, 0x400
  s_add_u32 s62, s68, 0x122000
  buffer_load_dwordx4 v4, s[20:23], s62 offen lds
  v_rcp_f32 v97, v97
  v_rcp_f32 v98, v98
  v_rcp_f32 v99, v99
  v_rcp_f32 v100, v100
  v_rcp_f32 v101, v101
  s_waitcnt lgkmcnt(6)
  v_mfma_f32_32x32x16_bf16 v[32:47], v[92:95], v[140:143], v[32:47]
  ds_read_b64_tr_b16 v[92:93], v9 offset:18432
  ds_read_b64_tr_b16 v[94:95], v9 offset:18944
  v_rcp_f32 v102, v102
  v_rcp_f32 v103, v103
  v_fma_f32 v96, v96, v22, v14
  v_fma_f32 v97, v97, v22, v14
  v_fma_f32 v98, v98, v22, v14
  v_fma_f32 v99, v99, v22, v14
  v_fma_f32 v100, v100, v22, v14
  s_waitcnt lgkmcnt(6)
  v_mfma_f32_32x32x16_bf16 v[32:47], v[80:83], v[144:147], v[32:47]
  ds_read_b64_tr_b16 v[80:81], v6 offset:32768
  ds_read_b64_tr_b16 v[82:83], v6 offset:33280
  s_add_u32 m0, s61, 0x1c000
  s_add_u32 s62, s68, 0x20000
  buffer_load_dwordx4 v4, s[20:23], s62 offen lds
  v_fma_f32 v101, v101, v22, v14
  v_fma_f32 v102, v102, v22, v14
  v_fma_f32 v103, v103, v22, v14
  v_mul_f32 v96, v56, v96
  v_mul_f32 v97, v57, v97
  v_mul_f32 v98, v58, v98
  v_mul_f32 v99, v59, v99
  v_mul_f32 v100, v60, v100
  v_mul_f32 v101, v61, v101
  s_waitcnt lgkmcnt(6)
  v_mfma_f32_32x32x16_bf16 v[32:47], v[84:87], v[148:151], v[32:47]
  ds_read_b64_tr_b16 v[84:85], v6 offset:34816
  ds_read_b64_tr_b16 v[86:87], v6 offset:35328
  v_mul_f32 v102, v62, v102
  v_mul_f32 v103, v63, v103
  v_cvt_pk_bf16_f32 v56, v96, v97
  v_cvt_pk_bf16_f32 v57, v98, v99
  v_cvt_pk_bf16_f32 v58, v100, v101
  v_cvt_pk_bf16_f32 v59, v102, v103
  buffer_store_dwordx4 v[56:59], v1, s[44:47], s74 offen offset:1024 sc1
  v_lshlrev_b32 v104, 2, v30
  v_add_u32 v104, 154112, v104
  s_waitcnt lgkmcnt(6)
  v_mfma_f32_32x32x16_bf16 v[32:47], v[88:91], v[152:155], v[32:47]
  ds_read_b64_tr_b16 v[88:89], v7 offset:32768
  ds_read_b64_tr_b16 v[90:91], v7 offset:33280
  s_add_u32 m0, s61, 0x1c400
  s_add_u32 s62, s68, 0x22000
  buffer_load_dwordx4 v4, s[20:23], s62 offen lds
  ds_read_b128 v[104:107], v104
  s_waitcnt lgkmcnt(7)
  v_mfma_f32_32x32x16_bf16 v[32:47], v[92:95], v[156:159], v[32:47]
  ds_read_b64_tr_b16 v[92:93], v7 offset:34816
  ds_read_b64_tr_b16 v[94:95], v7 offset:35328
  v_bfe_u32 v5, v0, 2, 2
  v_lshrrev_b32 v24, 5, v0
  v_lshl_add_u32 v5, v24, 2, v5
  v_lshlrev_b32 v5, 7, v5
  v_bfe_u32 v24, v0, 3, 1
  v_lshl_add_u32 v5, v24, 6, v5
  v_bfe_u32 v24, v0, 4, 1
  v_lshl_add_u32 v5, v24, 5, v5
  v_and_b32 v24, 3, v0
  v_lshl_add_u32 v5, v24, 3, v5
  s_lshl_b32 s3, s56, 6
  v_xor_b32 v5, s3, v5
  s_lshl_b32 s3, s57, 10
  v_add_u32 v24, s3, v1
  s_waitcnt lgkmcnt(2)
  v_add_f32 v104, v104, v105
  v_add_f32 v106, v106, v107
  v_add_f32 v104, v104, v106
  v_cvt_pk_bf16_f32 v105, v104, v104
  v_and_b32 v16, 0xffff0000, v105
  v_sub_f32 v104, v104, v16
  v_cvt_pk_bf16_f32 v17, v104, v104
  v_or_b32 v16, v16, v25
  v_mfma_f32_32x32x16_bf16 v[32:47], v[80:83], v[160:163], v[32:47]
  v_mfma_f32_16x16x32_bf16 v[124:127], v[120:123], v[80:83], v[124:127]
  ds_read_b64_tr_b16 v[80:81], v8 offset:32768
  ds_read_b64_tr_b16 v[82:83], v8 offset:33280
  v_mfma_f32_32x32x16_bf16 v[64:79], v[16:19], v[18:21], v[64:79]
  v_mfma_f32_32x32x16_bf16 v[32:47], v[84:87], v[164:167], v[32:47]
  v_mfma_f32_16x16x32_bf16 v[124:127], v[120:123], v[84:87], v[124:127]
  ds_read_b64_tr_b16 v[84:85], v8 offset:34816
  ds_read_b64_tr_b16 v[86:87], v8 offset:35328
  v_add_u32 v5, 0x10000, v5
  ds_read_b64_tr_b16 v[128:129], v5 offset:0
  ds_read_b64_tr_b16 v[130:131], v5 offset:1024
  ds_read_b64_tr_b16 v[132:133], v5 offset:2048
  ds_read_b64_tr_b16 v[134:135], v5 offset:3072
  ds_read_b64_tr_b16 v[136:137], v5 offset:4096
  ds_read_b64_tr_b16 v[138:139], v5 offset:5120
  ds_read_b64_tr_b16 v[140:141], v5 offset:6144
  ds_read_b64_tr_b16 v[142:143], v5 offset:7168
  v_mfma_f32_32x32x16_bf16 v[32:47], v[88:91], v[168:171], v[32:47]
  ds_read_b64_tr_b16 v[88:89], v9 offset:32768
  ds_read_b64_tr_b16 v[90:91], v9 offset:33280
  v_mul_f32 v96, v64, v15
  v_mul_f32 v97, v65, v15
  v_mul_f32 v98, v66, v15
  v_mul_f32 v99, v67, v15
  v_mul_f32 v100, v68, v15
  v_mul_f32 v101, v69, v15
  v_mul_f32 v102, v70, v15
  v_mul_f32 v103, v71, v15
  v_exp_f32 v96, v96
  s_waitcnt lgkmcnt(14)
  v_mfma_f32_32x32x16_bf16 v[32:47], v[92:95], v[172:175], v[32:47]
  ds_read_b64_tr_b16 v[92:93], v9 offset:34816
  ds_read_b64_tr_b16 v[94:95], v9 offset:35328
  ds_read_b64_tr_b16 v[144:145], v5 offset:8192
  ds_read_b64_tr_b16 v[146:147], v5 offset:9216
  ds_read_b64_tr_b16 v[148:149], v5 offset:10240
  ds_read_b64_tr_b16 v[150:151], v5 offset:11264
  ds_read_b64_tr_b16 v[152:153], v5 offset:12288
  ds_read_b64_tr_b16 v[154:155], v5 offset:13312
  ds_read_b64_tr_b16 v[156:157], v5 offset:14336
  ds_read_b64_tr_b16 v[158:159], v5 offset:15360
  v_exp_f32 v97, v97
  v_exp_f32 v98, v98
  v_exp_f32 v99, v99
  v_exp_f32 v100, v100
  v_exp_f32 v101, v101
  s_waitcnt lgkmcnt(15)
  v_mfma_f32_32x32x16_bf16 v[32:47], v[80:83], v[176:179], v[32:47]
  ds_read_b64_tr_b16 v[80:81], v10 offset:16384
  ds_read_b64_tr_b16 v[82:83], v10 offset:16896
  v_exp_f32 v102, v102
  v_exp_f32 v103, v103
  v_add_f32 v96, 1.0, v96
  v_add_f32 v97, 1.0, v97
  v_add_f32 v98, 1.0, v98
  v_add_f32 v99, 1.0, v99
  v_add_f32 v100, 1.0, v100
  v_mfma_f32_32x32x16_bf16 v[32:47], v[84:87], v[180:183], v[32:47]
  ds_read_b64_tr_b16 v[84:85], v10 offset:18432
  ds_read_b64_tr_b16 v[86:87], v10 offset:18944
  v_add_f32 v101, 1.0, v101
  v_add_f32 v102, 1.0, v102
  v_add_f32 v103, 1.0, v103
  v_fma_f32 v96, v96, v96, 1.0
  v_fma_f32 v97, v97, v97, 1.0
  v_fma_f32 v98, v98, v98, 1.0
  v_fma_f32 v99, v99, v99, 1.0
  v_fma_f32 v100, v100, v100, 1.0
  v_fma_f32 v101, v101, v101, 1.0
  s_waitcnt lgkmcnt(14)
  v_mfma_f32_32x32x16_bf16 v[32:47], v[88:91], v[184:187], v[32:47]
  ds_read_b64_tr_b16 v[88:89], v11 offset:16384
  ds_read_b64_tr_b16 v[90:91], v11 offset:16896
  v_fma_f32 v102, v102, v102, 1.0
  v_fma_f32 v103, v103, v103, 1.0
  v_rcp_f32 v96, v96
  v_rcp_f32 v97, v97
  v_rcp_f32 v98, v98
  v_rcp_f32 v99, v99
  s_waitcnt lgkmcnt(14)
  v_mfma_f32_32x32x16_bf16 v[32:47], v[92:95], v[188:191], v[32:47]
  ds_read_b64_tr_b16 v[92:93], v11 offset:18432
  ds_read_b64_tr_b16 v[94:95], v11 offset:18944
  v_rcp_f32 v100, v100
  v_rcp_f32 v101, v101
  v_rcp_f32 v102, v102
  v_rcp_f32 v103, v103
  v_fma_f32 v96, v96, v22, v14
  s_waitcnt lgkmcnt(6)
  v_mfma_f32_32x32x16_bf16 v[32:47], v[80:83], v[192:195], v[32:47]
  v_mfma_f32_16x16x32_bf16 v[124:127], v[120:123], v[80:83], v[124:127]
  ds_read_b64_tr_b16 v[80:81], v12 offset:16384
  ds_read_b64_tr_b16 v[82:83], v12 offset:16896
  v_fma_f32 v97, v97, v22, v14
  v_fma_f32 v98, v98, v22, v14
  v_fma_f32 v99, v99, v22, v14
  v_fma_f32 v100, v100, v22, v14
  v_fma_f32 v101, v101, v22, v14
  v_fma_f32 v102, v102, v22, v14
  v_fma_f32 v103, v103, v22, v14
  v_mul_f32 v96, v64, v96
  v_mul_f32 v97, v65, v97
  s_waitcnt lgkmcnt(6)
  v_mfma_f32_32x32x16_bf16 v[32:47], v[84:87], v[196:199], v[32:47]
  v_mfma_f32_16x16x32_bf16 v[124:127], v[120:123], v[84:87], v[124:127]
  ds_read_b64_tr_b16 v[84:85], v12 offset:18432
  ds_read_b64_tr_b16 v[86:87], v12 offset:18944
  v_mul_f32 v98, v66, v98
  v_mul_f32 v99, v67, v99
  v_mul_f32 v100, v68, v100
  v_mul_f32 v101, v69, v101
  v_mul_f32 v102, v70, v102
  v_mul_f32 v103, v71, v103
  v_cvt_pk_bf16_f32 v64, v96, v97
  v_cvt_pk_bf16_f32 v65, v98, v99
  v_cvt_pk_bf16_f32 v66, v100, v101
  s_waitcnt lgkmcnt(6)
  v_mfma_f32_32x32x16_bf16 v[32:47], v[88:91], v[200:203], v[32:47]
  s_barrier
  ds_read_b64_tr_b16 v[88:89], v13 offset:16384
  ds_read_b64_tr_b16 v[90:91], v13 offset:16896
  s_add_u32 m0, s61, 0x8000
  s_add_u32 s62, s68, 0x100000
  buffer_load_dwordx4 v4, s[20:23], s62 offen lds
  s_add_u32 m0, s61, 0x8400
  s_add_u32 s62, s68, 0x102000
  buffer_load_dwordx4 v4, s[20:23], s62 offen lds
  v_cvt_pk_bf16_f32 v67, v102, v103
  buffer_store_dwordx4 v[64:67], v1, s[44:47], s72 offen offset:0 sc1
  v_mul_f32 v96, v72, v15
  v_mul_f32 v97, v73, v15
  v_mul_f32 v98, v74, v15
  v_mul_f32 v99, v75, v15
  v_mul_f32 v100, v76, v15
  v_mul_f32 v101, v77, v15
  v_mul_f32 v102, v78, v15
  s_waitcnt vmcnt(4)
  buffer_store_dword v10, v28, s[44:47], s65 offen offset:128 sc1
  s_waitcnt lgkmcnt(6)
  v_mfma_f32_32x32x16_bf16 v[32:47], v[92:95], v[204:207], v[32:47]
  ds_read_b64_tr_b16 v[92:93], v13 offset:18432
  ds_read_b64_tr_b16 v[94:95], v13 offset:18944
  v_add_u32 v5, 0x4000, v5
  ds_read_b64_tr_b16 v[160:161], v5 offset:0
  ds_read_b64_tr_b16 v[162:163], v5 offset:1024
  ds_read_b64_tr_b16 v[164:165], v5 offset:2048
  ds_read_b64_tr_b16 v[166:167], v5 offset:3072
  ds_read_b64_tr_b16 v[168:169], v5 offset:4096
  ds_read_b64_tr_b16 v[170:171], v5 offset:5120
  ds_read_b64_tr_b16 v[172:173], v5 offset:6144
  ds_read_b64_tr_b16 v[174:175], v5 offset:7168
  v_mul_f32 v103, v79, v15
  v_exp_f32 v96, v96
  v_exp_f32 v97, v97
  v_exp_f32 v98, v98
  v_exp_f32 v99, v99
  s_waitcnt lgkmcnt(14)
  v_mfma_f32_32x32x16_bf16 v[32:47], v[80:83], v[208:211], v[32:47]
  ds_read_b64_tr_b16 v[80:81], v10 offset:49152
  ds_read_b64_tr_b16 v[82:83], v10 offset:49664
  s_add_u32 m0, s61, 0xc000
  s_add_u32 s62, s68, 0x50000
  buffer_load_dwordx4 v4, s[20:23], s62 offen lds
  v_exp_f32 v100, v100
  v_exp_f32 v101, v101
  v_exp_f32 v102, v102
  v_exp_f32 v103, v103
  v_add_f32 v96, 1.0, v96
  s_waitcnt lgkmcnt(14)
  v_mfma_f32_32x32x16_bf16 v[32:47], v[84:87], v[212:215], v[32:47]
  ds_read_b64_tr_b16 v[84:85], v10 offset:51200
  ds_read_b64_tr_b16 v[86:87], v10 offset:51712
  ds_read_b64_tr_b16 v[176:177], v5 offset:8192
  ds_read_b64_tr_b16 v[178:179], v5 offset:9216
  ds_read_b64_tr_b16 v[180:181], v5 offset:10240
  ds_read_b64_tr_b16 v[182:183], v5 offset:11264
  ds_read_b64_tr_b16 v[184:185], v5 offset:12288
  ds_read_b64_tr_b16 v[186:187], v5 offset:13312
  ds_read_b64_tr_b16 v[188:189], v5 offset:14336
  ds_read_b64_tr_b16 v[190:191], v5 offset:15360
  v_add_f32 v97, 1.0, v97
  v_add_f32 v98, 1.0, v98
  v_add_f32 v99, 1.0, v99
  v_add_f32 v100, 1.0, v100
  v_add_f32 v101, 1.0, v101
  v_add_f32 v102, 1.0, v102
  v_add_f32 v103, 1.0, v103
  v_fma_f32 v96, v96, v96, 1.0
  v_fma_f32 v97, v97, v97, 1.0
  s_waitcnt lgkmcnt(15)
  v_mfma_f32_32x32x16_bf16 v[32:47], v[88:91], v[216:219], v[32:47]
  ds_read_b64_tr_b16 v[88:89], v11 offset:49152
  ds_read_b64_tr_b16 v[90:91], v11 offset:49664
  s_add_u32 m0, s61, 0xc400
  s_add_u32 s62, s68, 0x52000
  buffer_load_dwordx4 v4, s[20:23], s62 offen lds
  v_fma_f32 v98, v98, v98, 1.0
  v_fma_f32 v99, v99, v99, 1.0
  v_fma_f32 v100, v100, v100, 1.0
  v_fma_f32 v101, v101, v101, 1.0
  v_fma_f32 v102, v102, v102, 1.0
  v_fma_f32 v103, v103, v103, 1.0
  v_rcp_f32 v96, v96
  v_rcp_f32 v97, v97
  v_mfma_f32_32x32x16_bf16 v[32:47], v[92:95], v[220:223], v[32:47]
  ds_read_b64_tr_b16 v[92:93], v11 offset:51200
  ds_read_b64_tr_b16 v[94:95], v11 offset:51712
  v_rcp_f32 v98, v98
  v_rcp_f32 v99, v99
  v_rcp_f32 v100, v100
  v_rcp_f32 v101, v101
  v_rcp_f32 v102, v102
  s_waitcnt lgkmcnt(14)
  v_mfma_f32_32x32x16_bf16 v[32:47], v[80:83], v[224:227], v[32:47]
  v_mfma_f32_16x16x32_bf16 v[124:127], v[120:123], v[80:83], v[124:127]
  ds_read_b64_tr_b16 v[80:81], v12 offset:49152
  ds_read_b64_tr_b16 v[82:83], v12 offset:49664
  s_add_u32 m0, s61, 0x10000
  s_add_u32 s62, s68, 0x130000
  buffer_load_dwordx4 v4, s[20:23], s62 offen lds
  v_add_u32 v5, 0xffff0000, v5
  ds_read_b64_tr_b16 v[192:193], v5 offset:0
  ds_read_b64_tr_b16 v[194:195], v5 offset:1024
  ds_read_b64_tr_b16 v[196:197], v5 offset:2048
  ds_read_b64_tr_b16 v[198:199], v5 offset:3072
  ds_read_b64_tr_b16 v[200:201], v5 offset:4096
  ds_read_b64_tr_b16 v[202:203], v5 offset:5120
  ds_read_b64_tr_b16 v[204:205], v5 offset:6144
  ds_read_b64_tr_b16 v[206:207], v5 offset:7168
  v_rcp_f32 v103, v103
  v_fma_f32 v96, v96, v22, v14
  v_fma_f32 v97, v97, v22, v14
  v_fma_f32 v98, v98, v22, v14
  v_fma_f32 v99, v99, v22, v14
  v_fma_f32 v100, v100, v22, v14
  v_fma_f32 v101, v101, v22, v14
  v_fma_f32 v102, v102, v22, v14
  s_waitcnt lgkmcnt(15)
  v_mfma_f32_32x32x16_bf16 v[32:47], v[84:87], v[228:231], v[32:47]
  v_mfma_f32_16x16x32_bf16 v[124:127], v[120:123], v[84:87], v[124:127]
  ds_read_b64_tr_b16 v[84:85], v12 offset:51200
  ds_read_b64_tr_b16 v[86:87], v12 offset:51712
  v_fma_f32 v103, v103, v22, v14
  v_mul_f32 v96, v72, v96
  v_mul_f32 v97, v73, v97
  v_mul_f32 v98, v74, v98
  v_mul_f32 v99, v75, v99
  v_mul_f32 v100, v76, v100
  v_mul_f32 v101, v77, v101
  v_mul_f32 v102, v78, v102
  v_mul_f32 v103, v79, v103
  s_waitcnt lgkmcnt(14)
  v_mfma_f32_32x32x16_bf16 v[32:47], v[88:91], v[232:235], v[32:47]
  ds_read_b64_tr_b16 v[88:89], v13 offset:49152
  ds_read_b64_tr_b16 v[90:91], v13 offset:49664
  s_add_u32 m0, s61, 0x10400
  s_add_u32 s62, s68, 0x132000
  buffer_load_dwordx4 v4, s[20:23], s62 offen lds
  ds_read_b64_tr_b16 v[208:209], v5 offset:8192
  ds_read_b64_tr_b16 v[210:211], v5 offset:9216
  ds_read_b64_tr_b16 v[212:213], v5 offset:10240
  ds_read_b64_tr_b16 v[214:215], v5 offset:11264
  ds_read_b64_tr_b16 v[216:217], v5 offset:12288
  ds_read_b64_tr_b16 v[218:219], v5 offset:13312
  ds_read_b64_tr_b16 v[220:221], v5 offset:14336
  ds_read_b64_tr_b16 v[222:223], v5 offset:15360
  v_cvt_pk_bf16_f32 v72, v96, v97
  v_cvt_pk_bf16_f32 v73, v98, v99
  v_cvt_pk_bf16_f32 v74, v100, v101
  v_cvt_pk_bf16_f32 v75, v102, v103
  buffer_store_dwordx4 v[72:75], v1, s[44:47], s72 offen offset:1024 sc1
  s_waitcnt lgkmcnt(15)
  v_mfma_f32_32x32x16_bf16 v[32:47], v[92:95], v[236:239], v[32:47]
  ds_read_b64_tr_b16 v[92:93], v13 offset:51200
  ds_read_b64_tr_b16 v[94:95], v13 offset:51712
  s_lshl_b32 s3, s49, 2
  s_add_u32 s3, s3, 156160
  v_add_u32 v125, s3, v1
  ds_write_b32 v125, v124
  v_mfma_f32_32x32x16_bf16 v[32:47], v[80:83], v[240:243], v[32:47]
  s_waitcnt lgkmcnt(13)
  v_mfma_f32_32x32x16_bf16 v[32:47], v[84:87], v[244:247], v[32:47]
  s_waitcnt lgkmcnt(11)
  v_mfma_f32_32x32x16_bf16 v[32:47], v[88:91], v[248:251], v[32:47]
  s_waitcnt lgkmcnt(1)
  v_mfma_f32_32x32x16_bf16 v[32:47], v[92:95], v[252:255], v[32:47]
  s_waitcnt lgkmcnt(0)
  s_barrier
  s_lshl_b32 s7, s54, 16
  s_lshl_b32 s4, s57, 15
  s_add_u32 s7, s7, s4
  s_lshl_b32 s4, s55, 7
  s_add_u32 s7, s7, s4
  s_lshl_b32 s4, s56, 6
  s_add_u32 s7, s7, s4
  v_lshlrev_b32 v108, 2, v30
  v_add_u32 v108, 156160, v108
  ds_read_b128 v[108:111], v108
  s_waitcnt lgkmcnt(0)
  v_add_f32 v108, v108, v109
  v_add_f32 v110, v110, v111
  v_add_f32 v108, v108, v110
  v_cvt_pk_bf16_f32 v109, v108, v108
  v_and_b32 v16, 0xffff0000, v109
  v_sub_f32 v108, v108, v16
  v_cvt_pk_bf16_f32 v17, v108, v108
  s_nop 1
  v_mfma_f32_32x32x16_bf16 v[32:47], v[16:19], v[18:21], v[32:47]
  v_bfe_u32 v25, v0, 2, 2
  v_lshrrev_b32 v26, 5, v0
  v_lshl_add_u32 v25, v26, 2, v25
  v_lshlrev_b32 v25, 5, v25
  v_bfe_u32 v26, v0, 4, 1
  v_lshl_add_u32 v25, v26, 4, v25
  v_bfe_u32 v26, v0, 1, 1
  v_lshl_add_u32 v25, v26, 3, v25
  s_lshl_b32 s4, s50, 10
  s_add_u32 s4, s4, 147456
  v_add_u32 v25, s4, v25
  ds_read_b64_tr_b16 v[112:113], v25 offset:0
  ds_read_b64_tr_b16 v[114:115], v25 offset:256
  ds_read_b64_tr_b16 v[116:117], v25 offset:512
  ds_read_b64_tr_b16 v[118:119], v25 offset:768
  v_bfe_u32 v26, v0, 2, 1
  v_mul_u32_u24 v26, 0x8000, v26
  v_lshl_or_b32 v26, v26, 16, v26
  s_waitcnt lgkmcnt(3)
  v_xor_b32 v112, v26, v112
  v_xor_b32 v113, v26, v113
  s_waitcnt lgkmcnt(2)
  v_xor_b32 v114, v26, v114
  v_xor_b32 v115, v26, v115
  s_waitcnt lgkmcnt(1)
  v_xor_b32 v116, v26, v116
  v_xor_b32 v117, v26, v117
  s_waitcnt lgkmcnt(0)
  v_xor_b32 v118, v26, v118
  v_xor_b32 v119, v26, v119
  v_cvt_pk_bf16_f32 v120, v32, v33
  v_cvt_pk_bf16_f32 v121, v34, v35
  v_cvt_pk_bf16_f32 v122, v36, v37
  v_cvt_pk_bf16_f32 v123, v38, v39
  v_cvt_pk_bf16_f32 v124, v40, v41
  v_cvt_pk_bf16_f32 v125, v42, v43
  v_cvt_pk_bf16_f32 v126, v44, v45
  v_cvt_pk_bf16_f32 v127, v46, v47
  v_mfma_f32_32x32x16_bf16 v[96:111], v[112:115], v[120:123], 0
  s_nop 0
  v_mfma_f32_32x32x16_bf16 v[48:63], v[116:119], v[124:127], 0
  s_nop 9
  v_max3_f32 v26, v96, v97, v98
  v_max3_f32 v31, v99, v100, v101
  v_max3_f32 v26, v26, v102, v103
  v_min_u32 v21, 15, v0
  v_lshlrev_b32 v21, 7, v21
  buffer_load_dword v9, v21, s[44:47], s71 offen offset:0 sc1
  v_max3_f32 v31, v31, v104, v105
  v_max3_f32 v26, v26, v106, v107
  v_max3_f32 v31, v31, v108, v109
  v_max3_f32 v26, v26, v110, v111
  v_max_f32 v26, v26, v31
  v_mul_f32_e64 v26, -v26, v15
  v_fma_f32 v96, v96, v15, v26
  v_fma_f32 v97, v97, v15, v26
  v_fma_f32 v98, v98, v15, v26
  v_fma_f32 v99, v99, v15, v26
  v_fma_f32 v100, v100, v15, v26
  v_fma_f32 v101, v101, v15, v26
  v_fma_f32 v102, v102, v15, v26
  v_fma_f32 v103, v103, v15, v26
  v_fma_f32 v104, v104, v15, v26
  v_fma_f32 v105, v105, v15, v26
  v_fma_f32 v106, v106, v15, v26
  v_fma_f32 v107, v107, v15, v26
  v_fma_f32 v108, v108, v15, v26
  v_fma_f32 v109, v109, v15, v26
  v_fma_f32 v110, v110, v15, v26
  v_fma_f32 v111, v111, v15, v26
  v_exp_f32 v96, v96
  v_exp_f32 v97, v97
  v_exp_f32 v98, v98
  v_exp_f32 v99, v99
  v_exp_f32 v100, v100
  v_exp_f32 v101, v101
  s_barrier
  v_add_u32 v24, 0x18000, v24
  ds_read_b128 v[240:243], v24 offset:0
  ds_read_b128 v[244:247], v24 offset:2048
  ds_read_b128 v[248:251], v24 offset:4096
  ds_read_b128 v[252:255], v24 offset:6144
  s_waitcnt lgkmcnt(3)
  v_mfma_f32_32x32x16_bf16 v[224:239], v[128:131], v[240:243], 0
  ds_read_b128 v[240:243], v24 offset:8192
  v_exp_f32 v102, v102
  v_exp_f32 v103, v103
  v_exp_f32 v104, v104
  v_exp_f32 v105, v105
  v_exp_f32 v106, v106
  v_exp_f32 v107, v107
  v_exp_f32 v108, v108
  s_waitcnt lgkmcnt(3)
  v_mfma_f32_32x32x16_bf16 v[224:239], v[132:135], v[244:247], v[224:239]
  ds_read_b128 v[244:247], v24 offset:10240
  v_exp_f32 v109, v109
  v_exp_f32 v110, v110
  v_exp_f32 v111, v111
  v_add_f32 v26, v96, v97
  v_add_f32 v31, v98, v99
  v_add_f32 v26, v26, v100
  v_add_f32 v31, v31, v101
  v_add_f32 v26, v26, v102
  v_add_f32 v31, v31, v103
  v_add_f32 v26, v26, v104
  s_waitcnt lgkmcnt(3)
  v_mfma_f32_32x32x16_bf16 v[224:239], v[136:139], v[248:251], v[224:239]
  ds_read_b128 v[248:251], v24 offset:12288
  v_add_f32 v31, v31, v105
  v_add_f32 v26, v26, v106
  v_add_f32 v31, v31, v107
  v_add_f32 v26, v26, v108
  s_waitcnt vmcnt(1)
  buffer_store_dword v10, v28, s[44:47], s65 offen offset:384 sc1
  s_waitcnt vmcnt(1)
  v_cmp_ne_u32 vcc, 0, v9
  s_nop 0
  s_andn2_b32 s3, 0xffff, vcc_lo
  s_cbranch_scc1 L12
L13:
  s_lshl_b32 s5, s57, 10
  s_add_u32 s5, s5, s70
  buffer_load_dwordx4 v[80:83], v1, s[44:47], s5 offen sc1
  v_and_b32 v21, 3, v0
  v_lshlrev_b32 v21, 4, v21
  s_lshl_b32 s5, s57, 6
  s_add_u32 s5, s5, s70
  buffer_load_dwordx4 v[84:87], v21, s[44:47], s5 offen offset:2048 sc1
  v_add_f32 v31, v31, v109
  v_add_f32 v26, v26, v110
  s_waitcnt lgkmcnt(3)
  v_mfma_f32_32x32x16_bf16 v[224:239], v[140:143], v[252:255], v[224:239]
  ds_read_b128 v[252:255], v24 offset:14336
  v_add_f32 v31, v31, v111
  v_add_f32 v26, v26, v31
  v_rcp_f32 v26, v26
  s_nop 0
  v_mul_f32 v96, v96, v26
  v_mul_f32 v97, v97, v26
  v_mul_f32 v98, v98, v26
  v_mul_f32 v99, v99, v26
  v_mul_f32 v100, v100, v26
  v_mul_f32 v101, v101, v26
  v_mul_f32 v102, v102, v26
  v_mul_f32 v103, v103, v26
  v_mul_f32 v104, v104, v26
  s_waitcnt lgkmcnt(3)
  v_mfma_f32_32x32x16_bf16 v[224:239], v[144:147], v[240:243], v[224:239]
  s_waitcnt lgkmcnt(0)
  s_barrier
  v_add_u32 v24, 0x8000, v24
  ds_read_b128 v[240:243], v24 offset:0
  v_add_u32 v5, 0xffffc000, v5
  ds_read_b64_tr_b16 v[128:129], v5 offset:0
  ds_read_b64_tr_b16 v[130:131], v5 offset:1024
  v_mul_f32 v105, v105, v26
  v_mul_f32 v106, v106, v26
  v_mul_f32 v107, v107, v26
  v_mul_f32 v108, v108, v26
  v_mul_f32 v109, v109, v26
  v_mul_f32 v110, v110, v26
  v_mul_f32 v111, v111, v26
  v_cvt_pk_bf16_f32 v32, v96, v97
  v_cvt_pk_bf16_f32 v33, v98, v99
  v_cvt_pk_bf16_f32 v34, v100, v101
  v_cvt_pk_bf16_f32 v35, v102, v103
  v_cvt_pk_bf16_f32 v36, v104, v105
  v_cvt_pk_bf16_f32 v37, v106, v107
  v_mfma_f32_32x32x16_bf16 v[224:239], v[148:151], v[244:247], v[224:239]
  ds_read_b128 v[244:247], v24 offset:2048
  ds_read_b64_tr_b16 v[132:133], v5 offset:2048
  ds_read_b64_tr_b16 v[134:135], v5 offset:3072
  v_cvt_pk_bf16_f32 v38, v108, v109
  v_cvt_pk_bf16_f32 v39, v110, v111
  v_max3_f32 v26, v48, v49, v50
  v_max3_f32 v31, v51, v52, v53
  v_max3_f32 v26, v26, v54, v55
  v_max3_f32 v31, v31, v56, v57
  v_max3_f32 v26, v26, v58, v59
  v_max3_f32 v31, v31, v60, v61
  v_max3_f32 v26, v26, v62, v63
  v_max_f32 v26, v26, v31
  v_mul_f32_e64 v26, -v26, v15
  v_fma_f32 v48, v48, v15, v26
  v_fma_f32 v49, v49, v15, v26
  v_mfma_f32_32x32x16_bf16 v[224:239], v[152:155], v[248:251], v[224:239]
  ds_read_b128 v[248:251], v24 offset:4096
  ds_read_b64_tr_b16 v[136:137], v5 offset:4096
  ds_read_b64_tr_b16 v[138:139], v5 offset:5120
  v_fma_f32 v50, v50, v15, v26
  v_fma_f32 v51, v51, v15, v26
  v_fma_f32 v52, v52, v15, v26
  v_fma_f32 v53, v53, v15, v26
  v_fma_f32 v54, v54, v15, v26
  v_fma_f32 v55, v55, v15, v26
  v_fma_f32 v56, v56, v15, v26
  v_fma_f32 v57, v57, v15, v26
  v_fma_f32 v58, v58, v15, v26
  v_fma_f32 v59, v59, v15, v26
  v_fma_f32 v60, v60, v15, v26
  v_fma_f32 v61, v61, v15, v26
  v_fma_f32 v62, v62, v15, v26
  v_mfma_f32_32x32x16_bf16 v[224:239], v[156:159], v[252:255], v[224:239]
  ds_read_b128 v[252:255], v24 offset:6144
  ds_read_b64_tr_b16 v[140:141], v5 offset:6144
  ds_read_b64_tr_b16 v[142:143], v5 offset:7168
  v_fma_f32 v63, v63, v15, v26
  v_exp_f32 v48, v48
  v_exp_f32 v49, v49
  v_exp_f32 v50, v50
  v_exp_f32 v51, v51
  v_exp_f32 v52, v52
  v_exp_f32 v53, v53
  s_waitcnt lgkmcnt(11)
  v_mfma_f32_32x32x16_bf16 v[224:239], v[160:163], v[240:243], v[224:239]
  ds_read_b128 v[240:243], v24 offset:8192
  ds_read_b64_tr_b16 v[144:145], v5 offset:8192
  ds_read_b64_tr_b16 v[146:147], v5 offset:9216
  v_exp_f32 v54, v54
  v_exp_f32 v55, v55
  v_exp_f32 v56, v56
  v_exp_f32 v57, v57
  v_exp_f32 v58, v58
  v_exp_f32 v59, v59
  v_exp_f32 v60, v60
  s_waitcnt lgkmcnt(11)
  v_mfma_f32_32x32x16_bf16 v[224:239], v[164:167], v[244:247], v[224:239]
  ds_read_b128 v[244:247], v24 offset:10240
  ds_read_b64_tr_b16 v[148:149], v5 offset:10240
  ds_read_b64_tr_b16 v[150:151], v5 offset:11264
  v_exp_f32 v61, v61
  v_exp_f32 v62, v62
  v_exp_f32 v63, v63
  v_add_f32 v26, v48, v49
  v_add_f32 v31, v50, v51
  v_add_f32 v26, v26, v52
  v_add_f32 v31, v31, v53
  v_add_f32 v26, v26, v54
  v_add_f32 v31, v31, v55
  v_add_f32 v26, v26, v56
  s_waitcnt lgkmcnt(11)
  v_mfma_f32_32x32x16_bf16 v[224:239], v[168:171], v[248:251], v[224:239]
  ds_read_b128 v[248:251], v24 offset:12288
  ds_read_b64_tr_b16 v[152:153], v5 offset:12288
  ds_read_b64_tr_b16 v[154:155], v5 offset:13312
  v_add_f32 v31, v31, v57
  v_add_f32 v26, v26, v58
  v_add_f32 v31, v31, v59
  v_add_f32 v26, v26, v60
  v_add_f32 v31, v31, v61
  v_add_f32 v26, v26, v62
  v_add_f32 v31, v31, v63
  v_add_f32 v26, v26, v31
  v_rcp_f32 v26, v26
  s_nop 0
  v_mul_f32 v48, v48, v26
  v_mul_f32 v49, v49, v26
  v_mul_f32 v50, v50, v26
  s_waitcnt lgkmcnt(11)
  v_mfma_f32_32x32x16_bf16 v[224:239], v[172:175], v[252:255], v[224:239]
  ds_read_b128 v[252:255], v24 offset:14336
  ds_read_b64_tr_b16 v[156:157], v5 offset:14336
  ds_read_b64_tr_b16 v[158:159], v5 offset:15360
  v_mul_f32 v51, v51, v26
  v_mul_f32 v52, v52, v26
  v_mul_f32 v53, v53, v26
  v_mul_f32 v54, v54, v26
  v_mul_f32 v55, v55, v26
  v_mul_f32 v56, v56, v26
  v_mul_f32 v57, v57, v26
  v_mul_f32 v58, v58, v26
  v_mul_f32 v59, v59, v26
  v_mul_f32 v60, v60, v26
  v_mul_f32 v61, v61, v26
  v_mul_f32 v62, v62, v26
  v_mul_f32 v63, v63, v26
  s_waitcnt lgkmcnt(11)
  v_mfma_f32_32x32x16_bf16 v[224:239], v[176:179], v[240:243], v[224:239]
  s_waitcnt lgkmcnt(0)
  s_barrier
  v_add_u32 v24, 0xffff4000, v24
  ds_read_b128 v[240:243], v24 offset:0
  v_add_u32 v5, 0x1c000, v5
  ds_read_b64_tr_b16 v[160:161], v5 offset:0
  ds_read_b64_tr_b16 v[162:163], v5 offset:1024
  v_cvt_pk_bf16_f32 v40, v48, v49
  v_cvt_pk_bf16_f32 v41, v50, v51
  v_cvt_pk_bf16_f32 v42, v52, v53
  v_cvt_pk_bf16_f32 v43, v54, v55
  v_cvt_pk_bf16_f32 v44, v56, v57
  v_cvt_pk_bf16_f32 v45, v58, v59
  v_cvt_pk_bf16_f32 v46, v60, v61
  v_cvt_pk_bf16_f32 v47, v62, v63
  s_waitcnt vmcnt(1)
  v_cvt_pk_bf16_f32 v80, v80, v81
  v_cvt_pk_bf16_f32 v81, v82, v83
  s_waitcnt vmcnt(0)
  v_cvt_pk_bf16_f32 v84, v84, v85
  v_cvt_pk_bf16_f32 v85, v86, v87
  s_mul_i32 s5, s56, 1088
  s_add_u32 s5, s5, 158208
  s_lshl_b32 s4, s57, 9
  s_add_u32 s4, s4, s5
  v_lshlrev_b32 v25, 3, v0
  v_add_u32 v25, s4, v25
  ds_write_b64 v25, v[80:81]
  s_lshl_b32 s4, s57, 5
  s_add_u32 s4, s4, s5
  v_lshrrev_b32 v21, 1, v21
  v_add_u32 v21, s4, v21
  ds_write_b64 v21, v[84:85] offset:1024
  v_mfma_f32_32x32x16_bf16 v[224:239], v[180:183], v[244:247], v[224:239]
  ds_read_b128 v[244:247], v24 offset:2048
  ds_read_b64_tr_b16 v[164:165], v5 offset:2048
  ds_read_b64_tr_b16 v[166:167], v5 offset:3072
  v_min_u32 v25, 64, v30
  v_lshlrev_b32 v25, 4, v25
  v_lshrrev_b32 v26, 5, v0
  v_lshl_add_u32 v25, v26, 5, v25
  v_add_u32 v25, 158208, v25
  s_lshl_b32 s5, s52, 12
  s_add_u32 s5, s5, s64
  s_add_u32 s72, s5, 114688
  v_mfma_f32_32x32x16_bf16 v[224:239], v[184:187], v[248:251], v[224:239]
  ds_read_b128 v[248:251], v24 offset:4096
  ds_read_b64_tr_b16 v[168:169], v5 offset:4096
  ds_read_b64_tr_b16 v[170:171], v5 offset:5120
  v_mfma_f32_32x32x16_bf16 v[224:239], v[188:191], v[252:255], v[224:239]
  ds_read_b128 v[252:255], v24 offset:6144
  ds_read_b64_tr_b16 v[172:173], v5 offset:6144
  ds_read_b64_tr_b16 v[174:175], v5 offset:7168
  s_waitcnt lgkmcnt(13)
  v_mfma_f32_32x32x16_bf16 v[224:239], v[192:195], v[240:243], v[224:239]
  ds_read_b128 v[240:243], v24 offset:8192
  ds_read_b64_tr_b16 v[176:177], v5 offset:8192
  ds_read_b64_tr_b16 v[178:179], v5 offset:9216
  s_waitcnt lgkmcnt(11)
  v_mfma_f32_32x32x16_bf16 v[224:239], v[196:199], v[244:247], v[224:239]
  ds_read_b128 v[244:247], v24 offset:10240
  ds_read_b64_tr_b16 v[180:181], v5 offset:10240
  ds_read_b64_tr_b16 v[182:183], v5 offset:11264
  s_waitcnt lgkmcnt(11)
  v_mfma_f32_32x32x16_bf16 v[224:239], v[200:203], v[248:251], v[224:239]
  ds_read_b128 v[248:251], v24 offset:12288
  ds_read_b64_tr_b16 v[184:185], v5 offset:12288
  ds_read_b64_tr_b16 v[186:187], v5 offset:13312
  s_waitcnt lgkmcnt(11)
  v_mfma_f32_32x32x16_bf16 v[224:239], v[204:207], v[252:255], v[224:239]
  ds_read_b128 v[252:255], v24 offset:14336
  ds_read_b64_tr_b16 v[188:189], v5 offset:14336
  ds_read_b64_tr_b16 v[190:191], v5 offset:15360
  s_waitcnt lgkmcnt(11)
  v_mfma_f32_32x32x16_bf16 v[224:239], v[208:211], v[240:243], v[224:239]
  s_waitcnt lgkmcnt(0)
  s_barrier
  v_add_u32 v24, 0xffff0000, v24
  ds_read_b128 v[240:243], v24 offset:0
  v_add_u32 v5, 0xfffec000, v5
  ds_read_b64_tr_b16 v[192:193], v5 offset:0
  ds_read_b64_tr_b16 v[194:195], v5 offset:1024
  ds_read_b128 v[112:115], v25
  ds_read_b128 v[116:119], v25 offset:16
  ds_read_b128 v[120:123], v25 offset:1088
  ds_read_b128 v[124:127], v25 offset:1104
  v_mfma_f32_32x32x16_bf16 v[224:239], v[212:215], v[244:247], v[224:239]
  ds_read_b128 v[244:247], v24 offset:2048
  ds_read_b64_tr_b16 v[196:197], v5 offset:2048
  ds_read_b64_tr_b16 v[198:199], v5 offset:3072
  v_mfma_f32_32x32x16_bf16 v[224:239], v[216:219], v[248:251], v[224:239]
  ds_read_b128 v[248:251], v24 offset:4096
  ds_read_b64_tr_b16 v[200:201], v5 offset:4096
  ds_read_b64_tr_b16 v[202:203], v5 offset:5120
  v_mfma_f32_32x32x16_bf16 v[224:239], v[220:223], v[252:255], v[224:239]
  ds_read_b128 v[252:255], v24 offset:6144
  ds_read_b64_tr_b16 v[204:205], v5 offset:6144
  ds_read_b64_tr_b16 v[206:207], v5 offset:7168
  s_waitcnt lgkmcnt(12)
  v_mfma_f32_32x32x16_bf16 v[96:111], v[112:115], v[32:35], 0
  s_waitcnt lgkmcnt(11)
  v_mfma_f32_32x32x16_bf16 v[96:111], v[116:119], v[36:39], v[96:111]
  s_waitcnt lgkmcnt(10)
  v_mfma_f32_32x32x16_bf16 v[48:63], v[120:123], v[40:43], 0
  s_waitcnt lgkmcnt(9)
  v_mfma_f32_32x32x16_bf16 v[48:63], v[124:127], v[44:47], v[48:63]
  v_mfma_f32_32x32x16_bf16 v[224:239], v[128:131], v[240:243], v[224:239]
  ds_read_b128 v[240:243], v24 offset:8192
  ds_read_b64_tr_b16 v[208:209], v5 offset:8192
  ds_read_b64_tr_b16 v[210:211], v5 offset:9216
  s_waitcnt lgkmcnt(11)
  v_mfma_f32_32x32x16_bf16 v[224:239], v[132:135], v[244:247], v[224:239]
  ds_read_b128 v[244:247], v24 offset:10240
  ds_read_b64_tr_b16 v[212:213], v5 offset:10240
  ds_read_b64_tr_b16 v[214:215], v5 offset:11264
  v_add_f32 v26, 0x358637bd, v104
  v_rcp_f32 v26, v26
  s_nop 0
  v_mul_f32 v96, v96, v26
  v_mul_f32 v97, v97, v26
  v_mul_f32 v98, v98, v26
  v_mul_f32 v99, v99, v26
  v_mul_f32 v100, v100, v26
  v_mul_f32 v101, v101, v26
  v_mul_f32 v102, v102, v26
  v_mul_f32 v103, v103, v26
  v_cvt_pk_bf16_f32 v32, v96, v97
  v_cvt_pk_bf16_f32 v33, v98, v99
  v_cvt_pk_bf16_f32 v34, v100, v101
  v_cvt_pk_bf16_f32 v35, v102, v103
  buffer_store_dwordx4 v[32:35], v1, s[44:47], s72 offen offset:0 sc1
  v_add_f32 v26, 0x358637bd, v56
  v_rcp_f32 v26, v26
  s_nop 0
  v_mul_f32 v48, v48, v26
  s_waitcnt lgkmcnt(11)
  v_mfma_f32_32x32x16_bf16 v[224:239], v[136:139], v[248:251], v[224:239]
  ds_read_b128 v[248:251], v24 offset:12288
  ds_read_b64_tr_b16 v[216:217], v5 offset:12288
  ds_read_b64_tr_b16 v[218:219], v5 offset:13312
  v_mul_f32 v49, v49, v26
  v_mul_f32 v50, v50, v26
  v_mul_f32 v51, v51, v26
  v_mul_f32 v52, v52, v26
  v_mul_f32 v53, v53, v26
  v_mul_f32 v54, v54, v26
  v_mul_f32 v55, v55, v26
  v_cvt_pk_bf16_f32 v36, v48, v49
  v_cvt_pk_bf16_f32 v37, v50, v51
  v_cvt_pk_bf16_f32 v38, v52, v53
  v_cvt_pk_bf16_f32 v39, v54, v55
  buffer_store_dwordx4 v[36:39], v1, s[44:47], s72 offen offset:1024 sc1
  s_waitcnt lgkmcnt(11)
  v_mfma_f32_32x32x16_bf16 v[224:239], v[140:143], v[252:255], v[224:239]
  ds_read_b128 v[252:255], v24 offset:14336
  ds_read_b64_tr_b16 v[220:221], v5 offset:14336
  ds_read_b64_tr_b16 v[222:223], v5 offset:15360
  s_waitcnt lgkmcnt(11)
  v_mfma_f32_32x32x16_bf16 v[224:239], v[144:147], v[240:243], v[224:239]
  s_waitcnt lgkmcnt(0)
  s_barrier
  v_add_u32 v24, 0x14000, v24
  ds_read_b128 v[240:243], v24 offset:0
  v_add_u32 v5, 0x4000, v5
  ds_read_b64_tr_b16 v[128:129], v5 offset:0
  ds_read_b64_tr_b16 v[130:131], v5 offset:1024
  v_mfma_f32_32x32x16_bf16 v[224:239], v[148:151], v[244:247], v[224:239]
  ds_read_b128 v[244:247], v24 offset:2048
  ds_read_b64_tr_b16 v[132:133], v5 offset:2048
  ds_read_b64_tr_b16 v[134:135], v5 offset:3072
  v_mfma_f32_32x32x16_bf16 v[224:239], v[152:155], v[248:251], v[224:239]
  ds_read_b128 v[248:251], v24 offset:4096
  ds_read_b64_tr_b16 v[136:137], v5 offset:4096
  ds_read_b64_tr_b16 v[138:139], v5 offset:5120
  v_mfma_f32_32x32x16_bf16 v[224:239], v[156:159], v[252:255], v[224:239]
  ds_read_b128 v[252:255], v24 offset:6144
  ds_read_b64_tr_b16 v[140:141], v5 offset:6144
  ds_read_b64_tr_b16 v[142:143], v5 offset:7168
  s_waitcnt lgkmcnt(11)
  v_mfma_f32_32x32x16_bf16 v[224:239], v[160:163], v[240:243], v[224:239]
  ds_read_b128 v[240:243], v24 offset:8192
  ds_read_b64_tr_b16 v[144:145], v5 offset:8192
  ds_read_b64_tr_b16 v[146:147], v5 offset:9216
  s_waitcnt lgkmcnt(11)
  v_mfma_f32_32x32x16_bf16 v[224:239], v[164:167], v[244:247], v[224:239]
  ds_read_b128 v[244:247], v24 offset:10240
  ds_read_b64_tr_b16 v[148:149], v5 offset:10240
  ds_read_b64_tr_b16 v[150:151], v5 offset:11264
  s_waitcnt lgkmcnt(11)
  v_mfma_f32_32x32x16_bf16 v[224:239], v[168:171], v[248:251], v[224:239]
  ds_read_b128 v[248:251], v24 offset:12288
  ds_read_b64_tr_b16 v[152:153], v5 offset:12288
  ds_read_b64_tr_b16 v[154:155], v5 offset:13312
  s_waitcnt lgkmcnt(11)
  v_mfma_f32_32x32x16_bf16 v[224:239], v[172:175], v[252:255], v[224:239]
  ds_read_b128 v[252:255], v24 offset:14336
  ds_read_b64_tr_b16 v[156:157], v5 offset:14336
  ds_read_b64_tr_b16 v[158:159], v5 offset:15360
  s_waitcnt vmcnt(0)
  buffer_store_dword v10, v28, s[44:47], s65 offen offset:512 sc1
  s_waitcnt lgkmcnt(11)
  v_mfma_f32_32x32x16_bf16 v[224:239], v[176:179], v[240:243], v[224:239]
  s_waitcnt lgkmcnt(0)
  s_barrier
  v_add_u32 v24, 0x8000, v24
  ds_read_b128 v[240:243], v24 offset:0
  v_add_u32 v5, 0x4000, v5
  ds_read_b64_tr_b16 v[160:161], v5 offset:0
  ds_read_b64_tr_b16 v[162:163], v5 offset:1024
  v_mfma_f32_32x32x16_bf16 v[224:239], v[180:183], v[244:247], v[224:239]
  ds_read_b128 v[244:247], v24 offset:2048
  ds_read_b64_tr_b16 v[164:165], v5 offset:2048
  ds_read_b64_tr_b16 v[166:167], v5 offset:3072
  v_mfma_f32_32x32x16_bf16 v[224:239], v[184:187], v[248:251], v[224:239]
  ds_read_b128 v[248:251], v24 offset:4096
  ds_read_b64_tr_b16 v[168:169], v5 offset:4096
  ds_read_b64_tr_b16 v[170:171], v5 offset:5120
  v_mfma_f32_32x32x16_bf16 v[224:239], v[188:191], v[252:255], v[224:239]
  ds_read_b128 v[252:255], v24 offset:6144
  ds_read_b64_tr_b16 v[172:173], v5 offset:6144
  ds_read_b64_tr_b16 v[174:175], v5 offset:7168
  s_waitcnt lgkmcnt(11)
  v_mfma_f32_32x32x16_bf16 v[224:239], v[192:195], v[240:243], v[224:239]
  ds_read_b128 v[240:243], v24 offset:8192
  ds_read_b64_tr_b16 v[176:177], v5 offset:8192
  ds_read_b64_tr_b16 v[178:179], v5 offset:9216
  s_waitcnt lgkmcnt(11)
  v_mfma_f32_32x32x16_bf16 v[224:239], v[196:199], v[244:247], v[224:239]
  ds_read_b128 v[244:247], v24 offset:10240
  ds_read_b64_tr_b16 v[180:181], v5 offset:10240
  ds_read_b64_tr_b16 v[182:183], v5 offset:11264
  s_waitcnt lgkmcnt(11)
  v_mfma_f32_32x32x16_bf16 v[224:239], v[200:203], v[248:251], v[224:239]
  ds_read_b128 v[248:251], v24 offset:12288
  ds_read_b64_tr_b16 v[184:185], v5 offset:12288
  ds_read_b64_tr_b16 v[186:187], v5 offset:13312
  s_waitcnt lgkmcnt(11)
  v_mfma_f32_32x32x16_bf16 v[224:239], v[204:207], v[252:255], v[224:239]
  ds_read_b128 v[252:255], v24 offset:14336
  ds_read_b64_tr_b16 v[188:189], v5 offset:14336
  ds_read_b64_tr_b16 v[190:191], v5 offset:15360
  s_waitcnt lgkmcnt(11)
  v_mfma_f32_32x32x16_bf16 v[224:239], v[208:211], v[240:243], v[224:239]
  s_waitcnt lgkmcnt(0)
  s_barrier
  v_add_u32 v24, 0xfffe0000, v24
  ds_read_b128 v[240:243], v24 offset:0
  v_add_u32 v5, 0x4000, v5
  ds_read_b64_tr_b16 v[192:193], v5 offset:0
  ds_read_b64_tr_b16 v[194:195], v5 offset:1024
  v_mfma_f32_32x32x16_bf16 v[224:239], v[212:215], v[244:247], v[224:239]
  ds_read_b128 v[244:247], v24 offset:2048
  ds_read_b64_tr_b16 v[196:197], v5 offset:2048
  ds_read_b64_tr_b16 v[198:199], v5 offset:3072
  v_mfma_f32_32x32x16_bf16 v[224:239], v[216:219], v[248:251], v[224:239]
  ds_read_b128 v[248:251], v24 offset:4096
  ds_read_b64_tr_b16 v[200:201], v5 offset:4096
  ds_read_b64_tr_b16 v[202:203], v5 offset:5120
  v_mfma_f32_32x32x16_bf16 v[224:239], v[220:223], v[252:255], v[224:239]
  ds_read_b128 v[252:255], v24 offset:6144
  ds_read_b64_tr_b16 v[204:205], v5 offset:6144
  ds_read_b64_tr_b16 v[206:207], v5 offset:7168
  s_waitcnt lgkmcnt(11)
  v_mfma_f32_32x32x16_bf16 v[224:239], v[128:131], v[240:243], v[224:239]
  ds_read_b128 v[240:243], v24 offset:8192
  ds_read_b64_tr_b16 v[208:209], v5 offset:8192
  ds_read_b64_tr_b16 v[210:211], v5 offset:9216
  s_waitcnt lgkmcnt(11)
  v_mfma_f32_32x32x16_bf16 v[224:239], v[132:135], v[244:247], v[224:239]
  ds_read_b128 v[244:247], v24 offset:10240
  ds_read_b64_tr_b16 v[212:213], v5 offset:10240
  ds_read_b64_tr_b16 v[214:215], v5 offset:11264
  s_waitcnt lgkmcnt(11)
  v_mfma_f32_32x32x16_bf16 v[224:239], v[136:139], v[248:251], v[224:239]
  ds_read_b128 v[248:251], v24 offset:12288
  ds_read_b64_tr_b16 v[216:217], v5 offset:12288
  ds_read_b64_tr_b16 v[218:219], v5 offset:13312
  s_waitcnt lgkmcnt(11)
  v_mfma_f32_32x32x16_bf16 v[224:239], v[140:143], v[252:255], v[224:239]
  ds_read_b128 v[252:255], v24 offset:14336
  ds_read_b64_tr_b16 v[220:221], v5 offset:14336
  ds_read_b64_tr_b16 v[222:223], v5 offset:15360
  s_waitcnt lgkmcnt(11)
  v_mfma_f32_32x32x16_bf16 v[224:239], v[144:147], v[240:243], v[224:239]
  s_waitcnt lgkmcnt(0)
  s_barrier
  v_add_u32 v24, 0x1c000, v24
  ds_read_b128 v[240:243], v24 offset:0
  v_add_u32 v5, 0xffff0000, v5
  ds_read_b64_tr_b16 v[128:129], v5 offset:0
  ds_read_b64_tr_b16 v[130:131], v5 offset:1024
  v_mfma_f32_32x32x16_bf16 v[224:239], v[148:151], v[244:247], v[224:239]
  ds_read_b128 v[244:247], v24 offset:2048
  ds_read_b64_tr_b16 v[132:133], v5 offset:2048
  ds_read_b64_tr_b16 v[134:135], v5 offset:3072
  v_mfma_f32_32x32x16_bf16 v[224:239], v[152:155], v[248:251], v[224:239]
  ds_read_b128 v[248:251], v24 offset:4096
  ds_read_b64_tr_b16 v[136:137], v5 offset:4096
  ds_read_b64_tr_b16 v[138:139], v5 offset:5120
  v_mfma_f32_32x32x16_bf16 v[224:239], v[156:159], v[252:255], v[224:239]
  ds_read_b128 v[252:255], v24 offset:6144
  ds_read_b64_tr_b16 v[140:141], v5 offset:6144
  ds_read_b64_tr_b16 v[142:143], v5 offset:7168
  s_waitcnt lgkmcnt(11)
  v_mfma_f32_32x32x16_bf16 v[224:239], v[160:163], v[240:243], v[224:239]
  ds_read_b128 v[240:243], v24 offset:8192
  ds_read_b64_tr_b16 v[144:145], v5 offset:8192
  ds_read_b64_tr_b16 v[146:147], v5 offset:9216
  s_waitcnt lgkmcnt(11)
  v_mfma_f32_32x32x16_bf16 v[224:239], v[164:167], v[244:247], v[224:239]
  ds_read_b128 v[244:247], v24 offset:10240
  ds_read_b64_tr_b16 v[148:149], v5 offset:10240
  ds_read_b64_tr_b16 v[150:151], v5 offset:11264
  s_waitcnt lgkmcnt(11)
  v_mfma_f32_32x32x16_bf16 v[224:239], v[168:171], v[248:251], v[224:239]
  ds_read_b128 v[248:251], v24 offset:12288
  ds_read_b64_tr_b16 v[152:153], v5 offset:12288
  ds_read_b64_tr_b16 v[154:155], v5 offset:13312
  s_waitcnt lgkmcnt(11)
  v_mfma_f32_32x32x16_bf16 v[224:239], v[172:175], v[252:255], v[224:239]
  ds_read_b128 v[252:255], v24 offset:14336
  ds_read_b64_tr_b16 v[156:157], v5 offset:14336
  ds_read_b64_tr_b16 v[158:159], v5 offset:15360
  s_waitcnt lgkmcnt(11)
  v_mfma_f32_32x32x16_bf16 v[224:239], v[176:179], v[240:243], v[224:239]
  s_waitcnt lgkmcnt(0)
  s_barrier
  v_add_u32 v24, 0xfffec000, v24
  ds_read_b128 v[240:243], v24 offset:0
  v_add_u32 v5, 0x14000, v5
  ds_read_b64_tr_b16 v[160:161], v5 offset:0
  ds_read_b64_tr_b16 v[162:163], v5 offset:1024
  v_lshlrev_b32 v20, 8, v30
  v_lshrrev_b32 v21, 5, v0
  v_lshl_add_u32 v20, v21, 4, v20
  v_lshlrev_b32 v19, 5, v30
  v_lshl_add_u32 v19, v21, 4, v19
  v_mfma_f32_32x32x16_bf16 v[224:239], v[180:183], v[244:247], v[224:239]
  ds_read_b128 v[244:247], v24 offset:2048
  ds_read_b64_tr_b16 v[164:165], v5 offset:2048
  ds_read_b64_tr_b16 v[166:167], v5 offset:3072
  v_bfe_u32 v21, v0, 1, 1
  v_xor_b32 v21, s56, v21
  v_lshl_add_u32 v19, v21, 6, v19
  v_mfma_f32_32x32x16_bf16 v[224:239], v[184:187], v[248:251], v[224:239]
  ds_read_b128 v[248:251], v24 offset:4096
  ds_read_b64_tr_b16 v[168:169], v5 offset:4096
  ds_read_b64_tr_b16 v[170:171], v5 offset:5120
  v_mfma_f32_32x32x16_bf16 v[224:239], v[188:191], v[252:255], v[224:239]
  ds_read_b128 v[252:255], v24 offset:6144
  ds_read_b64_tr_b16 v[172:173], v5 offset:6144
  ds_read_b64_tr_b16 v[174:175], v5 offset:7168
  s_waitcnt lgkmcnt(11)
  v_mfma_f32_32x32x16_bf16 v[224:239], v[192:195], v[240:243], v[224:239]
  ds_read_b128 v[240:243], v24 offset:8192
  ds_read_b64_tr_b16 v[176:177], v5 offset:8192
  ds_read_b64_tr_b16 v[178:179], v5 offset:9216
  s_waitcnt lgkmcnt(11)
  v_mfma_f32_32x32x16_bf16 v[224:239], v[196:199], v[244:247], v[224:239]
  ds_read_b128 v[244:247], v24 offset:10240
  ds_read_b64_tr_b16 v[180:181], v5 offset:10240
  ds_read_b64_tr_b16 v[182:183], v5 offset:11264
  s_waitcnt lgkmcnt(11)
  v_mfma_f32_32x32x16_bf16 v[224:239], v[200:203], v[248:251], v[224:239]
  ds_read_b128 v[248:251], v24 offset:12288
  ds_read_b64_tr_b16 v[184:185], v5 offset:12288
  ds_read_b64_tr_b16 v[186:187], v5 offset:13312
  s_waitcnt lgkmcnt(11)
  v_mfma_f32_32x32x16_bf16 v[224:239], v[204:207], v[252:255], v[224:239]
  ds_read_b128 v[252:255], v24 offset:14336
  ds_read_b64_tr_b16 v[188:189], v5 offset:14336
  ds_read_b64_tr_b16 v[190:191], v5 offset:15360
  s_waitcnt lgkmcnt(11)
  v_mfma_f32_32x32x16_bf16 v[224:239], v[208:211], v[240:243], v[224:239]
  s_waitcnt lgkmcnt(0)
  s_barrier
  v_add_u32 v24, 0x4000, v24
  ds_read_b128 v[240:243], v24 offset:0
  v_add_u32 v5, 0x8000, v5
  ds_read_b64_tr_b16 v[192:193], v5 offset:0
  ds_read_b64_tr_b16 v[194:195], v5 offset:1024
  v_mfma_f32_32x32x16_bf16 v[224:239], v[212:215], v[244:247], v[224:239]
  ds_read_b128 v[244:247], v24 offset:2048
  ds_read_b64_tr_b16 v[196:197], v5 offset:2048
  ds_read_b64_tr_b16 v[198:199], v5 offset:3072
  v_mfma_f32_32x32x16_bf16 v[224:239], v[216:219], v[248:251], v[224:239]
  ds_read_b128 v[248:251], v24 offset:4096
  ds_read_b64_tr_b16 v[200:201], v5 offset:4096
  ds_read_b64_tr_b16 v[202:203], v5 offset:5120
  v_mfma_f32_32x32x16_bf16 v[224:239], v[220:223], v[252:255], v[224:239]
  ds_read_b128 v[252:255], v24 offset:6144
  ds_read_b64_tr_b16 v[204:205], v5 offset:6144
  ds_read_b64_tr_b16 v[206:207], v5 offset:7168
  s_waitcnt lgkmcnt(11)
  v_mfma_f32_32x32x16_bf16 v[224:239], v[128:131], v[240:243], v[224:239]
  ds_read_b128 v[240:243], v24 offset:8192
  ds_read_b64_tr_b16 v[208:209], v5 offset:8192
  ds_read_b64_tr_b16 v[210:211], v5 offset:9216
  s_waitcnt lgkmcnt(11)
  v_mfma_f32_32x32x16_bf16 v[224:239], v[132:135], v[244:247], v[224:239]
  ds_read_b128 v[244:247], v24 offset:10240
  ds_read_b64_tr_b16 v[212:213], v5 offset:10240
  ds_read_b64_tr_b16 v[214:215], v5 offset:11264
  s_waitcnt lgkmcnt(11)
  v_mfma_f32_32x32x16_bf16 v[224:239], v[136:139], v[248:251], v[224:239]
  ds_read_b128 v[248:251], v24 offset:12288
  ds_read_b64_tr_b16 v[216:217], v5 offset:12288
  ds_read_b64_tr_b16 v[218:219], v5 offset:13312
  s_waitcnt lgkmcnt(11)
  v_mfma_f32_32x32x16_bf16 v[224:239], v[140:143], v[252:255], v[224:239]
  ds_read_b128 v[252:255], v24 offset:14336
  ds_read_b64_tr_b16 v[220:221], v5 offset:14336
  ds_read_b64_tr_b16 v[222:223], v5 offset:15360
  s_waitcnt lgkmcnt(11)
  v_mfma_f32_32x32x16_bf16 v[224:239], v[144:147], v[240:243], v[224:239]
  s_waitcnt lgkmcnt(0)
  s_barrier
  v_add_u32 v24, 0x4000, v24
  ds_read_b128 v[240:243], v24 offset:0
  v_add_u32 v5, 0xfffe0000, v5
  ds_read_b64_tr_b16 v[128:129], v5 offset:0
  ds_read_b64_tr_b16 v[130:131], v5 offset:1024
  v_mfma_f32_32x32x16_bf16 v[224:239], v[148:151], v[244:247], v[224:239]
  ds_read_b128 v[244:247], v24 offset:2048
  ds_read_b64_tr_b16 v[132:133], v5 offset:2048
  ds_read_b64_tr_b16 v[134:135], v5 offset:3072
  v_mfma_f32_32x32x16_bf16 v[224:239], v[152:155], v[248:251], v[224:239]
  ds_read_b128 v[248:251], v24 offset:4096
  ds_read_b64_tr_b16 v[136:137], v5 offset:4096
  ds_read_b64_tr_b16 v[138:139], v5 offset:5120
  v_mfma_f32_32x32x16_bf16 v[224:239], v[156:159], v[252:255], v[224:239]
  ds_read_b128 v[252:255], v24 offset:6144
  ds_read_b64_tr_b16 v[140:141], v5 offset:6144
  ds_read_b64_tr_b16 v[142:143], v5 offset:7168
  s_waitcnt lgkmcnt(11)
  v_mfma_f32_32x32x16_bf16 v[224:239], v[160:163], v[240:243], v[224:239]
  ds_read_b128 v[240:243], v24 offset:8192
  ds_read_b64_tr_b16 v[144:145], v5 offset:8192
  ds_read_b64_tr_b16 v[146:147], v5 offset:9216
  s_waitcnt lgkmcnt(11)
  v_mfma_f32_32x32x16_bf16 v[224:239], v[164:167], v[244:247], v[224:239]
  ds_read_b128 v[244:247], v24 offset:10240
  ds_read_b64_tr_b16 v[148:149], v5 offset:10240
  ds_read_b64_tr_b16 v[150:151], v5 offset:11264
  s_waitcnt lgkmcnt(11)
  v_mfma_f32_32x32x16_bf16 v[224:239], v[168:171], v[248:251], v[224:239]
  ds_read_b128 v[248:251], v24 offset:12288
  ds_read_b64_tr_b16 v[152:153], v5 offset:12288
  ds_read_b64_tr_b16 v[154:155], v5 offset:13312
  s_waitcnt lgkmcnt(11)
  v_mfma_f32_32x32x16_bf16 v[224:239], v[172:175], v[252:255], v[224:239]
  ds_read_b128 v[252:255], v24 offset:14336
  ds_read_b64_tr_b16 v[156:157], v5 offset:14336
  ds_read_b64_tr_b16 v[158:159], v5 offset:15360
  s_waitcnt lgkmcnt(11)
  v_mfma_f32_32x32x16_bf16 v[224:239], v[176:179], v[240:243], v[224:239]
  s_waitcnt lgkmcnt(0)
  s_barrier
  v_add_u32 v24, 0x4000, v24
  ds_read_b128 v[240:243], v24 offset:0
  v_add_u32 v5, 0x24000, v5
  ds_read_b64_tr_b16 v[160:161], v5 offset:0
  ds_read_b64_tr_b16 v[162:163], v5 offset:1024
  v_mfma_f32_32x32x16_bf16 v[224:239], v[180:183], v[244:247], v[224:239]
  ds_read_b128 v[244:247], v24 offset:2048
  ds_read_b64_tr_b16 v[164:165], v5 offset:2048
  ds_read_b64_tr_b16 v[166:167], v5 offset:3072
  v_mfma_f32_32x32x16_bf16 v[224:239], v[184:187], v[248:251], v[224:239]
  ds_read_b128 v[248:251], v24 offset:4096
  ds_read_b64_tr_b16 v[168:169], v5 offset:4096
  ds_read_b64_tr_b16 v[170:171], v5 offset:5120
  v_mfma_f32_32x32x16_bf16 v[224:239], v[188:191], v[252:255], v[224:239]
  ds_read_b128 v[252:255], v24 offset:6144
  ds_read_b64_tr_b16 v[172:173], v5 offset:6144
  ds_read_b64_tr_b16 v[174:175], v5 offset:7168
  s_waitcnt lgkmcnt(11)
  v_mfma_f32_32x32x16_bf16 v[224:239], v[192:195], v[240:243], v[224:239]
  ds_read_b128 v[240:243], v24 offset:8192
  ds_read_b64_tr_b16 v[176:177], v5 offset:8192
  ds_read_b64_tr_b16 v[178:179], v5 offset:9216
  s_waitcnt lgkmcnt(11)
  v_mfma_f32_32x32x16_bf16 v[224:239], v[196:199], v[244:247], v[224:239]
  ds_read_b128 v[244:247], v24 offset:10240
  ds_read_b64_tr_b16 v[180:181], v5 offset:10240
  ds_read_b64_tr_b16 v[182:183], v5 offset:11264
  s_waitcnt lgkmcnt(11)
  v_mfma_f32_32x32x16_bf16 v[224:239], v[200:203], v[248:251], v[224:239]
  ds_read_b128 v[248:251], v24 offset:12288
  ds_read_b64_tr_b16 v[184:185], v5 offset:12288
  ds_read_b64_tr_b16 v[186:187], v5 offset:13312
  s_waitcnt lgkmcnt(11)
  v_mfma_f32_32x32x16_bf16 v[224:239], v[204:207], v[252:255], v[224:239]
  ds_read_b128 v[252:255], v24 offset:14336
  ds_read_b64_tr_b16 v[188:189], v5 offset:14336
  ds_read_b64_tr_b16 v[190:191], v5 offset:15360
  s_waitcnt lgkmcnt(11)
  v_mfma_f32_32x32x16_bf16 v[224:239], v[208:211], v[240:243], v[224:239]
  s_waitcnt lgkmcnt(0)
  s_barrier
  v_add_u32 v24, 0x8000, v24
  ds_read_b128 v[240:243], v24 offset:0
  v_add_u32 v5, 0xfffe0000, v5
  ds_read_b64_tr_b16 v[192:193], v5 offset:0
  ds_read_b64_tr_b16 v[194:195], v5 offset:1024
  v_mfma_f32_32x32x16_bf16 v[224:239], v[212:215], v[244:247], v[224:239]
  ds_read_b128 v[244:247], v24 offset:2048
  ds_read_b64_tr_b16 v[196:197], v5 offset:2048
  ds_read_b64_tr_b16 v[198:199], v5 offset:3072
  v_mfma_f32_32x32x16_bf16 v[224:239], v[216:219], v[248:251], v[224:239]
  ds_read_b128 v[248:251], v24 offset:4096
  ds_read_b64_tr_b16 v[200:201], v5 offset:4096
  ds_read_b64_tr_b16 v[202:203], v5 offset:5120
  v_mfma_f32_32x32x16_bf16 v[224:239], v[220:223], v[252:255], v[224:239]
  ds_read_b128 v[252:255], v24 offset:6144
  ds_read_b64_tr_b16 v[204:205], v5 offset:6144
  ds_read_b64_tr_b16 v[206:207], v5 offset:7168
  s_waitcnt lgkmcnt(11)
  v_mfma_f32_32x32x16_bf16 v[224:239], v[128:131], v[240:243], v[224:239]
  ds_read_b128 v[240:243], v24 offset:8192
  ds_read_b64_tr_b16 v[208:209], v5 offset:8192
  ds_read_b64_tr_b16 v[210:211], v5 offset:9216
  s_waitcnt lgkmcnt(11)
  v_mfma_f32_32x32x16_bf16 v[224:239], v[132:135], v[244:247], v[224:239]
  ds_read_b128 v[244:247], v24 offset:10240
  ds_read_b64_tr_b16 v[212:213], v5 offset:10240
  ds_read_b64_tr_b16 v[214:215], v5 offset:11264
  s_waitcnt lgkmcnt(11)
  v_mfma_f32_32x32x16_bf16 v[224:239], v[136:139], v[248:251], v[224:239]
  ds_read_b128 v[248:251], v24 offset:12288
  ds_read_b64_tr_b16 v[216:217], v5 offset:12288
  ds_read_b64_tr_b16 v[218:219], v5 offset:13312
  s_waitcnt lgkmcnt(11)
  v_mfma_f32_32x32x16_bf16 v[224:239], v[140:143], v[252:255], v[224:239]
  ds_read_b128 v[252:255], v24 offset:14336
  ds_read_b64_tr_b16 v[220:221], v5 offset:14336
  ds_read_b64_tr_b16 v[222:223], v5 offset:15360
  s_waitcnt lgkmcnt(11)
  v_mfma_f32_32x32x16_bf16 v[224:239], v[144:147], v[240:243], v[224:239]
  s_waitcnt lgkmcnt(0)
  s_barrier
  v_add_u32 v24, 0xfffec000, v24
  ds_read_b128 v[240:243], v24 offset:0
  v_add_u32 v5, 0x14000, v5
  ds_read_b64_tr_b16 v[128:129], v5 offset:0
  ds_read_b64_tr_b16 v[130:131], v5 offset:1024
  v_mfma_f32_32x32x16_bf16 v[224:239], v[148:151], v[244:247], v[224:239]
  ds_read_b128 v[244:247], v24 offset:2048
  ds_read_b64_tr_b16 v[132:133], v5 offset:2048
  ds_read_b64_tr_b16 v[134:135], v5 offset:3072
  v_mfma_f32_32x32x16_bf16 v[224:239], v[152:155], v[248:251], v[224:239]
  ds_read_b128 v[248:251], v24 offset:4096
  ds_read_b64_tr_b16 v[136:137], v5 offset:4096
  ds_read_b64_tr_b16 v[138:139], v5 offset:5120
  v_mfma_f32_32x32x16_bf16 v[224:239], v[156:159], v[252:255], v[224:239]
  ds_read_b128 v[252:255], v24 offset:6144
  ds_read_b64_tr_b16 v[140:141], v5 offset:6144
  ds_read_b64_tr_b16 v[142:143], v5 offset:7168
  s_waitcnt lgkmcnt(11)
  v_mfma_f32_32x32x16_bf16 v[224:239], v[160:163], v[240:243], v[224:239]
  ds_read_b128 v[240:243], v24 offset:8192
  ds_read_b64_tr_b16 v[144:145], v5 offset:8192
  ds_read_b64_tr_b16 v[146:147], v5 offset:9216
  s_waitcnt lgkmcnt(11)
  v_mfma_f32_32x32x16_bf16 v[224:239], v[164:167], v[244:247], v[224:239]
  ds_read_b128 v[244:247], v24 offset:10240
  ds_read_b64_tr_b16 v[148:149], v5 offset:10240
  ds_read_b64_tr_b16 v[150:151], v5 offset:11264
  s_waitcnt lgkmcnt(11)
  v_mfma_f32_32x32x16_bf16 v[224:239], v[168:171], v[248:251], v[224:239]
  ds_read_b128 v[248:251], v24 offset:12288
  ds_read_b64_tr_b16 v[152:153], v5 offset:12288
  ds_read_b64_tr_b16 v[154:155], v5 offset:13312
  s_waitcnt lgkmcnt(11)
  v_mfma_f32_32x32x16_bf16 v[224:239], v[172:175], v[252:255], v[224:239]
  ds_read_b128 v[252:255], v24 offset:14336
  ds_read_b64_tr_b16 v[156:157], v5 offset:14336
  ds_read_b64_tr_b16 v[158:159], v5 offset:15360
  s_waitcnt lgkmcnt(11)
  v_mfma_f32_32x32x16_bf16 v[224:239], v[176:179], v[240:243], v[224:239]
  s_barrier
  v_add_u32 v24, 0x4000, v24
  ds_read_b128 v[240:243], v24 offset:0
  v_add_u32 v5, 0x8000, v5
  ds_read_b64_tr_b16 v[160:161], v5 offset:0
  ds_read_b64_tr_b16 v[162:163], v5 offset:1024
  s_waitcnt lgkmcnt(11)
  v_mfma_f32_32x32x16_bf16 v[224:239], v[180:183], v[244:247], v[224:239]
  ds_read_b128 v[244:247], v24 offset:2048
  ds_read_b64_tr_b16 v[164:165], v5 offset:2048
  ds_read_b64_tr_b16 v[166:167], v5 offset:3072
  s_waitcnt lgkmcnt(11)
  v_mfma_f32_32x32x16_bf16 v[224:239], v[184:187], v[248:251], v[224:239]
  ds_read_b128 v[248:251], v24 offset:4096
  ds_read_b64_tr_b16 v[168:169], v5 offset:4096
  ds_read_b64_tr_b16 v[170:171], v5 offset:5120
  s_waitcnt lgkmcnt(11)
  v_mfma_f32_32x32x16_bf16 v[224:239], v[188:191], v[252:255], v[224:239]
  ds_read_b128 v[252:255], v24 offset:6144
  ds_read_b64_tr_b16 v[172:173], v5 offset:6144
  ds_read_b64_tr_b16 v[174:175], v5 offset:7168
  s_waitcnt lgkmcnt(11)
  v_mfma_f32_32x32x16_bf16 v[32:47], v[192:195], v[240:243], 0
  ds_read_b128 v[240:243], v24 offset:8192
  ds_read_b64_tr_b16 v[176:177], v5 offset:8192
  ds_read_b64_tr_b16 v[178:179], v5 offset:9216
  s_waitcnt lgkmcnt(11)
  v_mfma_f32_32x32x16_bf16 v[32:47], v[196:199], v[244:247], v[32:47]
  ds_read_b128 v[244:247], v24 offset:10240
  ds_read_b64_tr_b16 v[180:181], v5 offset:10240
  ds_read_b64_tr_b16 v[182:183], v5 offset:11264
  v_mul_f32 v80, 0xbfb8aa3b, v224
  v_mul_f32 v81, 0xbfb8aa3b, v225
  v_mul_f32 v82, 0xbfb8aa3b, v226
  v_mul_f32 v83, 0xbfb8aa3b, v227
  v_mul_f32 v84, 0xbfb8aa3b, v228
  s_waitcnt lgkmcnt(11)
  v_mfma_f32_32x32x16_bf16 v[32:47], v[200:203], v[248:251], v[32:47]
  ds_read_b128 v[248:251], v24 offset:12288
  ds_read_b64_tr_b16 v[184:185], v5 offset:12288
  ds_read_b64_tr_b16 v[186:187], v5 offset:13312
  v_mul_f32 v85, 0xbfb8aa3b, v229
  v_mul_f32 v86, 0xbfb8aa3b, v230
  v_mul_f32 v87, 0xbfb8aa3b, v231
  v_mul_f32 v88, 0xbfb8aa3b, v232
  v_mul_f32 v89, 0xbfb8aa3b, v233
  s_waitcnt lgkmcnt(11)
  v_mfma_f32_32x32x16_bf16 v[32:47], v[204:207], v[252:255], v[32:47]
  ds_read_b128 v[252:255], v24 offset:14336
  ds_read_b64_tr_b16 v[188:189], v5 offset:14336
  ds_read_b64_tr_b16 v[190:191], v5 offset:15360
  v_mul_f32 v90, 0xbfb8aa3b, v234
  v_mul_f32 v91, 0xbfb8aa3b, v235
  v_mul_f32 v92, 0xbfb8aa3b, v236
  v_mul_f32 v93, 0xbfb8aa3b, v237
  v_mul_f32 v94, 0xbfb8aa3b, v238
  s_waitcnt lgkmcnt(11)
  v_mfma_f32_32x32x16_bf16 v[32:47], v[208:211], v[240:243], v[32:47]
  s_barrier
  v_add_u32 v24, 0x4000, v24
  ds_read_b128 v[240:243], v24 offset:0
  v_add_u32 v5, 0xfffe0000, v5
  ds_read_b64_tr_b16 v[192:193], v5 offset:0
  ds_read_b64_tr_b16 v[194:195], v5 offset:1024
  v_mul_f32 v95, 0xbfb8aa3b, v239
  v_exp_f32 v80, v80
  v_exp_f32 v81, v81
  s_waitcnt lgkmcnt(11)
  v_mfma_f32_32x32x16_bf16 v[32:47], v[212:215], v[244:247], v[32:47]
  ds_read_b128 v[244:247], v24 offset:2048
  ds_read_b64_tr_b16 v[196:197], v5 offset:2048
  ds_read_b64_tr_b16 v[198:199], v5 offset:3072
  v_exp_f32 v82, v82
  v_exp_f32 v83, v83
  v_exp_f32 v84, v84
  s_waitcnt lgkmcnt(11)
  v_mfma_f32_32x32x16_bf16 v[32:47], v[216:219], v[248:251], v[32:47]
  ds_read_b128 v[248:251], v24 offset:4096
  ds_read_b64_tr_b16 v[200:201], v5 offset:4096
  ds_read_b64_tr_b16 v[202:203], v5 offset:5120
  v_exp_f32 v85, v85
  v_exp_f32 v86, v86
  v_exp_f32 v87, v87
  s_waitcnt lgkmcnt(11)
  v_mfma_f32_32x32x16_bf16 v[32:47], v[220:223], v[252:255], v[32:47]
  ds_read_b128 v[252:255], v24 offset:6144
  ds_read_b64_tr_b16 v[204:205], v5 offset:6144
  ds_read_b64_tr_b16 v[206:207], v5 offset:7168
  v_exp_f32 v88, v88
  v_exp_f32 v89, v89
  v_exp_f32 v90, v90
  s_waitcnt lgkmcnt(11)
  v_mfma_f32_32x32x16_bf16 v[32:47], v[128:131], v[240:243], v[32:47]
  ds_read_b128 v[240:243], v24 offset:8192
  ds_read_b64_tr_b16 v[208:209], v5 offset:8192
  ds_read_b64_tr_b16 v[210:211], v5 offset:9216
  v_exp_f32 v91, v91
  v_exp_f32 v92, v92
  v_exp_f32 v93, v93
  s_waitcnt lgkmcnt(11)
  v_mfma_f32_32x32x16_bf16 v[32:47], v[132:135], v[244:247], v[32:47]
  ds_read_b128 v[244:247], v24 offset:10240
  ds_read_b64_tr_b16 v[212:213], v5 offset:10240
  ds_read_b64_tr_b16 v[214:215], v5 offset:11264
  v_exp_f32 v94, v94
  v_exp_f32 v95, v95
  v_add_f32 v80, 1.0, v80
  s_waitcnt lgkmcnt(11)
  v_mfma_f32_32x32x16_bf16 v[32:47], v[136:139], v[248:251], v[32:47]
  ds_read_b128 v[248:251], v24 offset:12288
  ds_read_b64_tr_b16 v[216:217], v5 offset:12288
  ds_read_b64_tr_b16 v[218:219], v5 offset:13312
  v_add_f32 v81, 1.0, v81
  v_add_f32 v82, 1.0, v82
  v_add_f32 v83, 1.0, v83
  v_add_f32 v84, 1.0, v84
  v_add_f32 v85, 1.0, v85
  s_waitcnt lgkmcnt(11)
  v_mfma_f32_32x32x16_bf16 v[32:47], v[140:143], v[252:255], v[32:47]
  ds_read_b128 v[252:255], v24 offset:14336
  ds_read_b64_tr_b16 v[220:221], v5 offset:14336
  ds_read_b64_tr_b16 v[222:223], v5 offset:15360
  v_add_f32 v86, 1.0, v86
  v_add_f32 v87, 1.0, v87
  v_add_f32 v88, 1.0, v88
  v_add_f32 v89, 1.0, v89
  v_add_f32 v90, 1.0, v90
  s_waitcnt lgkmcnt(11)
  v_mfma_f32_32x32x16_bf16 v[32:47], v[144:147], v[240:243], v[32:47]
  s_barrier
  v_add_u32 v24, 0x14000, v24
  ds_read_b128 v[240:243], v24 offset:0
  v_add_f32 v91, 1.0, v91
  v_add_f32 v92, 1.0, v92
  v_add_f32 v93, 1.0, v93
  v_add_f32 v94, 1.0, v94
  v_add_f32 v95, 1.0, v95
  s_waitcnt lgkmcnt(9)
  v_mfma_f32_32x32x16_bf16 v[32:47], v[148:151], v[244:247], v[32:47]
  ds_read_b128 v[244:247], v24 offset:2048
  v_rcp_f32 v80, v80
  v_rcp_f32 v81, v81
  v_rcp_f32 v82, v82
  s_waitcnt lgkmcnt(7)
  v_mfma_f32_32x32x16_bf16 v[32:47], v[152:155], v[248:251], v[32:47]
  ds_read_b128 v[248:251], v24 offset:4096
  s_lshl_b32 s4, s57, 12
  s_add_u32 s4, s4, 90112
  v_add_u32 v19, s4, v19
  ds_read_b128 v[48:51], v19
  ds_read_b128 v[52:55], v19 offset:32
  v_rcp_f32 v83, v83
  v_rcp_f32 v84, v84
  v_rcp_f32 v85, v85
  s_waitcnt lgkmcnt(7)
  v_mfma_f32_32x32x16_bf16 v[32:47], v[156:159], v[252:255], v[32:47]
  ds_read_b128 v[252:255], v24 offset:6144
  v_rcp_f32 v86, v86
  v_rcp_f32 v87, v87
  v_rcp_f32 v88, v88
  s_waitcnt lgkmcnt(5)
  v_mfma_f32_32x32x16_bf16 v[32:47], v[160:163], v[240:243], v[32:47]
  ds_read_b128 v[240:243], v24 offset:8192
  v_rcp_f32 v89, v89
  v_rcp_f32 v90, v90
  v_rcp_f32 v91, v91
  s_waitcnt lgkmcnt(5)
  v_mfma_f32_32x32x16_bf16 v[32:47], v[164:167], v[244:247], v[32:47]
  ds_read_b128 v[244:247], v24 offset:10240
  v_rcp_f32 v92, v92
  v_rcp_f32 v93, v93
  v_rcp_f32 v94, v94
  s_waitcnt lgkmcnt(5)
  v_mfma_f32_32x32x16_bf16 v[32:47], v[168:171], v[248:251], v[32:47]
  ds_read_b128 v[248:251], v24 offset:12288
  v_rcp_f32 v95, v95
  v_mul_f32 v224, v224, v80
  v_mul_f32 v225, v225, v81
  v_mul_f32 v226, v226, v82
  s_waitcnt lgkmcnt(3)
  v_mfma_f32_32x32x16_bf16 v[32:47], v[172:175], v[252:255], v[32:47]
  ds_read_b128 v[252:255], v24 offset:14336
  v_mul_f32 v227, v227, v83
  v_mul_f32 v228, v228, v84
  v_mul_f32 v229, v229, v85
  v_mul_f32 v230, v230, v86
  v_mul_f32 v231, v231, v87
  s_waitcnt lgkmcnt(3)
  v_mfma_f32_32x32x16_bf16 v[32:47], v[176:179], v[240:243], v[32:47]
  s_barrier
  v_add_u32 v24, 0xffff8000, v24
  ds_read_b128 v[240:243], v24 offset:0
  v_mul_f32 v232, v232, v88
  v_mul_f32 v233, v233, v89
  v_mul_f32 v234, v234, v90
  v_mul_f32 v235, v235, v91
  v_mul_f32 v236, v236, v92
  s_waitcnt lgkmcnt(3)
  v_mfma_f32_32x32x16_bf16 v[32:47], v[180:183], v[244:247], v[32:47]
  ds_read_b128 v[244:247], v24 offset:2048
  v_mul_f32 v237, v237, v93
  v_mul_f32 v238, v238, v94
  v_mul_f32 v239, v239, v95
  v_permlane32_swap_b32 v48, v50
  v_permlane32_swap_b32 v49, v51
  s_waitcnt lgkmcnt(3)
  v_mfma_f32_32x32x16_bf16 v[32:47], v[184:187], v[248:251], v[32:47]
  ds_read_b128 v[248:251], v24 offset:4096
  v_permlane32_swap_b32 v52, v54
  v_permlane32_swap_b32 v53, v55
  v_lshlrev_b32 v64, 16, v48
  v_and_b32 v65, 0xffff0000, v48
  v_lshlrev_b32 v66, 16, v49
  s_waitcnt lgkmcnt(3)
  v_mfma_f32_32x32x16_bf16 v[32:47], v[188:191], v[252:255], v[32:47]
  ds_read_b128 v[252:255], v24 offset:6144
  v_and_b32 v67, 0xffff0000, v49
  v_lshlrev_b32 v68, 16, v50
  v_and_b32 v69, 0xffff0000, v50
  v_lshlrev_b32 v70, 16, v51
  v_and_b32 v71, 0xffff0000, v51
  s_waitcnt lgkmcnt(3)
  v_mfma_f32_32x32x16_bf16 v[32:47], v[192:195], v[240:243], v[32:47]
  ds_read_b128 v[240:243], v24 offset:8192
  v_lshlrev_b32 v72, 16, v52
  v_and_b32 v73, 0xffff0000, v52
  v_lshlrev_b32 v74, 16, v53
  v_and_b32 v75, 0xffff0000, v53
  v_lshlrev_b32 v76, 16, v54
  s_waitcnt lgkmcnt(3)
  v_mfma_f32_32x32x16_bf16 v[32:47], v[196:199], v[244:247], v[32:47]
  ds_read_b128 v[244:247], v24 offset:10240
  v_and_b32 v77, 0xffff0000, v54
  v_lshlrev_b32 v78, 16, v55
  v_and_b32 v79, 0xffff0000, v55
  s_waitcnt lgkmcnt(3)
  v_mfma_f32_32x32x16_bf16 v[32:47], v[200:203], v[248:251], v[32:47]
  ds_read_b128 v[248:251], v24 offset:12288
  s_waitcnt lgkmcnt(3)
  v_mfma_f32_32x32x16_bf16 v[32:47], v[204:207], v[252:255], v[32:47]
  ds_read_b128 v[252:255], v24 offset:14336
  s_waitcnt lgkmcnt(3)
  v_mfma_f32_32x32x16_bf16 v[32:47], v[208:211], v[240:243], v[32:47]
  s_waitcnt lgkmcnt(2)
  v_mfma_f32_32x32x16_bf16 v[32:47], v[212:215], v[244:247], v[32:47]
  s_waitcnt lgkmcnt(1)
  v_mfma_f32_32x32x16_bf16 v[32:47], v[216:219], v[248:251], v[32:47]
  s_waitcnt lgkmcnt(0)
  v_mfma_f32_32x32x16_bf16 v[32:47], v[220:223], v[252:255], v[32:47]
  s_nop 11
  v_fma_f32 v32, v32, v224, v64
  v_fma_f32 v33, v33, v225, v65
  v_fma_f32 v34, v34, v226, v66
  v_fma_f32 v35, v35, v227, v67
  v_fma_f32 v36, v36, v228, v68
  v_fma_f32 v37, v37, v229, v69
  v_fma_f32 v38, v38, v230, v70
  v_fma_f32 v39, v39, v231, v71
  v_cvt_pk_bf16_f32 v48, v32, v33
  v_cvt_pk_bf16_f32 v49, v34, v35
  v_cvt_pk_bf16_f32 v50, v36, v37
  v_cvt_pk_bf16_f32 v51, v38, v39
  s_nop 0
  v_permlane32_swap_b32 v48, v50
  v_permlane32_swap_b32 v49, v51
  buffer_store_dwordx4 v[48:51], v20, s[36:39], s7 offen offset:0
  v_fma_f32 v40, v40, v232, v72
  v_fma_f32 v41, v41, v233, v73
  v_fma_f32 v42, v42, v234, v74
  v_fma_f32 v43, v43, v235, v75
  v_fma_f32 v44, v44, v236, v76
  v_fma_f32 v45, v45, v237, v77
  v_fma_f32 v46, v46, v238, v78
  v_fma_f32 v47, v47, v239, v79
  v_cvt_pk_bf16_f32 v52, v40, v41
  v_cvt_pk_bf16_f32 v53, v42, v43
  v_cvt_pk_bf16_f32 v54, v44, v45
  v_cvt_pk_bf16_f32 v55, v46, v47
  s_nop 0
  v_permlane32_swap_b32 v52, v54
  v_permlane32_swap_b32 v53, v55
  buffer_store_dwordx4 v[52:55], v20, s[36:39], s7 offen offset:32
  s_endpgm
L_typeB1:
  s_and_b32 s5, s52, 1
  s_cmp_eq_u32 s5, 0
  s_cselect_b32 s5, 4, 2
  s_cselect_b32 s4, 12288, 0
  s_lshl_b32 s5, s5, 10
  s_add_u32 s72, s74, s4
  s_add_u32 s5, s5, 2048
  s_add_u32 s74, s74, s5
  s_waitcnt vmcnt(8)
  s_barrier
  ds_read_b128 v[128:131], v64 offset:0
  ds_read_b128 v[132:135], v65 offset:0
  ds_read_b64_tr_b16 v[80:81], v6 offset:49152
  ds_read_b64_tr_b16 v[82:83], v6 offset:49664
  ds_read_b128 v[136:139], v66 offset:0
  ds_read_b128 v[140:143], v67 offset:0
  ds_read_b128 v[144:147], v68 offset:0
  ds_read_b64_tr_b16 v[84:85], v6 offset:51200
  ds_read_b64_tr_b16 v[86:87], v6 offset:51712
  ds_read_b128 v[148:151], v69 offset:0
  ds_read_b128 v[152:155], v70 offset:0
  ds_read_b128 v[156:159], v71 offset:0
  ds_read_b64_tr_b16 v[88:89], v7 offset:49152
  ds_read_b64_tr_b16 v[90:91], v7 offset:49664
  ds_read_b64_tr_b16 v[92:93], v7 offset:51200
  ds_read_b64_tr_b16 v[94:95], v7 offset:51712
  s_waitcnt lgkmcnt(12)
  v_mfma_f32_32x32x16_bf16 v[32:47], v[80:83], v[128:131], 0
  v_mfma_f32_16x16x32_bf16 v[124:127], v[120:123], v[80:83], 0
  s_waitcnt lgkmcnt(4)
  s_barrier
  ds_read_b64_tr_b16 v[80:81], v8 offset:49152
  ds_read_b64_tr_b16 v[82:83], v8 offset:49664
  v_mfma_f32_32x32x16_bf16 v[32:47], v[84:87], v[132:135], v[32:47]
  v_mfma_f32_16x16x32_bf16 v[124:127], v[120:123], v[84:87], v[124:127]
  ds_read_b64_tr_b16 v[84:85], v8 offset:51200
  ds_read_b64_tr_b16 v[86:87], v8 offset:51712
  s_add_u32 m0, s61, 0x0
  s_mul_i32 s89, s100, 256
  s_add_u32 s89, s89, s86
  s_add_u32 s62, s89, 0x0
  buffer_load_dwordx4 v72, s[8:11], s62 offen lds
  s_add_u32 m0, s61, 0x400
  s_add_u32 s62, s89, 0x0
  buffer_load_dwordx4 v73, s[8:11], s62 offen lds
  v_dot2_f32_bf16 v96, v132, s60, 0
  v_dot2_f32_bf16 v98, v132, v132, 0
  v_dot2_f32_bf16 v97, v133, s60, 0
  v_dot2_f32_bf16 v99, v133, v133, 0
  v_dot2_f32_bf16 v96, v134, s60, v96
  v_dot2_f32_bf16 v98, v134, v134, v98
  v_dot2_f32_bf16 v97, v135, s60, v97
  v_dot2_f32_bf16 v99, v135, v135, v99
  v_dot2_f32_bf16 v96, v140, s60, v96
  v_dot2_f32_bf16 v98, v140, v140, v98
  v_dot2_f32_bf16 v97, v141, s60, v97
  v_dot2_f32_bf16 v99, v141, v141, v99
  v_dot2_f32_bf16 v96, v142, s60, v96
  v_dot2_f32_bf16 v98, v142, v142, v98
  v_dot2_f32_bf16 v97, v143, s60, v97
  v_dot2_f32_bf16 v99, v143, v143, v99
  s_waitcnt lgkmcnt(6)
  v_mfma_f32_32x32x16_bf16 v[32:47], v[88:91], v[136:139], v[32:47]
  ds_read_b64_tr_b16 v[88:89], v9 offset:49152
  ds_read_b64_tr_b16 v[90:91], v9 offset:49664
  s_waitcnt lgkmcnt(6)
  v_mfma_f32_32x32x16_bf16 v[32:47], v[92:95], v[140:143], v[32:47]
  ds_read_b64_tr_b16 v[92:93], v9 offset:51200
  ds_read_b64_tr_b16 v[94:95], v9 offset:51712
  s_add_u32 m0, s61, 0x4000
  s_add_u32 s62, s89, 0x10000
  buffer_load_dwordx4 v72, s[8:11], s62 offen lds
  s_add_u32 m0, s61, 0x4400
  s_add_u32 s62, s89, 0x10000
  buffer_load_dwordx4 v73, s[8:11], s62 offen lds
  v_dot2_f32_bf16 v96, v148, s60, v96
  v_dot2_f32_bf16 v98, v148, v148, v98
  v_dot2_f32_bf16 v97, v149, s60, v97
  v_dot2_f32_bf16 v99, v149, v149, v99
  v_dot2_f32_bf16 v96, v150, s60, v96
  v_dot2_f32_bf16 v98, v150, v150, v98
  v_dot2_f32_bf16 v97, v151, s60, v97
  v_dot2_f32_bf16 v99, v151, v151, v99
  v_dot2_f32_bf16 v96, v156, s60, v96
  v_dot2_f32_bf16 v98, v156, v156, v98
  v_dot2_f32_bf16 v97, v157, s60, v97
  v_dot2_f32_bf16 v99, v157, v157, v99
  v_dot2_f32_bf16 v96, v158, s60, v96
  v_dot2_f32_bf16 v98, v158, v158, v98
  v_dot2_f32_bf16 v97, v159, s60, v97
  v_dot2_f32_bf16 v99, v159, v159, v99
  s_waitcnt lgkmcnt(6)
  v_mfma_f32_32x32x16_bf16 v[32:47], v[80:83], v[144:147], v[32:47]
  s_waitcnt vmcnt(6)
  s_barrier
  ds_read_b128 v[160:163], v64 offset:32768
  ds_read_b128 v[164:167], v65 offset:32768
  ds_read_b64_tr_b16 v[80:81], v10 offset:0
  ds_read_b64_tr_b16 v[82:83], v10 offset:512
  s_waitcnt lgkmcnt(8)
  v_mfma_f32_32x32x16_bf16 v[32:47], v[84:87], v[148:151], v[32:47]
  ds_read_b128 v[168:171], v66 offset:32768
  ds_read_b128 v[172:175], v67 offset:32768
  ds_read_b128 v[176:179], v68 offset:32768
  ds_read_b64_tr_b16 v[84:85], v10 offset:2048
  ds_read_b64_tr_b16 v[86:87], v10 offset:2560
  s_add_u32 m0, s61, 0x18000
  s_mul_i32 s89, s100, 458752
  s_add_u32 s89, s89, s63
  s_add_u32 s62, s89, 0x0
  buffer_load_dwordx4 v3, s[16:19], s62 offen lds
  s_add_u32 m0, s61, 0x18400
  s_add_u32 s62, s89, 0x7000
  buffer_load_dwordx4 v3, s[16:19], s62 offen lds
  s_waitcnt lgkmcnt(11)
  v_mfma_f32_32x32x16_bf16 v[32:47], v[88:91], v[152:155], v[32:47]
  ds_read_b128 v[180:183], v69 offset:32768
  ds_read_b128 v[184:187], v70 offset:32768
  ds_read_b128 v[188:191], v71 offset:32768
  ds_read_b64_tr_b16 v[88:89], v11 offset:0
  ds_read_b64_tr_b16 v[90:91], v11 offset:512
  v_lshrrev_b32 v31, 1, v30
  buffer_load_ushort v25, v31, s[32:35], s92 offen
  buffer_load_ushort v23, v31, s[32:35], s93 offen
  buffer_load_ushort v24, v31, s[32:35], s93 offen offset:128
  s_lshl_b32 s3, s52, 11
  s_lshl_b32 s4, s57, 10
  s_add_u32 s3, s3, s4
  s_add_u32 m0, s4, 147456
  s_nop 0
  buffer_load_dwordx4 v1, s[28:31], s3 offen lds
  s_waitcnt lgkmcnt(14)
  v_mfma_f32_32x32x16_bf16 v[32:47], v[92:95], v[156:159], v[32:47]
  ds_read_b64_tr_b16 v[92:93], v11 offset:2048
  ds_read_b64_tr_b16 v[94:95], v11 offset:2560
  s_add_u32 m0, s61, 0x1c000
  s_mul_i32 s89, s101, 458752
  s_add_u32 s89, s89, s63
  s_add_u32 s62, s89, 0x0
  buffer_load_dwordx4 v3, s[16:19], s62 offen lds
  s_add_u32 m0, s61, 0x1c400
  s_add_u32 s62, s89, 0x7000
  buffer_load_dwordx4 v3, s[16:19], s62 offen lds
  s_waitcnt lgkmcnt(12)
  v_mfma_f32_32x32x16_bf16 v[32:47], v[80:83], v[160:163], v[32:47]
  v_mfma_f32_16x16x32_bf16 v[124:127], v[120:123], v[80:83], v[124:127]
  s_waitcnt lgkmcnt(4)
  s_barrier
  ds_read_b64_tr_b16 v[80:81], v12 offset:0
  ds_read_b64_tr_b16 v[82:83], v12 offset:512
  v_mfma_f32_32x32x16_bf16 v[32:47], v[84:87], v[164:167], v[32:47]
  v_mfma_f32_16x16x32_bf16 v[124:127], v[120:123], v[84:87], v[124:127]
  ds_read_b64_tr_b16 v[84:85], v12 offset:2048
  ds_read_b64_tr_b16 v[86:87], v12 offset:2560
  s_add_u32 m0, s61, 0x8000
  s_mul_i32 s89, s101, 256
  s_add_u32 s89, s89, s86
  s_add_u32 s62, s89, 0x0
  buffer_load_dwordx4 v72, s[8:11], s62 offen lds
  s_add_u32 m0, s61, 0x8400
  s_add_u32 s62, s89, 0x0
  buffer_load_dwordx4 v73, s[8:11], s62 offen lds
  v_dot2_f32_bf16 v96, v164, s60, v96
  v_dot2_f32_bf16 v98, v164, v164, v98
  v_dot2_f32_bf16 v97, v165, s60, v97
  v_dot2_f32_bf16 v99, v165, v165, v99
  v_dot2_f32_bf16 v96, v166, s60, v96
  v_dot2_f32_bf16 v98, v166, v166, v98
  v_dot2_f32_bf16 v97, v167, s60, v97
  v_dot2_f32_bf16 v99, v167, v167, v99
  v_dot2_f32_bf16 v96, v172, s60, v96
  v_dot2_f32_bf16 v98, v172, v172, v98
  v_dot2_f32_bf16 v97, v173, s60, v97
  v_dot2_f32_bf16 v99, v173, v173, v99
  v_dot2_f32_bf16 v96, v174, s60, v96
  v_dot2_f32_bf16 v98, v174, v174, v98
  v_dot2_f32_bf16 v97, v175, s60, v97
  v_dot2_f32_bf16 v99, v175, v175, v99
  s_waitcnt lgkmcnt(6)
  v_mfma_f32_32x32x16_bf16 v[32:47], v[88:91], v[168:171], v[32:47]
  ds_read_b64_tr_b16 v[88:89], v13 offset:0
  ds_read_b64_tr_b16 v[90:91], v13 offset:512
  s_waitcnt lgkmcnt(6)
  v_mfma_f32_32x32x16_bf16 v[32:47], v[92:95], v[172:175], v[32:47]
  ds_read_b64_tr_b16 v[92:93], v13 offset:2048
  ds_read_b64_tr_b16 v[94:95], v13 offset:2560
  s_add_u32 m0, s61, 0xc000
  s_add_u32 s62, s89, 0x10000
  buffer_load_dwordx4 v72, s[8:11], s62 offen lds
  s_add_u32 m0, s61, 0xc400
  s_add_u32 s62, s89, 0x10000
  buffer_load_dwordx4 v73, s[8:11], s62 offen lds
  v_dot2_f32_bf16 v96, v180, s60, v96
  v_dot2_f32_bf16 v98, v180, v180, v98
  v_dot2_f32_bf16 v97, v181, s60, v97
  v_dot2_f32_bf16 v99, v181, v181, v99
  v_dot2_f32_bf16 v96, v182, s60, v96
  v_dot2_f32_bf16 v98, v182, v182, v98
  v_dot2_f32_bf16 v97, v183, s60, v97
  v_dot2_f32_bf16 v99, v183, v183, v99
  v_dot2_f32_bf16 v96, v188, s60, v96
  v_dot2_f32_bf16 v98, v188, v188, v98
  v_dot2_f32_bf16 v97, v189, s60, v97
  v_dot2_f32_bf16 v99, v189, v189, v99
  v_dot2_f32_bf16 v96, v190, s60, v96
  v_dot2_f32_bf16 v98, v190, v190, v98
  v_dot2_f32_bf16 v97, v191, s60, v97
  v_dot2_f32_bf16 v99, v191, v191, v99
  s_waitcnt lgkmcnt(6)
  v_mfma_f32_32x32x16_bf16 v[32:47], v[80:83], v[176:179], v[32:47]
  s_waitcnt vmcnt(10)
  s_barrier
  ds_read_b128 v[192:195], v64 offset:0
  ds_read_b128 v[196:199], v65 offset:0
  ds_read_b64_tr_b16 v[80:81], v10 offset:16384
  ds_read_b64_tr_b16 v[82:83], v10 offset:16896
  s_waitcnt lgkmcnt(8)
  v_mfma_f32_32x32x16_bf16 v[32:47], v[84:87], v[180:183], v[32:47]
  ds_read_b128 v[200:203], v66 offset:0
  ds_read_b128 v[204:207], v67 offset:0
  ds_read_b128 v[208:211], v68 offset:0
  ds_read_b64_tr_b16 v[84:85], v10 offset:18432
  ds_read_b64_tr_b16 v[86:87], v10 offset:18944
  s_add_u32 m0, s61, 0x20000
  s_mul_i32 s89, s98, 458752
  s_add_u32 s89, s89, s6
  s_add_u32 s62, s89, 0x0
  buffer_load_dwordx4 v3, s[16:19], s62 offen lds
  s_add_u32 m0, s61, 0x20400
  s_add_u32 s62, s89, 0x7000
  buffer_load_dwordx4 v3, s[16:19], s62 offen lds
  s_waitcnt lgkmcnt(11)
  v_mfma_f32_32x32x16_bf16 v[32:47], v[88:91], v[184:187], v[32:47]
  ds_read_b128 v[212:215], v69 offset:0
  ds_read_b128 v[216:219], v70 offset:0
  ds_read_b128 v[220:223], v71 offset:0
  ds_read_b64_tr_b16 v[88:89], v11 offset:16384
  ds_read_b64_tr_b16 v[90:91], v11 offset:16896
  s_waitcnt lgkmcnt(14)
  v_mfma_f32_32x32x16_bf16 v[32:47], v[92:95], v[188:191], v[32:47]
  ds_read_b64_tr_b16 v[92:93], v11 offset:18432
  ds_read_b64_tr_b16 v[94:95], v11 offset:18944
  s_add_u32 m0, s61, 0x10000
  s_mul_i32 s89, s99, 458752
  s_add_u32 s89, s89, s6
  s_add_u32 s62, s89, 0x0
  buffer_load_dwordx4 v3, s[16:19], s62 offen lds
  s_add_u32 m0, s61, 0x10400
  s_add_u32 s62, s89, 0x7000
  buffer_load_dwordx4 v3, s[16:19], s62 offen lds
  s_waitcnt lgkmcnt(12)
  v_mfma_f32_32x32x16_bf16 v[32:47], v[80:83], v[192:195], v[32:47]
  v_mfma_f32_16x16x32_bf16 v[124:127], v[120:123], v[80:83], v[124:127]
  ds_read_b64_tr_b16 v[80:81], v12 offset:16384
  ds_read_b64_tr_b16 v[82:83], v12 offset:16896
  s_waitcnt lgkmcnt(9)
  v_mfma_f32_32x32x16_bf16 v[32:47], v[84:87], v[196:199], v[32:47]
  v_mfma_f32_16x16x32_bf16 v[124:127], v[120:123], v[84:87], v[124:127]
  ds_read_b64_tr_b16 v[84:85], v12 offset:18432
  ds_read_b64_tr_b16 v[86:87], v12 offset:18944
  v_dot2_f32_bf16 v96, v196, s60, v96
  v_dot2_f32_bf16 v98, v196, v196, v98
  v_dot2_f32_bf16 v97, v197, s60, v97
  v_dot2_f32_bf16 v99, v197, v197, v99
  v_dot2_f32_bf16 v96, v198, s60, v96
  v_dot2_f32_bf16 v98, v198, v198, v98
  v_dot2_f32_bf16 v97, v199, s60, v97
  v_dot2_f32_bf16 v99, v199, v199, v99
  v_dot2_f32_bf16 v96, v204, s60, v96
  v_dot2_f32_bf16 v98, v204, v204, v98
  v_dot2_f32_bf16 v97, v205, s60, v97
  v_dot2_f32_bf16 v99, v205, v205, v99
  v_dot2_f32_bf16 v96, v206, s60, v96
  v_dot2_f32_bf16 v98, v206, v206, v98
  v_dot2_f32_bf16 v97, v207, s60, v97
  v_dot2_f32_bf16 v99, v207, v207, v99
  s_waitcnt lgkmcnt(6)
  v_mfma_f32_32x32x16_bf16 v[32:47], v[88:91], v[200:203], v[32:47]
  ds_read_b64_tr_b16 v[88:89], v13 offset:16384
  ds_read_b64_tr_b16 v[90:91], v13 offset:16896
  s_waitcnt lgkmcnt(6)
  v_mfma_f32_32x32x16_bf16 v[32:47], v[92:95], v[204:207], v[32:47]
  ds_read_b64_tr_b16 v[92:93], v13 offset:18432
  ds_read_b64_tr_b16 v[94:95], v13 offset:18944
  v_dot2_f32_bf16 v96, v212, s60, v96
  v_dot2_f32_bf16 v98, v212, v212, v98
  v_dot2_f32_bf16 v97, v213, s60, v97
  v_dot2_f32_bf16 v99, v213, v213, v99
  v_dot2_f32_bf16 v96, v214, s60, v96
  v_dot2_f32_bf16 v98, v214, v214, v98
  v_dot2_f32_bf16 v97, v215, s60, v97
  v_dot2_f32_bf16 v99, v215, v215, v99
  v_dot2_f32_bf16 v96, v220, s60, v96
  v_dot2_f32_bf16 v98, v220, v220, v98
  v_dot2_f32_bf16 v97, v221, s60, v97
  v_dot2_f32_bf16 v99, v221, v221, v99
  v_dot2_f32_bf16 v96, v222, s60, v96
  v_dot2_f32_bf16 v98, v222, v222, v98
  v_dot2_f32_bf16 v97, v223, s60, v97
  v_dot2_f32_bf16 v99, v223, v223, v99
  s_waitcnt lgkmcnt(6)
  v_mfma_f32_32x32x16_bf16 v[32:47], v[80:83], v[208:211], v[32:47]
  s_waitcnt vmcnt(10)
  s_waitcnt vmcnt(8)
  s_waitcnt vmcnt(6)
  s_waitcnt vmcnt(4)
  s_waitcnt vmcnt(2)
  s_barrier
  ds_read_b128 v[224:227], v64 offset:32768
  ds_read_b128 v[228:231], v65 offset:32768
  ds_read_b64_tr_b16 v[80:81], v10 offset:32768
  ds_read_b64_tr_b16 v[82:83], v10 offset:33280
  s_waitcnt lgkmcnt(8)
  v_mfma_f32_32x32x16_bf16 v[32:47], v[84:87], v[212:215], v[32:47]
  ds_read_b128 v[232:235], v66 offset:32768
  ds_read_b128 v[236:239], v67 offset:32768
  ds_read_b128 v[240:243], v68 offset:32768
  ds_read_b64_tr_b16 v[84:85], v10 offset:34816
  ds_read_b64_tr_b16 v[86:87], v10 offset:35328
  s_add_u32 m0, s61, 0x14000
  s_mul_i32 s89, s100, 458752
  s_add_u32 s89, s89, s6
  s_add_u32 s62, s89, 0x0
  buffer_load_dwordx4 v3, s[16:19], s62 offen lds
  s_add_u32 m0, s61, 0x14400
  s_add_u32 s62, s89, 0x7000
  buffer_load_dwordx4 v3, s[16:19], s62 offen lds
  s_waitcnt lgkmcnt(11)
  v_mfma_f32_32x32x16_bf16 v[32:47], v[88:91], v[216:219], v[32:47]
  ds_read_b128 v[244:247], v69 offset:32768
  ds_read_b128 v[248:251], v70 offset:32768
  ds_read_b128 v[252:255], v71 offset:32768
  ds_read_b64_tr_b16 v[88:89], v11 offset:32768
  ds_read_b64_tr_b16 v[90:91], v11 offset:33280
  s_waitcnt lgkmcnt(14)
  v_mfma_f32_32x32x16_bf16 v[32:47], v[92:95], v[220:223], v[32:47]
  ds_read_b64_tr_b16 v[92:93], v11 offset:34816
  ds_read_b64_tr_b16 v[94:95], v11 offset:35328
  s_add_u32 m0, s61, 0x4000
  s_mul_i32 s89, s101, 458752
  s_add_u32 s89, s89, s6
  s_add_u32 s62, s89, 0x0
  buffer_load_dwordx4 v3, s[16:19], s62 offen lds
  s_add_u32 m0, s61, 0x4400
  s_add_u32 s62, s89, 0x7000
  buffer_load_dwordx4 v3, s[16:19], s62 offen lds
  s_waitcnt lgkmcnt(12)
  v_mfma_f32_32x32x16_bf16 v[32:47], v[80:83], v[224:227], v[32:47]
  v_mfma_f32_16x16x32_bf16 v[124:127], v[120:123], v[80:83], v[124:127]
  ds_read_b64_tr_b16 v[80:81], v12 offset:32768
  ds_read_b64_tr_b16 v[82:83], v12 offset:33280
  s_waitcnt lgkmcnt(9)
  v_mfma_f32_32x32x16_bf16 v[32:47], v[84:87], v[228:231], v[32:47]
  v_mfma_f32_16x16x32_bf16 v[124:127], v[120:123], v[84:87], v[124:127]
  ds_read_b64_tr_b16 v[84:85], v12 offset:34816
  ds_read_b64_tr_b16 v[86:87], v12 offset:35328
  v_dot2_f32_bf16 v96, v228, s60, v96
  v_dot2_f32_bf16 v98, v228, v228, v98
  v_dot2_f32_bf16 v97, v229, s60, v97
  v_dot2_f32_bf16 v99, v229, v229, v99
  v_dot2_f32_bf16 v96, v230, s60, v96
  v_dot2_f32_bf16 v98, v230, v230, v98
  v_dot2_f32_bf16 v97, v231, s60, v97
  v_dot2_f32_bf16 v99, v231, v231, v99
  v_dot2_f32_bf16 v96, v236, s60, v96
  v_dot2_f32_bf16 v98, v236, v236, v98
  v_dot2_f32_bf16 v97, v237, s60, v97
  v_dot2_f32_bf16 v99, v237, v237, v99
  v_dot2_f32_bf16 v96, v238, s60, v96
  v_dot2_f32_bf16 v98, v238, v238, v98
  v_dot2_f32_bf16 v97, v239, s60, v97
  v_dot2_f32_bf16 v99, v239, v239, v99
  s_waitcnt lgkmcnt(6)
  v_mfma_f32_32x32x16_bf16 v[32:47], v[88:91], v[232:235], v[32:47]
  ds_read_b64_tr_b16 v[88:89], v13 offset:32768
  ds_read_b64_tr_b16 v[90:91], v13 offset:33280
  s_waitcnt lgkmcnt(6)
  v_mfma_f32_32x32x16_bf16 v[32:47], v[92:95], v[236:239], v[32:47]
  ds_read_b64_tr_b16 v[92:93], v13 offset:34816
  ds_read_b64_tr_b16 v[94:95], v13 offset:35328
  s_lshl_b32 s3, s49, 2
  s_add_u32 s3, s3, 155136
  v_add_u32 v125, s3, v1
  ds_write_b32 v125, v124
  v_dot2_f32_bf16 v96, v244, s60, v96
  v_dot2_f32_bf16 v98, v244, v244, v98
  v_dot2_f32_bf16 v97, v245, s60, v97
  v_dot2_f32_bf16 v99, v245, v245, v99
  v_dot2_f32_bf16 v96, v246, s60, v96
  v_dot2_f32_bf16 v98, v246, v246, v98
  v_dot2_f32_bf16 v97, v247, s60, v97
  v_dot2_f32_bf16 v99, v247, v247, v99
  v_dot2_f32_bf16 v96, v252, s60, v96
  v_dot2_f32_bf16 v98, v252, v252, v98
  v_dot2_f32_bf16 v97, v253, s60, v97
  v_dot2_f32_bf16 v99, v253, v253, v99
  v_dot2_f32_bf16 v96, v254, s60, v96
  v_dot2_f32_bf16 v98, v254, v254, v98
  v_dot2_f32_bf16 v97, v255, s60, v97
  v_dot2_f32_bf16 v99, v255, v255, v99
  s_nop 1
  v_add_f32 v96, v96, v97
  v_add_f32 v97, v98, v99
  v_lshrrev_b32 v98, 5, v0
  v_lshlrev_b32 v98, 3, v98
  v_lshl_add_u32 v98, v30, 3, v98
  s_lshl_b32 s3, s49, 10
  s_add_u32 s3, s3, 150032
  v_add_u32 v98, s3, v98
  ds_write_b64 v98, v[96:97]
  s_waitcnt lgkmcnt(8)
  v_mfma_f32_32x32x16_bf16 v[32:47], v[80:83], v[240:243], v[32:47]
  ds_read_b64_tr_b16 v[80:81], v10 offset:49152
  ds_read_b64_tr_b16 v[82:83], v10 offset:49664
  s_lshl_b32 s4, s75, 3
  s_add_u32 s4, s4, s48
  s_mul_i32 s5, s4, 896
  s_lshl_b32 s4, s4, 8
  s_mov_b32 m0, 162816
  v_min_u32 v31, 6, v0
  v_lshlrev_b32 v31, 7, v31
  buffer_load_dword v31, s[20:23], s5 offen lds
  v_min_u32 v31, 1, v0
  v_lshlrev_b32 v31, 7, v31
  buffer_load_dword v31, s[24:27], s4 offen lds
  s_waitcnt lgkmcnt(8)
  v_mfma_f32_32x32x16_bf16 v[32:47], v[84:87], v[244:247], v[32:47]
  ds_read_b64_tr_b16 v[84:85], v10 offset:51200
  ds_read_b64_tr_b16 v[86:87], v10 offset:51712
  s_add_u32 m0, s61, 0x0
  s_mul_i32 s89, s99, 458752
  s_add_u32 s89, s89, s2
  s_add_u32 s62, s89, 0x0
  buffer_load_dwordx4 v5, s[16:19], s62 offen lds
  s_waitcnt lgkmcnt(8)
  v_mfma_f32_32x32x16_bf16 v[32:47], v[88:91], v[248:251], v[32:47]
  ds_read_b64_tr_b16 v[88:89], v11 offset:49152
  ds_read_b64_tr_b16 v[90:91], v11 offset:49664
  s_waitcnt lgkmcnt(8)
  v_mfma_f32_32x32x16_bf16 v[32:47], v[92:95], v[252:255], v[32:47]
  ds_read_b64_tr_b16 v[92:93], v11 offset:51200
  ds_read_b64_tr_b16 v[94:95], v11 offset:51712
  s_waitcnt lgkmcnt(6)
  v_mfma_f32_32x32x16_bf16 v[48:63], v[80:83], v[128:131], 0
  v_mfma_f32_16x16x32_bf16 v[124:127], v[120:123], v[80:83], 0
  ds_read_b64_tr_b16 v[80:81], v12 offset:49152
  ds_read_b64_tr_b16 v[82:83], v12 offset:49664
  s_waitcnt lgkmcnt(6)
  v_mfma_f32_32x32x16_bf16 v[48:63], v[84:87], v[132:135], v[48:63]
  v_mfma_f32_16x16x32_bf16 v[124:127], v[120:123], v[84:87], v[124:127]
  ds_read_b64_tr_b16 v[84:85], v12 offset:51200
  ds_read_b64_tr_b16 v[86:87], v12 offset:51712
  s_waitcnt lgkmcnt(6)
  v_mfma_f32_32x32x16_bf16 v[48:63], v[88:91], v[136:139], v[48:63]
  s_waitcnt vmcnt(7)
  s_waitcnt vmcnt(5)
  s_barrier
  ds_read_b64_tr_b16 v[88:89], v13 offset:49152
  ds_read_b64_tr_b16 v[90:91], v13 offset:49664
  s_lshl_b32 s4, s49, 10
  s_add_u32 s4, s4, 150016
  v_lshlrev_b32 v31, 3, v30
  v_add_u32 v31, s4, v31
  ds_read_b128 v[96:99], v31
  ds_read_b128 v[100:103], v31 offset:16
  v_lshlrev_b32 v104, 2, v30
  v_add_u32 v104, 155136, v104
  ds_read_b128 v[104:107], v104
  s_lshl_b32 s4, s49, 7
  s_add_u32 s4, s4, 149504
  v_add_u32 v31, s4, v30
  v_cmp_gt_u32 s[94:95], 32, v0
  s_waitcnt lgkmcnt(9)
  v_mfma_f32_32x32x16_bf16 v[48:63], v[92:95], v[140:143], v[48:63]
  ds_read_b64_tr_b16 v[92:93], v13 offset:51200
  ds_read_b64_tr_b16 v[94:95], v13 offset:51712
  s_add_u32 m0, s61, 0x400
  s_add_u32 s62, s89, 0xe000
  buffer_load_dwordx4 v5, s[16:19], s62 offen lds
  s_waitcnt lgkmcnt(4)
  v_add_f32 v96, v96, v98
  v_add_f32 v97, v97, v99
  s_waitcnt lgkmcnt(2)
  v_add_f32 v104, v104, v105
  v_add_f32 v100, v100, v102
  v_add_f32 v101, v101, v103
  v_add_f32 v106, v106, v107
  v_mfma_f32_32x32x16_bf16 v[48:63], v[80:83], v[144:147], v[48:63]
  ds_read_b64_tr_b16 v[80:81], v6 offset:49152
  ds_read_b64_tr_b16 v[82:83], v6 offset:49664
  v_add_f32 v96, v96, v100
  v_add_f32 v97, v97, v101
  v_add_f32 v104, v104, v106
  v_mul_f32 v96, 0xbb000000, v96
  v_mul_f32 v97, 0x3b000000, v97
  v_cvt_pk_bf16_f32 v105, v104, v104
  v_mfma_f32_32x32x16_bf16 v[48:63], v[84:87], v[148:151], v[48:63]
  ds_read_b64_tr_b16 v[84:85], v6 offset:51200
  ds_read_b64_tr_b16 v[86:87], v6 offset:51712
  v_fma_f32 v97, -v96, v96, v97
  v_max_f32 v97, 0, v97
  v_and_b32 v16, 0xffff0000, v105
  v_cvt_pk_bf16_f32 v97, v97, v97
  v_lshlrev_b32 v97, 16, v97
  v_sub_f32 v104, v104, v16
  v_mfma_f32_32x32x16_bf16 v[48:63], v[88:91], v[152:155], v[48:63]
  ds_read_b64_tr_b16 v[88:89], v7 offset:49152
  ds_read_b64_tr_b16 v[90:91], v7 offset:49664
  v_add_f32 v97, 0x3727c5ac, v97
  v_cvt_pk_bf16_f32 v97, v97, v97
  v_cvt_pk_bf16_f32 v17, v104, v104
  v_lshlrev_b32 v97, 16, v97
  v_sqrt_f32 v97, v97
  s_waitcnt lgkmcnt(6)
  v_mfma_f32_32x32x16_bf16 v[48:63], v[92:95], v[156:159], v[48:63]
  ds_read_b64_tr_b16 v[92:93], v7 offset:51200
  ds_read_b64_tr_b16 v[94:95], v7 offset:51712
  s_add_u32 m0, s61, 0x1c000
  s_mul_i32 s89, s101, 458752
  s_add_u32 s89, s89, s2
  s_add_u32 s62, s89, 0x0
  buffer_load_dwordx4 v5, s[16:19], s62 offen lds
  v_or_b32 v16, v16, v23
  v_cvt_pk_bf16_f32 v97, v97, v96
  v_lshlrev_b32 v14, 16, v97
  v_rcp_f32 v14, v14
  v_cndmask_b32 v18, 0, v97, s[94:95]
  s_waitcnt lgkmcnt(6)
  v_mfma_f32_32x32x16_bf16 v[48:63], v[80:83], v[160:163], v[48:63]
  v_mfma_f32_16x16x32_bf16 v[124:127], v[120:123], v[80:83], v[124:127]
  ds_read_b64_tr_b16 v[80:81], v8 offset:49152
  ds_read_b64_tr_b16 v[82:83], v8 offset:49664
  v_lshrrev_b32 v19, 16, v18
  v_mul_f32 v15, 0x3fb8aa3b, v14
  v_mul_f32 v22, -2.0, v14
  ds_write_b32 v31, v14
  v_mfma_f32_32x32x16_bf16 v[32:47], v[16:19], v[18:21], v[32:47]
  s_waitcnt lgkmcnt(7)
  v_mfma_f32_32x32x16_bf16 v[48:63], v[84:87], v[164:167], v[48:63]
  v_mfma_f32_16x16x32_bf16 v[124:127], v[120:123], v[84:87], v[124:127]
  ds_read_b64_tr_b16 v[84:85], v8 offset:51200
  ds_read_b64_tr_b16 v[86:87], v8 offset:51712
  s_waitcnt lgkmcnt(7)
  v_mfma_f32_32x32x16_bf16 v[48:63], v[88:91], v[168:171], v[48:63]
  ds_read_b64_tr_b16 v[88:89], v9 offset:49152
  ds_read_b64_tr_b16 v[90:91], v9 offset:49664
  s_waitcnt lgkmcnt(7)
  v_mfma_f32_32x32x16_bf16 v[48:63], v[92:95], v[172:175], v[48:63]
  ds_read_b64_tr_b16 v[92:93], v9 offset:51200
  ds_read_b64_tr_b16 v[94:95], v9 offset:51712
  s_waitcnt lgkmcnt(7)
  v_mfma_f32_32x32x16_bf16 v[48:63], v[80:83], v[176:179], v[48:63]
  ds_read_b64_tr_b16 v[80:81], v10 offset:0
  ds_read_b64_tr_b16 v[82:83], v10 offset:512
  v_mul_f32 v96, v32, v15
  v_mul_f32 v97, v33, v15
  v_mul_f32 v98, v34, v15
  v_mul_f32 v99, v35, v15
  v_mul_f32 v100, v36, v15
  v_mul_f32 v101, v37, v15
  s_waitcnt lgkmcnt(6)
  v_mfma_f32_32x32x16_bf16 v[48:63], v[84:87], v[180:183], v[48:63]
  ds_read_b64_tr_b16 v[84:85], v10 offset:2048
  ds_read_b64_tr_b16 v[86:87], v10 offset:2560
  s_add_u32 m0, s61, 0x1c400
  s_add_u32 s62, s89, 0xe000
  buffer_load_dwordx4 v5, s[16:19], s62 offen lds
  v_mul_f32 v102, v38, v15
  v_mul_f32 v103, v39, v15
  v_exp_f32 v96, v96
  v_exp_f32 v97, v97
  s_waitcnt lgkmcnt(6)
  v_mfma_f32_32x32x16_bf16 v[48:63], v[88:91], v[184:187], v[48:63]
  ds_read_b64_tr_b16 v[88:89], v11 offset:0
  ds_read_b64_tr_b16 v[90:91], v11 offset:512
  v_exp_f32 v98, v98
  v_exp_f32 v99, v99
  v_exp_f32 v100, v100
  s_waitcnt lgkmcnt(6)
  v_mfma_f32_32x32x16_bf16 v[48:63], v[92:95], v[188:191], v[48:63]
  ds_read_b64_tr_b16 v[92:93], v11 offset:2048
  ds_read_b64_tr_b16 v[94:95], v11 offset:2560
  s_add_u32 m0, s61, 0x8000
  s_mul_i32 s89, s98, 393216
  s_add_u32 s89, s89, s7
  s_add_u32 s62, s89, 0x0
  buffer_load_dwordx4 v2, s[12:15], s62 offen lds
  v_exp_f32 v101, v101
  v_exp_f32 v102, v102
  v_exp_f32 v103, v103
  s_waitcnt lgkmcnt(6)
  v_mfma_f32_32x32x16_bf16 v[48:63], v[80:83], v[192:195], v[48:63]
  v_mfma_f32_16x16x32_bf16 v[124:127], v[120:123], v[80:83], v[124:127]
  ds_read_b64_tr_b16 v[80:81], v12 offset:0
  ds_read_b64_tr_b16 v[82:83], v12 offset:512
  v_add_f32 v96, 1.0, v96
  v_add_f32 v97, 1.0, v97
  v_add_f32 v98, 1.0, v98
  v_add_f32 v99, 1.0, v99
  v_add_f32 v100, 1.0, v100
  v_add_f32 v101, 1.0, v101
  s_waitcnt lgkmcnt(6)
  v_mfma_f32_32x32x16_bf16 v[48:63], v[84:87], v[196:199], v[48:63]
  v_mfma_f32_16x16x32_bf16 v[124:127], v[120:123], v[84:87], v[124:127]
  ds_read_b64_tr_b16 v[84:85], v12 offset:2048
  ds_read_b64_tr_b16 v[86:87], v12 offset:2560
  s_add_u32 m0, s61, 0x8400
  s_add_u32 s62, s89, 0x6000
  buffer_load_dwordx4 v2, s[12:15], s62 offen lds
  v_add_f32 v102, 1.0, v102
  v_add_f32 v103, 1.0, v103
  v_fma_f32 v96, v96, v96, 1.0
  v_fma_f32 v97, v97, v97, 1.0
  v_fma_f32 v98, v98, v98, 1.0
  v_fma_f32 v99, v99, v99, 1.0
  s_waitcnt lgkmcnt(6)
  v_mfma_f32_32x32x16_bf16 v[48:63], v[88:91], v[200:203], v[48:63]
  s_waitcnt vmcnt(8)
  s_waitcnt vmcnt(4)
  s_barrier
  ds_read_b64_tr_b16 v[88:89], v13 offset:0
  ds_read_b64_tr_b16 v[90:91], v13 offset:512
  v_fma_f32 v100, v100, v100, 1.0
  v_fma_f32 v101, v101, v101, 1.0
  v_fma_f32 v102, v102, v102, 1.0
  v_fma_f32 v103, v103, v103, 1.0
  v_rcp_f32 v96, v96
  s_waitcnt lgkmcnt(6)
  v_mfma_f32_32x32x16_bf16 v[48:63], v[92:95], v[204:207], v[48:63]
  ds_read_b64_tr_b16 v[92:93], v13 offset:2048
  ds_read_b64_tr_b16 v[94:95], v13 offset:2560
  s_add_u32 m0, s61, 0xc000
  s_mul_i32 s89, s99, 393216
  s_add_u32 s89, s89, s7
  s_add_u32 s62, s89, 0x0
  buffer_load_dwordx4 v2, s[12:15], s62 offen lds
  v_rcp_f32 v97, v97
  v_rcp_f32 v98, v98
  v_rcp_f32 v99, v99
  s_waitcnt lgkmcnt(6)
  v_mfma_f32_32x32x16_bf16 v[48:63], v[80:83], v[208:211], v[48:63]
  ds_read_b64_tr_b16 v[80:81], v6 offset:0
  ds_read_b64_tr_b16 v[82:83], v6 offset:512
  v_rcp_f32 v100, v100
  v_rcp_f32 v101, v101
  v_rcp_f32 v102, v102
  s_waitcnt lgkmcnt(6)
  v_mfma_f32_32x32x16_bf16 v[48:63], v[84:87], v[212:215], v[48:63]
  ds_read_b64_tr_b16 v[84:85], v6 offset:2048
  ds_read_b64_tr_b16 v[86:87], v6 offset:2560
  s_add_u32 m0, s61, 0xc400
  s_add_u32 s62, s89, 0x6000
  buffer_load_dwordx4 v2, s[12:15], s62 offen lds
  v_rcp_f32 v103, v103
  v_fma_f32 v96, v96, v22, v14
  v_fma_f32 v97, v97, v22, v14
  v_fma_f32 v98, v98, v22, v14
  v_fma_f32 v99, v99, v22, v14
  s_waitcnt lgkmcnt(6)
  v_mfma_f32_32x32x16_bf16 v[48:63], v[88:91], v[216:219], v[48:63]
  ds_read_b64_tr_b16 v[88:89], v7 offset:0
  ds_read_b64_tr_b16 v[90:91], v7 offset:512
  v_fma_f32 v100, v100, v22, v14
  v_fma_f32 v101, v101, v22, v14
  v_fma_f32 v102, v102, v22, v14
  v_fma_f32 v103, v103, v22, v14
  v_mul_f32 v96, v32, v96
  v_mul_f32 v97, v33, v97
  s_waitcnt lgkmcnt(6)
  v_mfma_f32_32x32x16_bf16 v[48:63], v[92:95], v[220:223], v[48:63]
  ds_read_b64_tr_b16 v[92:93], v7 offset:2048
  ds_read_b64_tr_b16 v[94:95], v7 offset:2560
  v_mul_f32 v98, v34, v98
  v_mul_f32 v99, v35, v99
  v_mul_f32 v100, v36, v100
  v_mul_f32 v101, v37, v101
  v_mul_f32 v102, v38, v102
  v_mul_f32 v103, v39, v103
  s_waitcnt lgkmcnt(6)
  v_mfma_f32_32x32x16_bf16 v[48:63], v[80:83], v[224:227], v[48:63]
  v_mfma_f32_16x16x32_bf16 v[124:127], v[120:123], v[80:83], v[124:127]
  ds_read_b64_tr_b16 v[80:81], v8 offset:0
  ds_read_b64_tr_b16 v[82:83], v8 offset:512
  v_cvt_pk_bf16_f32 v32, v96, v97
  v_cvt_pk_bf16_f32 v33, v98, v99
  v_cvt_pk_bf16_f32 v34, v100, v101
  v_cvt_pk_bf16_f32 v35, v102, v103
  buffer_store_dwordx4 v[32:35], v1, s[44:47], s74 offen offset:0 sc1
  v_mul_f32 v96, v40, v15
  v_mul_f32 v97, v41, v15
  s_waitcnt lgkmcnt(6)
  v_mfma_f32_32x32x16_bf16 v[48:63], v[84:87], v[228:231], v[48:63]
  v_mfma_f32_16x16x32_bf16 v[124:127], v[120:123], v[84:87], v[124:127]
  ds_read_b64_tr_b16 v[84:85], v8 offset:2048
  ds_read_b64_tr_b16 v[86:87], v8 offset:2560
  s_add_u32 m0, s61, 0x18000
  s_mul_i32 s89, s100, 393216
  s_add_u32 s89, s89, s7
  s_add_u32 s62, s89, 0x0
  buffer_load_dwordx4 v2, s[12:15], s62 offen lds
  v_mul_f32 v98, v42, v15
  v_mul_f32 v99, v43, v15
  v_mul_f32 v100, v44, v15
  v_mul_f32 v101, v45, v15
  v_mul_f32 v102, v46, v15
  v_mul_f32 v103, v47, v15
  s_waitcnt lgkmcnt(6)
  v_mfma_f32_32x32x16_bf16 v[48:63], v[88:91], v[232:235], v[48:63]
  ds_read_b64_tr_b16 v[88:89], v9 offset:0
  ds_read_b64_tr_b16 v[90:91], v9 offset:512
  v_exp_f32 v96, v96
  v_exp_f32 v97, v97
  v_exp_f32 v98, v98
  s_waitcnt lgkmcnt(6)
  v_mfma_f32_32x32x16_bf16 v[48:63], v[92:95], v[236:239], v[48:63]
  ds_read_b64_tr_b16 v[92:93], v9 offset:2048
  ds_read_b64_tr_b16 v[94:95], v9 offset:2560
  s_add_u32 m0, s61, 0x18400
  s_add_u32 s62, s89, 0x6000
  buffer_load_dwordx4 v2, s[12:15], s62 offen lds
  s_lshl_b32 s3, s49, 2
  s_add_u32 s3, s3, 157184
  v_add_u32 v125, s3, v1
  ds_write_b32 v125, v124
  v_exp_f32 v99, v99
  v_exp_f32 v100, v100
  v_exp_f32 v101, v101
  s_waitcnt lgkmcnt(7)
  v_mfma_f32_32x32x16_bf16 v[48:63], v[80:83], v[240:243], v[48:63]
  buffer_load_dword v27, v30, s[40:43], 0 offen offset:128 sc1
  v_exp_f32 v102, v102
  v_exp_f32 v103, v103
  v_add_f32 v96, 1.0, v96
  v_add_f32 v97, 1.0, v97
  s_waitcnt lgkmcnt(5)
  v_mfma_f32_32x32x16_bf16 v[48:63], v[84:87], v[244:247], v[48:63]
  s_add_u32 m0, s61, 0x20000
  s_mul_i32 s89, s101, 393216
  s_add_u32 s89, s89, s7
  s_add_u32 s62, s89, 0x0
  buffer_load_dwordx4 v2, s[12:15], s62 offen lds
  v_add_f32 v98, 1.0, v98
  v_add_f32 v99, 1.0, v99
  v_add_f32 v100, 1.0, v100
  v_add_f32 v101, 1.0, v101
  v_add_f32 v102, 1.0, v102
  v_add_f32 v103, 1.0, v103
  s_waitcnt lgkmcnt(3)
  v_mfma_f32_32x32x16_bf16 v[48:63], v[88:91], v[248:251], v[48:63]
  v_fma_f32 v96, v96, v96, 1.0
  v_fma_f32 v97, v97, v97, 1.0
  v_fma_f32 v98, v98, v98, 1.0
  v_fma_f32 v99, v99, v99, 1.0
  v_fma_f32 v100, v100, v100, 1.0
  v_fma_f32 v101, v101, v101, 1.0
  s_waitcnt lgkmcnt(1)
  v_mfma_f32_32x32x16_bf16 v[48:63], v[92:95], v[252:255], v[48:63]
  s_add_u32 m0, s61, 0x20400
  s_add_u32 s62, s89, 0x6000
  buffer_load_dwordx4 v2, s[12:15], s62 offen lds
  v_fma_f32 v102, v102, v102, 1.0
  v_fma_f32 v103, v103, v103, 1.0
  v_rcp_f32 v96, v96
  v_rcp_f32 v97, v97
  s_waitcnt vmcnt(10)
  s_waitcnt vmcnt(8)
  s_waitcnt lgkmcnt(0)
  s_barrier
  v_rcp_f32 v98, v98
  v_rcp_f32 v99, v99
  v_rcp_f32 v100, v100
  v_rcp_f32 v101, v101
  v_rcp_f32 v102, v102
  v_rcp_f32 v103, v103
  v_fma_f32 v96, v96, v22, v14
  v_fma_f32 v97, v97, v22, v14
  v_fma_f32 v98, v98, v22, v14
  v_fma_f32 v99, v99, v22, v14
  v_fma_f32 v100, v100, v22, v14
  v_fma_f32 v101, v101, v22, v14
  v_fma_f32 v102, v102, v22, v14
  v_fma_f32 v103, v103, v22, v14
  s_add_u32 m0, s61, 0x10000
  s_add_u32 s62, s68, 0x10000
  buffer_load_dwordx4 v4, s[20:23], s62 offen lds
  v_mul_f32 v96, v40, v96
  v_mul_f32 v97, v41, v97
  v_mul_f32 v98, v42, v98
  v_mul_f32 v99, v43, v99
  v_mul_f32 v100, v44, v100
  v_mul_f32 v101, v45, v101
  v_mul_f32 v102, v46, v102
  v_mul_f32 v103, v47, v103
  v_cvt_pk_bf16_f32 v40, v96, v97
  v_cvt_pk_bf16_f32 v41, v98, v99
  v_cvt_pk_bf16_f32 v42, v100, v101
  v_cvt_pk_bf16_f32 v43, v102, v103
  buffer_store_dwordx4 v[40:43], v1, s[44:47], s74 offen offset:1024 sc1
  s_add_u32 s74, s74, 4096
  v_lshlrev_b32 v104, 2, v30
  v_add_u32 v104, 157184, v104
  ds_read_b128 v[104:107], v104
  s_waitcnt lgkmcnt(0)
  v_add_f32 v104, v104, v105
  v_add_f32 v106, v106, v107
  v_add_f32 v104, v104, v106
  v_cvt_pk_bf16_f32 v105, v104, v104
  v_and_b32 v16, 0xffff0000, v105
  v_sub_f32 v104, v104, v16
  v_cvt_pk_bf16_f32 v17, v104, v104
  v_or_b32 v16, v16, v24
  s_nop 1
  v_mfma_f32_32x32x16_bf16 v[48:63], v[16:19], v[18:21], v[48:63]
  s_nop 11
  v_mul_f32 v96, v48, v15
  v_mul_f32 v97, v49, v15
  v_mul_f32 v98, v50, v15
  v_mul_f32 v99, v51, v15
  s_add_u32 m0, s61, 0x10400
  s_add_u32 s62, s68, 0x12000
  buffer_load_dwordx4 v4, s[20:23], s62 offen lds
  v_mul_f32 v100, v52, v15
  v_mul_f32 v101, v53, v15
  v_mul_f32 v102, v54, v15
  v_mul_f32 v103, v55, v15
  v_exp_f32 v96, v96
  v_exp_f32 v97, v97
  v_exp_f32 v98, v98
  s_add_u32 m0, s61, 0x14000
  s_add_u32 s62, s68, 0xf0000
  buffer_load_dwordx4 v4, s[20:23], s62 offen lds
  v_exp_f32 v99, v99
  v_exp_f32 v100, v100
  v_exp_f32 v101, v101
  v_exp_f32 v102, v102
  v_exp_f32 v103, v103
  s_add_u32 m0, s61, 0x14400
  s_add_u32 s62, s68, 0xf2000
  buffer_load_dwordx4 v4, s[20:23], s62 offen lds
  v_add_f32 v96, 1.0, v96
  v_add_f32 v97, 1.0, v97
  v_add_f32 v98, 1.0, v98
  v_add_f32 v99, 1.0, v99
  v_add_f32 v100, 1.0, v100
  v_add_f32 v101, 1.0, v101
  v_add_f32 v102, 1.0, v102
  v_add_f32 v103, 1.0, v103
  v_fma_f32 v96, v96, v96, 1.0
  v_fma_f32 v97, v97, v97, 1.0
  s_add_u32 m0, s61, 0x12000
  s_add_u32 s62, s68, 0x80000
  buffer_load_dwordx4 v4, s[20:23], s62 offen lds
  v_fma_f32 v98, v98, v98, 1.0
  v_fma_f32 v99, v99, v99, 1.0
  v_fma_f32 v100, v100, v100, 1.0
  v_fma_f32 v101, v101, v101, 1.0
  v_fma_f32 v102, v102, v102, 1.0
  v_fma_f32 v103, v103, v103, 1.0
  v_rcp_f32 v96, v96
  v_rcp_f32 v97, v97
  s_add_u32 m0, s61, 0x12400
  s_add_u32 s62, s68, 0x82000
  buffer_load_dwordx4 v4, s[20:23], s62 offen lds
  v_rcp_f32 v98, v98
  v_rcp_f32 v99, v99
  v_rcp_f32 v100, v100
  v_rcp_f32 v101, v101
  v_rcp_f32 v102, v102
  v_rcp_f32 v103, v103
  v_fma_f32 v96, v96, v22, v14
  v_fma_f32 v97, v97, v22, v14
  v_fma_f32 v98, v98, v22, v14
  v_fma_f32 v99, v99, v22, v14
  v_fma_f32 v100, v100, v22, v14
  v_fma_f32 v101, v101, v22, v14
  v_fma_f32 v102, v102, v22, v14
  v_fma_f32 v103, v103, v22, v14
  s_add_u32 m0, s61, 0x4000
  s_add_u32 s62, s68, 0x40000
  buffer_load_dwordx4 v4, s[20:23], s62 offen lds
  v_mul_f32 v96, v48, v96
  v_mul_f32 v97, v49, v97
  v_mul_f32 v98, v50, v98
  v_mul_f32 v99, v51, v99
  v_mul_f32 v100, v52, v100
  v_mul_f32 v101, v53, v101
  v_mul_f32 v102, v54, v102
  v_mul_f32 v103, v55, v103
  v_cvt_pk_bf16_f32 v48, v96, v97
  v_cvt_pk_bf16_f32 v49, v98, v99
  s_add_u32 m0, s61, 0x4400
  s_add_u32 s62, s68, 0x42000
  buffer_load_dwordx4 v4, s[20:23], s62 offen lds
  v_cvt_pk_bf16_f32 v50, v100, v101
  v_cvt_pk_bf16_f32 v51, v102, v103
  buffer_store_dwordx4 v[48:51], v1, s[44:47], s74 offen offset:0 sc1
  v_mul_f32 v96, v56, v15
  v_mul_f32 v97, v57, v15
  v_mul_f32 v98, v58, v15
  v_mul_f32 v99, v59, v15
  v_mul_f32 v100, v60, v15
  v_mul_f32 v101, v61, v15
  s_waitcnt vmcnt(12)
  v_cmp_ne_u32 vcc, 0, v27
  s_nop 0
  s_andn2_b32 s3, 0xffffffff, vcc_lo
  s_cbranch_scc1 L15
L16:
  s_waitcnt vmcnt(8)
  buffer_store_dword v10, v28, s[44:47], s65 offen offset:0 sc1
  s_add_u32 m0, s61, 0x2000
  s_add_u32 s62, s68, 0xfffd0000
  buffer_load_dwordx4 v4, s[20:23], s62 offen lds
  v_mul_f32 v102, v62, v15
  v_mul_f32 v103, v63, v15
  v_exp_f32 v96, v96
  v_exp_f32 v97, v97
  v_exp_f32 v98, v98
  v_exp_f32 v99, v99
  s_add_u32 m0, s61, 0x2400
  s_add_u32 s62, s68, 0xfffd2000
  buffer_load_dwordx4 v4, s[20:23], s62 offen lds
  v_exp_f32 v100, v100
  v_exp_f32 v101, v101
  v_exp_f32 v102, v102
  v_exp_f32 v103, v103
  v_add_f32 v96, 1.0, v96
  v_add_f32 v97, 1.0, v97
  ds_read_b64_tr_b16 v[80:81], v6 offset:16384
  ds_read_b64_tr_b16 v[82:83], v6 offset:16896
  ds_read_b64_tr_b16 v[84:85], v6 offset:18432
  ds_read_b64_tr_b16 v[86:87], v6 offset:18944
  ds_read_b64_tr_b16 v[88:89], v7 offset:16384
  ds_read_b64_tr_b16 v[90:91], v7 offset:16896
  ds_read_b64_tr_b16 v[92:93], v7 offset:18432
  ds_read_b64_tr_b16 v[94:95], v7 offset:18944
  s_waitcnt lgkmcnt(6)
  v_mfma_f32_32x32x16_bf16 v[32:47], v[80:83], v[128:131], 0
  v_mfma_f32_16x16x32_bf16 v[124:127], v[120:123], v[80:83], 0
  ds_read_b64_tr_b16 v[80:81], v8 offset:16384
  ds_read_b64_tr_b16 v[82:83], v8 offset:16896
  v_add_f32 v98, 1.0, v98
  v_add_f32 v99, 1.0, v99
  v_add_f32 v100, 1.0, v100
  s_waitcnt lgkmcnt(6)
  v_mfma_f32_32x32x16_bf16 v[32:47], v[84:87], v[132:135], v[32:47]
  v_mfma_f32_16x16x32_bf16 v[124:127], v[120:123], v[84:87], v[124:127]
  ds_read_b64_tr_b16 v[84:85], v8 offset:18432
  ds_read_b64_tr_b16 v[86:87], v8 offset:18944
  v_add_f32 v101, 1.0, v101
  v_add_f32 v102, 1.0, v102
  v_add_f32 v103, 1.0, v103
  s_waitcnt lgkmcnt(6)
  v_mfma_f32_32x32x16_bf16 v[32:47], v[88:91], v[136:139], v[32:47]
  s_waitcnt vmcnt(10)
  s_barrier
  ds_read_b64_tr_b16 v[88:89], v9 offset:16384
  ds_read_b64_tr_b16 v[90:91], v9 offset:16896
  v_fma_f32 v96, v96, v96, 1.0
  v_fma_f32 v97, v97, v97, 1.0
  v_fma_f32 v98, v98, v98, 1.0
  s_waitcnt lgkmcnt(6)
  v_mfma_f32_32x32x16_bf16 v[32:47], v[92:95], v[140:143], v[32:47]
  ds_read_b64_tr_b16 v[92:93], v9 offset:18432
  ds_read_b64_tr_b16 v[94:95], v9 offset:18944
  s_add_u32 m0, s61, 0x0
  s_add_u32 s62, s68, 0x120000
  buffer_load_dwordx4 v4, s[20:23], s62 offen lds
  s_add_u32 m0, s61, 0x400
  s_add_u32 s62, s68, 0x122000
  buffer_load_dwordx4 v4, s[20:23], s62 offen lds
  v_fma_f32 v99, v99, v99, 1.0
  v_fma_f32 v100, v100, v100, 1.0
  v_fma_f32 v101, v101, v101, 1.0
  s_waitcnt lgkmcnt(6)
  v_mfma_f32_32x32x16_bf16 v[32:47], v[80:83], v[144:147], v[32:47]
  ds_read_b64_tr_b16 v[80:81], v6 offset:32768
  ds_read_b64_tr_b16 v[82:83], v6 offset:33280
  v_fma_f32 v102, v102, v102, 1.0
  v_fma_f32 v103, v103, v103, 1.0
  v_rcp_f32 v96, v96
  s_waitcnt lgkmcnt(6)
  v_mfma_f32_32x32x16_bf16 v[32:47], v[84:87], v[148:151], v[32:47]
  ds_read_b64_tr_b16 v[84:85], v6 offset:34816
  ds_read_b64_tr_b16 v[86:87], v6 offset:35328
  s_add_u32 m0, s61, 0x1c000
  s_add_u32 s62, s68, 0x20000
  buffer_load_dwordx4 v4, s[20:23], s62 offen lds
  v_rcp_f32 v97, v97
  v_rcp_f32 v98, v98
  s_waitcnt lgkmcnt(6)
  v_mfma_f32_32x32x16_bf16 v[32:47], v[88:91], v[152:155], v[32:47]
  ds_read_b64_tr_b16 v[88:89], v7 offset:32768
  ds_read_b64_tr_b16 v[90:91], v7 offset:33280
  v_rcp_f32 v99, v99
  v_rcp_f32 v100, v100
  s_waitcnt lgkmcnt(6)
  v_mfma_f32_32x32x16_bf16 v[32:47], v[92:95], v[156:159], v[32:47]
  ds_read_b64_tr_b16 v[92:93], v7 offset:34816
  ds_read_b64_tr_b16 v[94:95], v7 offset:35328
  v_bfe_u32 v5, v0, 2, 3
  v_mul_u32_u24 v5, 640, v5
  v_and_b32 v24, 3, v0
  v_lshl_add_u32 v5, v24, 2, v5
  v_rcp_f32 v101, v101
  v_rcp_f32 v102, v102
  s_waitcnt lgkmcnt(6)
  v_mfma_f32_32x32x16_bf16 v[32:47], v[80:83], v[160:163], v[32:47]
  v_mfma_f32_16x16x32_bf16 v[124:127], v[120:123], v[80:83], v[124:127]
  ds_read_b64_tr_b16 v[80:81], v8 offset:32768
  ds_read_b64_tr_b16 v[82:83], v8 offset:33280
  v_rcp_f32 v103, v103
  v_fma_f32 v96, v96, v22, v14
  s_waitcnt lgkmcnt(6)
  v_mfma_f32_32x32x16_bf16 v[32:47], v[84:87], v[164:167], v[32:47]
  v_mfma_f32_16x16x32_bf16 v[124:127], v[120:123], v[84:87], v[124:127]
  ds_read_b64_tr_b16 v[84:85], v8 offset:34816
  ds_read_b64_tr_b16 v[86:87], v8 offset:35328
  s_add_u32 m0, s61, 0x1c400
  s_add_u32 s62, s68, 0x22000
  buffer_load_dwordx4 v4, s[20:23], s62 offen lds
  v_fma_f32 v97, v97, v22, v14
  v_fma_f32 v98, v98, v22, v14
  v_fma_f32 v99, v99, v22, v14
  s_waitcnt lgkmcnt(6)
  v_mfma_f32_32x32x16_bf16 v[32:47], v[88:91], v[168:171], v[32:47]
  ds_read_b64_tr_b16 v[88:89], v9 offset:32768
  ds_read_b64_tr_b16 v[90:91], v9 offset:33280
  v_fma_f32 v100, v100, v22, v14
  v_fma_f32 v101, v101, v22, v14
  v_fma_f32 v102, v102, v22, v14
  s_waitcnt lgkmcnt(6)
  v_mfma_f32_32x32x16_bf16 v[32:47], v[92:95], v[172:175], v[32:47]
  ds_read_b64_tr_b16 v[92:93], v9 offset:34816
  ds_read_b64_tr_b16 v[94:95], v9 offset:35328
  v_fma_f32 v103, v103, v22, v14
  v_mul_f32 v96, v56, v96
  v_mul_f32 v97, v57, v97
  s_waitcnt lgkmcnt(6)
  v_mfma_f32_32x32x16_bf16 v[32:47], v[80:83], v[176:179], v[32:47]
  ds_read_b64_tr_b16 v[80:81], v10 offset:16384
  ds_read_b64_tr_b16 v[82:83], v10 offset:16896
  v_mul_f32 v98, v58, v98
  v_mul_f32 v99, v59, v99
  v_mul_f32 v100, v60, v100
  s_waitcnt lgkmcnt(6)
  v_mfma_f32_32x32x16_bf16 v[32:47], v[84:87], v[180:183], v[32:47]
  ds_read_b64_tr_b16 v[84:85], v10 offset:18432
  ds_read_b64_tr_b16 v[86:87], v10 offset:18944
  v_mul_f32 v101, v61, v101
  v_mul_f32 v102, v62, v102
  v_mul_f32 v103, v63, v103
  s_waitcnt lgkmcnt(6)
  v_mfma_f32_32x32x16_bf16 v[32:47], v[88:91], v[184:187], v[32:47]
  ds_read_b64_tr_b16 v[88:89], v11 offset:16384
  ds_read_b64_tr_b16 v[90:91], v11 offset:16896
  v_cvt_pk_bf16_f32 v56, v96, v97
  v_cvt_pk_bf16_f32 v57, v98, v99
  v_cvt_pk_bf16_f32 v58, v100, v101
  s_waitcnt lgkmcnt(6)
  v_mfma_f32_32x32x16_bf16 v[32:47], v[92:95], v[188:191], v[32:47]
  ds_read_b64_tr_b16 v[92:93], v11 offset:18432
  ds_read_b64_tr_b16 v[94:95], v11 offset:18944
  v_cvt_pk_bf16_f32 v59, v102, v103
  buffer_store_dwordx4 v[56:59], v1, s[44:47], s74 offen offset:1024 sc1
  s_waitcnt lgkmcnt(6)
  v_mfma_f32_32x32x16_bf16 v[32:47], v[80:83], v[192:195], v[32:47]
  v_mfma_f32_16x16x32_bf16 v[124:127], v[120:123], v[80:83], v[124:127]
  ds_read_b64_tr_b16 v[80:81], v12 offset:16384
  ds_read_b64_tr_b16 v[82:83], v12 offset:16896
  s_waitcnt lgkmcnt(6)
  v_mfma_f32_32x32x16_bf16 v[32:47], v[84:87], v[196:199], v[32:47]
  v_mfma_f32_16x16x32_bf16 v[124:127], v[120:123], v[84:87], v[124:127]
  ds_read_b64_tr_b16 v[84:85], v12 offset:18432
  ds_read_b64_tr_b16 v[86:87], v12 offset:18944
  s_waitcnt lgkmcnt(6)
  v_mfma_f32_32x32x16_bf16 v[32:47], v[88:91], v[200:203], v[32:47]
  s_waitcnt vmcnt(11)
  s_waitcnt vmcnt(5)
  s_barrier
  ds_read_b64_tr_b16 v[88:89], v13 offset:16384
  ds_read_b64_tr_b16 v[90:91], v13 offset:16896
  s_waitcnt lgkmcnt(6)
  v_mfma_f32_32x32x16_bf16 v[32:47], v[92:95], v[204:207], v[32:47]
  ds_read_b64_tr_b16 v[92:93], v13 offset:18432
  ds_read_b64_tr_b16 v[94:95], v13 offset:18944
  s_add_u32 m0, s61, 0x8000
  s_add_u32 s62, s68, 0x100000
  buffer_load_dwordx4 v4, s[20:23], s62 offen lds
  s_add_u32 m0, s61, 0x8400
  s_add_u32 s62, s68, 0x102000
  buffer_load_dwordx4 v4, s[20:23], s62 offen lds
  s_waitcnt lgkmcnt(6)
  v_mfma_f32_32x32x16_bf16 v[32:47], v[80:83], v[208:211], v[32:47]
  ds_read_b64_tr_b16 v[80:81], v10 offset:49152
  ds_read_b64_tr_b16 v[82:83], v10 offset:49664
  s_waitcnt lgkmcnt(6)
  v_mfma_f32_32x32x16_bf16 v[32:47], v[84:87], v[212:215], v[32:47]
  ds_read_b64_tr_b16 v[84:85], v10 offset:51200
  ds_read_b64_tr_b16 v[86:87], v10 offset:51712
  s_add_u32 m0, s61, 0xc000
  s_add_u32 s62, s68, 0x50000
  buffer_load_dwordx4 v4, s[20:23], s62 offen lds
  s_waitcnt lgkmcnt(6)
  v_mfma_f32_32x32x16_bf16 v[32:47], v[88:91], v[216:219], v[32:47]
  ds_read_b64_tr_b16 v[88:89], v11 offset:49152
  ds_read_b64_tr_b16 v[90:91], v11 offset:49664
  s_waitcnt lgkmcnt(6)
  v_mfma_f32_32x32x16_bf16 v[32:47], v[92:95], v[220:223], v[32:47]
  ds_read_b64_tr_b16 v[92:93], v11 offset:51200
  ds_read_b64_tr_b16 v[94:95], v11 offset:51712
  s_add_u32 m0, s61, 0xc400
  s_add_u32 s62, s68, 0x52000
  buffer_load_dwordx4 v4, s[20:23], s62 offen lds
  s_waitcnt lgkmcnt(6)
  v_mfma_f32_32x32x16_bf16 v[32:47], v[80:83], v[224:227], v[32:47]
  v_mfma_f32_16x16x32_bf16 v[124:127], v[120:123], v[80:83], v[124:127]
  ds_read_b64_tr_b16 v[80:81], v12 offset:49152
  ds_read_b64_tr_b16 v[82:83], v12 offset:49664
  s_waitcnt lgkmcnt(6)
  v_mfma_f32_32x32x16_bf16 v[32:47], v[84:87], v[228:231], v[32:47]
  v_mfma_f32_16x16x32_bf16 v[124:127], v[120:123], v[84:87], v[124:127]
  ds_read_b64_tr_b16 v[84:85], v12 offset:51200
  ds_read_b64_tr_b16 v[86:87], v12 offset:51712
  s_add_u32 m0, s61, 0x10000
  s_add_u32 s62, s68, 0x130000
  buffer_load_dwordx4 v4, s[20:23], s62 offen lds
  s_waitcnt vmcnt(5)
  buffer_store_dword v10, v28, s[44:47], s65 offen offset:128 sc1
  s_waitcnt lgkmcnt(6)
  v_mfma_f32_32x32x16_bf16 v[32:47], v[88:91], v[232:235], v[32:47]
  ds_read_b64_tr_b16 v[88:89], v13 offset:49152
  ds_read_b64_tr_b16 v[90:91], v13 offset:49664
  s_waitcnt lgkmcnt(6)
  v_mfma_f32_32x32x16_bf16 v[32:47], v[92:95], v[236:239], v[32:47]
  ds_read_b64_tr_b16 v[92:93], v13 offset:51200
  ds_read_b64_tr_b16 v[94:95], v13 offset:51712
  s_add_u32 m0, s61, 0x10400
  s_add_u32 s62, s68, 0x132000
  buffer_load_dwordx4 v4, s[20:23], s62 offen lds
  s_lshl_b32 s3, s49, 2
  s_add_u32 s3, s3, 157184
  v_add_u32 v125, s3, v1
  ds_write_b32 v125, v124
  buffer_load_dword v27, v5, s[44:47], s67 offen offset:0 sc1
  s_waitcnt lgkmcnt(7)
  v_mfma_f32_32x32x16_bf16 v[32:47], v[80:83], v[240:243], v[32:47]
  s_waitcnt lgkmcnt(5)
  v_mfma_f32_32x32x16_bf16 v[32:47], v[84:87], v[244:247], v[32:47]
  s_waitcnt lgkmcnt(3)
  v_mfma_f32_32x32x16_bf16 v[32:47], v[88:91], v[248:251], v[32:47]
  s_waitcnt lgkmcnt(1)
  v_mfma_f32_32x32x16_bf16 v[32:47], v[92:95], v[252:255], v[32:47]
  s_waitcnt lgkmcnt(0)
  s_barrier
  s_lshl_b32 s91, s54, 16
  s_lshl_b32 s4, s49, 14
  s_add_u32 s91, s91, s4
  s_lshl_b32 s4, s55, 7
  s_add_u32 s91, s91, s4
  s_waitcnt vmcnt(0)
  v_cmp_ne_u32 vcc, 0, v27
  s_nop 0
  s_andn2_b32 s3, 0xffffffff, vcc_lo
  s_cbranch_scc1 L18
L19:
  s_add_u32 m0, s61, 0x18000
  s_add_u32 s62, s0, 0x1000
  buffer_load_dwordx4 v1, s[44:47], s62 offen sc1 lds
  v_lshlrev_b32 v108, 2, v30
  v_add_u32 v108, 157184, v108
  ds_read_b128 v[108:111], v108
  s_waitcnt lgkmcnt(0)
  v_add_f32 v108, v108, v109
  v_add_f32 v110, v110, v111
  s_add_u32 m0, s61, 0x18400
  s_add_u32 s62, s0, 0x25000
  buffer_load_dwordx4 v1, s[44:47], s62 offen sc1 lds
  v_add_f32 v108, v108, v110
  v_cvt_pk_bf16_f32 v109, v108, v108
  v_and_b32 v16, 0xffff0000, v109
  v_sub_f32 v108, v108, v16
  s_add_u32 m0, s61, 0x16000
  s_add_u32 s62, s0, 0xffffa000
  buffer_load_dwordx4 v1, s[44:47], s62 offen sc1 lds
  v_cvt_pk_bf16_f32 v17, v108, v108
  s_nop 1
  v_mfma_f32_32x32x16_bf16 v[32:47], v[16:19], v[18:21], v[32:47]
  v_bfe_u32 v25, v0, 2, 2
  v_lshrrev_b32 v26, 5, v0
  s_add_u32 m0, s61, 0x16400
  s_add_u32 s62, s0, 0x1e000
  buffer_load_dwordx4 v1, s[44:47], s62 offen sc1 lds
  v_lshl_add_u32 v25, v26, 2, v25
  v_lshlrev_b32 v25, 5, v25
  v_bfe_u32 v26, v0, 4, 1
  v_lshl_add_u32 v25, v26, 4, v25
  s_add_u32 m0, s61, 0x20000
  s_add_u32 s62, s0, 0xf000
  buffer_load_dwordx4 v1, s[44:47], s62 offen sc1 lds
  v_bfe_u32 v26, v0, 1, 1
  v_lshl_add_u32 v25, v26, 3, v25
  s_lshl_b32 s4, s50, 10
  s_add_u32 s4, s4, 147456
  v_add_u32 v25, s4, v25
  ds_read_b64_tr_b16 v[112:113], v25 offset:0
  s_add_u32 m0, s61, 0x20400
  s_add_u32 s62, s0, 0x33000
  buffer_load_dwordx4 v1, s[44:47], s62 offen sc1 lds
  ds_read_b64_tr_b16 v[114:115], v25 offset:256
  ds_read_b64_tr_b16 v[116:117], v25 offset:512
  ds_read_b64_tr_b16 v[118:119], v25 offset:768
  v_bfe_u32 v26, v0, 2, 1
  v_mul_u32_u24 v26, 0x8000, v26
  v_lshl_or_b32 v26, v26, 16, v26
  s_add_u32 m0, s61, 0x1e000
  s_add_u32 s62, s0, 0x8000
  buffer_load_dwordx4 v1, s[44:47], s62 offen sc1 lds
  s_waitcnt lgkmcnt(3)
  v_xor_b32 v112, v26, v112
  v_xor_b32 v113, v26, v113
  s_waitcnt lgkmcnt(2)
  v_xor_b32 v114, v26, v114
  v_xor_b32 v115, v26, v115
  s_add_u32 m0, s61, 0x1e400
  s_add_u32 s62, s0, 0x2c000
  buffer_load_dwordx4 v1, s[44:47], s62 offen sc1 lds
  s_waitcnt lgkmcnt(1)
  v_xor_b32 v116, v26, v116
  v_xor_b32 v117, v26, v117
  s_waitcnt lgkmcnt(0)
  v_xor_b32 v118, v26, v118
  v_xor_b32 v119, v26, v119
  s_add_u32 m0, s61, 0x14000
  s_add_u32 s62, s0, 0x4000
  buffer_load_dwordx4 v1, s[44:47], s62 offen sc1 lds
  v_cvt_pk_bf16_f32 v120, v32, v33
  v_cvt_pk_bf16_f32 v121, v34, v35
  v_cvt_pk_bf16_f32 v122, v36, v37
  v_cvt_pk_bf16_f32 v123, v38, v39
  s_add_u32 m0, s61, 0x14400
  s_add_u32 s62, s0, 0x28000
  buffer_load_dwordx4 v1, s[44:47], s62 offen sc1 lds
  v_cvt_pk_bf16_f32 v124, v40, v41
  v_cvt_pk_bf16_f32 v125, v42, v43
  v_cvt_pk_bf16_f32 v126, v44, v45
  v_cvt_pk_bf16_f32 v127, v46, v47
  s_add_u32 m0, s61, 0x12000
  s_add_u32 s62, s0, 0xffffd000
  buffer_load_dwordx4 v1, s[44:47], s62 offen sc1 lds
  v_mfma_f32_32x32x16_bf16 v[96:111], v[112:115], v[120:123], 0
  v_mfma_f32_32x32x16_bf16 v[48:63], v[116:119], v[124:127], 0
  s_nop 10
  v_max3_f32 v26, v96, v97, v98
  v_max3_f32 v31, v99, v100, v101
  s_add_u32 m0, s61, 0x12400
  s_add_u32 s62, s0, 0x21000
  buffer_load_dwordx4 v1, s[44:47], s62 offen sc1 lds
  v_min_u32 v21, 15, v0
  v_lshlrev_b32 v21, 7, v21
  buffer_load_dword v9, v21, s[44:47], s71 offen offset:0 sc1
  v_max3_f32 v26, v26, v102, v103
  v_max3_f32 v31, v31, v104, v105
  v_max3_f32 v26, v26, v106, v107
  s_add_u32 m0, s61, 0x4000
  s_add_u32 s62, s0, 0x12000
  buffer_load_dwordx4 v1, s[44:47], s62 offen sc1 lds
  v_max3_f32 v31, v31, v108, v109
  v_max3_f32 v26, v26, v110, v111
  v_max_f32 v26, v26, v31
  v_mul_f32_e64 v26, -v26, v15
  s_add_u32 m0, s61, 0x4400
  s_add_u32 s62, s0, 0x36000
  buffer_load_dwordx4 v1, s[44:47], s62 offen sc1 lds
  v_fma_f32 v96, v96, v15, v26
  v_fma_f32 v97, v97, v15, v26
  v_fma_f32 v98, v98, v15, v26
  v_fma_f32 v99, v99, v15, v26
  s_add_u32 m0, s61, 0x2000
  s_add_u32 s62, s0, 0xb000
  buffer_load_dwordx4 v1, s[44:47], s62 offen sc1 lds
  v_fma_f32 v100, v100, v15, v26
  v_fma_f32 v101, v101, v15, v26
  v_fma_f32 v102, v102, v15, v26
  v_fma_f32 v103, v103, v15, v26
  s_add_u32 m0, s61, 0x2400
  s_add_u32 s62, s0, 0x2f000
  buffer_load_dwordx4 v1, s[44:47], s62 offen sc1 lds
  v_fma_f32 v104, v104, v15, v26
  v_fma_f32 v105, v105, v15, v26
  v_fma_f32 v106, v106, v15, v26
  v_fma_f32 v107, v107, v15, v26
  v_fma_f32 v108, v108, v15, v26
  v_fma_f32 v109, v109, v15, v26
  v_fma_f32 v110, v110, v15, v26
  v_fma_f32 v111, v111, v15, v26
  v_exp_f32 v96, v96
  v_exp_f32 v97, v97
  v_exp_f32 v98, v98
  v_exp_f32 v99, v99
  v_exp_f32 v100, v100
  v_exp_f32 v101, v101
  s_waitcnt vmcnt(13)
  s_barrier
  buffer_load_dword v204, v5, s[44:47], s67 offen offset:128 sc1
  v_exp_f32 v102, v102
  v_exp_f32 v103, v103
  v_exp_f32 v104, v104
  v_exp_f32 v105, v105
  v_exp_f32 v106, v106
  v_exp_f32 v107, v107
  v_exp_f32 v108, v108
  v_exp_f32 v109, v109
  v_exp_f32 v110, v110
  v_exp_f32 v111, v111
  v_add_f32 v26, v96, v97
  v_add_f32 v31, v98, v99
  v_add_f32 v26, v26, v100
  v_add_f32 v31, v31, v101
  v_add_f32 v26, v26, v102
  v_add_f32 v31, v31, v103
  v_add_f32 v26, v26, v104
  v_add_f32 v31, v31, v105
  v_add_f32 v26, v26, v106
  v_add_f32 v31, v31, v107
  v_add_f32 v26, v26, v108
  s_waitcnt vmcnt(5)
  v_cmp_ne_u32 vcc, 0, v9
  s_nop 0
  s_andn2_b32 s3, 0xffff, vcc_lo
  s_cbranch_scc1 L21
L22:
  s_lshl_b32 s5, s57, 10
  s_add_u32 s5, s5, s70
  buffer_load_dwordx4 v[80:83], v1, s[44:47], s5 offen sc1
  v_and_b32 v21, 3, v0
  v_lshlrev_b32 v21, 4, v21
  s_lshl_b32 s5, s57, 6
  s_add_u32 s5, s5, s70
  buffer_load_dwordx4 v[84:87], v21, s[44:47], s5 offen offset:2048 sc1
  v_add_f32 v31, v31, v109
  v_add_f32 v26, v26, v110
  v_add_f32 v31, v31, v111
  v_add_f32 v26, v26, v31
  v_rcp_f32 v26, v26
  s_nop 0
  v_mul_f32 v96, v96, v26
  v_mul_f32 v97, v97, v26
  v_mul_f32 v98, v98, v26
  v_mul_f32 v99, v99, v26
  v_mul_f32 v100, v100, v26
  v_mul_f32 v101, v101, v26
  v_mul_f32 v102, v102, v26
  v_mul_f32 v103, v103, v26
  v_mul_f32 v104, v104, v26
  v_mul_f32 v105, v105, v26
  v_mul_f32 v106, v106, v26
  v_mul_f32 v107, v107, v26
  v_mul_f32 v108, v108, v26
  v_mul_f32 v109, v109, v26
  v_mul_f32 v110, v110, v26
  v_mul_f32 v111, v111, v26
  v_cvt_pk_bf16_f32 v32, v96, v97
  v_cvt_pk_bf16_f32 v33, v98, v99
  v_cvt_pk_bf16_f32 v34, v100, v101
  v_cvt_pk_bf16_f32 v35, v102, v103
  v_cvt_pk_bf16_f32 v36, v104, v105
  v_cvt_pk_bf16_f32 v37, v106, v107
  v_cvt_pk_bf16_f32 v38, v108, v109
  v_cvt_pk_bf16_f32 v39, v110, v111
  v_max3_f32 v26, v48, v49, v50
  v_max3_f32 v31, v51, v52, v53
  v_max3_f32 v26, v26, v54, v55
  v_max3_f32 v31, v31, v56, v57
  v_max3_f32 v26, v26, v58, v59
  v_max3_f32 v31, v31, v60, v61
  v_max3_f32 v26, v26, v62, v63
  v_max_f32 v26, v26, v31
  v_mul_f32_e64 v26, -v26, v15
  v_fma_f32 v48, v48, v15, v26
  v_fma_f32 v49, v49, v15, v26
  v_fma_f32 v50, v50, v15, v26
  v_fma_f32 v51, v51, v15, v26
  v_fma_f32 v52, v52, v15, v26
  v_fma_f32 v53, v53, v15, v26
  v_fma_f32 v54, v54, v15, v26
  v_fma_f32 v55, v55, v15, v26
  v_fma_f32 v56, v56, v15, v26
  v_fma_f32 v57, v57, v15, v26
  v_fma_f32 v58, v58, v15, v26
  v_fma_f32 v59, v59, v15, v26
  v_fma_f32 v60, v60, v15, v26
  v_fma_f32 v61, v61, v15, v26
  v_fma_f32 v62, v62, v15, v26
  v_fma_f32 v63, v63, v15, v26
  v_exp_f32 v48, v48
  v_exp_f32 v49, v49
  v_exp_f32 v50, v50
  s_barrier
  s_waitcnt vmcnt(2)
  v_cmp_ne_u32 vcc, 0, v204
  s_nop 0
  s_andn2_b32 s3, 0xffffffff, vcc_lo
  s_cbranch_scc1 L24
L25:
  s_add_u32 m0, s61, 0x18000
  s_add_u32 s62, s0, 0x2000
  buffer_load_dwordx4 v1, s[44:47], s62 offen sc1 lds
  v_exp_f32 v51, v51
  v_exp_f32 v52, v52
  s_add_u32 m0, s61, 0x18400
  s_add_u32 s62, s0, 0x26000
  buffer_load_dwordx4 v1, s[44:47], s62 offen sc1 lds
  v_exp_f32 v53, v53
  v_exp_f32 v54, v54
  s_add_u32 m0, s61, 0x16000
  s_add_u32 s62, s0, 0xffffb000
  buffer_load_dwordx4 v1, s[44:47], s62 offen sc1 lds
  v_exp_f32 v55, v55
  v_exp_f32 v56, v56
  s_add_u32 m0, s61, 0x16400
  s_add_u32 s62, s0, 0x1f000
  buffer_load_dwordx4 v1, s[44:47], s62 offen sc1 lds
  v_exp_f32 v57, v57
  v_exp_f32 v58, v58
  v_exp_f32 v59, v59
  v_exp_f32 v60, v60
  v_exp_f32 v61, v61
  v_exp_f32 v62, v62
  v_exp_f32 v63, v63
  v_add_f32 v26, v48, v49
  v_add_f32 v31, v50, v51
  v_add_f32 v26, v26, v52
  v_add_f32 v31, v31, v53
  v_add_f32 v26, v26, v54
  v_add_f32 v31, v31, v55
  v_add_f32 v26, v26, v56
  v_add_f32 v31, v31, v57
  v_add_f32 v26, v26, v58
  v_add_f32 v31, v31, v59
  v_add_f32 v26, v26, v60
  v_add_f32 v31, v31, v61
  v_add_f32 v26, v26, v62
  v_add_f32 v31, v31, v63
  v_add_f32 v26, v26, v31
  v_rcp_f32 v26, v26
  s_nop 0
  v_mul_f32 v48, v48, v26
  v_mul_f32 v49, v49, v26
  v_mul_f32 v50, v50, v26
  v_mul_f32 v51, v51, v26
  v_mul_f32 v52, v52, v26
  v_mul_f32 v53, v53, v26
  v_mul_f32 v54, v54, v26
  v_mul_f32 v55, v55, v26
  v_mul_f32 v56, v56, v26
  v_mul_f32 v57, v57, v26
  v_mul_f32 v58, v58, v26
  v_mul_f32 v59, v59, v26
  v_mul_f32 v60, v60, v26
  v_mul_f32 v61, v61, v26
  v_mul_f32 v62, v62, v26
  v_mul_f32 v63, v63, v26
  v_cvt_pk_bf16_f32 v40, v48, v49
  v_cvt_pk_bf16_f32 v41, v50, v51
  v_cvt_pk_bf16_f32 v42, v52, v53
  v_cvt_pk_bf16_f32 v43, v54, v55
  v_cvt_pk_bf16_f32 v44, v56, v57
  v_cvt_pk_bf16_f32 v45, v58, v59
  v_cvt_pk_bf16_f32 v46, v60, v61
  v_cvt_pk_bf16_f32 v47, v62, v63
  s_waitcnt vmcnt(5)
  v_cvt_pk_bf16_f32 v80, v80, v81
  v_cvt_pk_bf16_f32 v81, v82, v83
  s_waitcnt vmcnt(4)
  v_cvt_pk_bf16_f32 v84, v84, v85
  v_cvt_pk_bf16_f32 v85, v86, v87
  s_mul_i32 s5, s56, 1088
  s_add_u32 s5, s5, 158208
  s_lshl_b32 s4, s57, 9
  s_add_u32 s4, s4, s5
  v_lshlrev_b32 v25, 3, v0
  v_add_u32 v25, s4, v25
  ds_write_b64 v25, v[80:81]
  s_lshl_b32 s4, s57, 5
  s_add_u32 s4, s4, s5
  v_lshrrev_b32 v21, 1, v21
  v_add_u32 v21, s4, v21
  ds_write_b64 v21, v[84:85] offset:1024
  v_min_u32 v25, 64, v30
  v_lshlrev_b32 v25, 4, v25
  v_lshrrev_b32 v26, 5, v0
  v_lshl_add_u32 v25, v26, 5, v25
  v_add_u32 v25, 160384, v25
  s_lshl_b32 s5, s52, 12
  s_add_u32 s5, s5, s64
  s_add_u32 s72, s5, 116736
  s_waitcnt lgkmcnt(0)
  s_barrier
  s_add_u32 m0, s61, 0x20000
  s_add_u32 s62, s0, 0x10000
  buffer_load_dwordx4 v1, s[44:47], s62 offen sc1 lds
  ds_read_b128 v[112:115], v25
  ds_read_b128 v[116:119], v25 offset:16
  ds_read_b128 v[120:123], v25 offset:1088
  ds_read_b128 v[124:127], v25 offset:1104
  s_waitcnt lgkmcnt(3)
  v_mfma_f32_32x32x16_bf16 v[96:111], v[112:115], v[32:35], 0
  s_waitcnt lgkmcnt(2)
  v_mfma_f32_32x32x16_bf16 v[96:111], v[116:119], v[36:39], v[96:111]
  s_add_u32 m0, s61, 0x20400
  s_add_u32 s62, s0, 0x34000
  buffer_load_dwordx4 v1, s[44:47], s62 offen sc1 lds
  s_waitcnt lgkmcnt(1)
  v_mfma_f32_32x32x16_bf16 v[48:63], v[120:123], v[40:43], 0
  s_waitcnt lgkmcnt(0)
  v_mfma_f32_32x32x16_bf16 v[48:63], v[124:127], v[44:47], v[48:63]
  s_nop 4
  v_add_f32 v26, 0x358637bd, v104
  v_rcp_f32 v26, v26
  s_add_u32 m0, s61, 0x1e000
  s_add_u32 s62, s0, 0x9000
  buffer_load_dwordx4 v1, s[44:47], s62 offen sc1 lds
  v_mul_f32 v96, v96, v26
  v_mul_f32 v97, v97, v26
  v_mul_f32 v98, v98, v26
  v_mul_f32 v99, v99, v26
  s_add_u32 m0, s61, 0x1e400
  s_add_u32 s62, s0, 0x2d000
  buffer_load_dwordx4 v1, s[44:47], s62 offen sc1 lds
  v_mul_f32 v100, v100, v26
  v_mul_f32 v101, v101, v26
  v_mul_f32 v102, v102, v26
  v_mul_f32 v103, v103, v26
  s_add_u32 m0, s61, 0x0
  s_add_u32 s62, s0, 0x5000
  buffer_load_dwordx4 v1, s[44:47], s62 offen sc1 lds
  v_cvt_pk_bf16_f32 v32, v96, v97
  v_cvt_pk_bf16_f32 v33, v98, v99
  v_cvt_pk_bf16_f32 v34, v100, v101
  v_cvt_pk_bf16_f32 v35, v102, v103
  s_add_u32 m0, s61, 0x400
  s_add_u32 s62, s0, 0x29000
  buffer_load_dwordx4 v1, s[44:47], s62 offen sc1 lds
  buffer_store_dwordx4 v[32:35], v1, s[44:47], s72 offen offset:0 sc1
  v_add_f32 v26, 0x358637bd, v56
  v_rcp_f32 v26, v26
  s_nop 0
  v_mul_f32 v48, v48, v26
  s_add_u32 m0, s61, 0xffffe000
  s_add_u32 s62, s0, 0xffffe000
  buffer_load_dwordx4 v1, s[44:47], s62 offen sc1 lds
  v_mul_f32 v49, v49, v26
  v_mul_f32 v50, v50, v26
  v_mul_f32 v51, v51, v26
  v_mul_f32 v52, v52, v26
  s_add_u32 m0, s61, 0xffffe400
  s_add_u32 s62, s0, 0x22000
  buffer_load_dwordx4 v1, s[44:47], s62 offen sc1 lds
  v_mul_f32 v53, v53, v26
  v_mul_f32 v54, v54, v26
  v_mul_f32 v55, v55, v26
  v_cvt_pk_bf16_f32 v36, v48, v49
  v_cvt_pk_bf16_f32 v37, v50, v51
  v_cvt_pk_bf16_f32 v38, v52, v53
  v_cvt_pk_bf16_f32 v39, v54, v55
  buffer_store_dwordx4 v[36:39], v1, s[44:47], s72 offen offset:1024 sc1
  s_barrier
  buffer_load_dword v208, v5, s[44:47], s67 offen offset:384 sc1
  s_add_u32 m0, s61, 0x14000
  s_add_u32 s62, s68, 0x30000
  buffer_load_dwordx4 v4, s[20:23], s62 offen lds
  s_add_u32 m0, s61, 0x14400
  s_add_u32 s62, s68, 0x32000
  buffer_load_dwordx4 v4, s[20:23], s62 offen lds
  s_add_u32 m0, s61, 0x12000
  s_add_u32 s62, s68, 0xfffc0000
  buffer_load_dwordx4 v4, s[20:23], s62 offen lds
  s_add_u32 m0, s61, 0x12400
  s_add_u32 s62, s68, 0xfffc2000
  buffer_load_dwordx4 v4, s[20:23], s62 offen lds
  s_add_u32 m0, s61, 0x1c000
  s_add_u32 s62, s0, 0x13000
  buffer_load_dwordx4 v1, s[44:47], s62 offen sc1 lds
  s_add_u32 m0, s61, 0x1c400
  s_add_u32 s62, s0, 0x37000
  buffer_load_dwordx4 v1, s[44:47], s62 offen sc1 lds
  s_add_u32 m0, s61, 0x1a000
  s_add_u32 s62, s0, 0xc000
  buffer_load_dwordx4 v1, s[44:47], s62 offen sc1 lds
  s_add_u32 m0, s61, 0x1a400
  s_add_u32 s62, s0, 0x30000
  buffer_load_dwordx4 v1, s[44:47], s62 offen sc1 lds
  s_waitcnt vmcnt(9)
  buffer_store_dword v10, v28, s[44:47], s65 offen offset:512 sc1
  s_barrier
  s_add_u32 m0, s61, 0x4000
  s_add_u32 s62, s68, 0x110000
  buffer_load_dwordx4 v4, s[20:23], s62 offen lds
  s_add_u32 m0, s61, 0x4400
  s_add_u32 s62, s68, 0x112000
  buffer_load_dwordx4 v4, s[20:23], s62 offen lds
  s_add_u32 m0, s61, 0x2000
  s_add_u32 s62, s68, 0xa0000
  buffer_load_dwordx4 v4, s[20:23], s62 offen lds
  s_add_u32 m0, s61, 0x2400
  s_add_u32 s62, s68, 0xa2000
  buffer_load_dwordx4 v4, s[20:23], s62 offen lds
  s_waitcnt vmcnt(13)
  v_cmp_ne_u32 vcc, 0, v208
  s_nop 0
  s_andn2_b32 s3, 0x55555555, vcc_lo
  s_cbranch_scc1 L27
L28:
  s_add_u32 m0, s61, 0x8000
  s_add_u32 s62, s0, 0x3000
  buffer_load_dwordx4 v1, s[44:47], s62 offen sc1 lds
  s_add_u32 m0, s61, 0x8400
  s_add_u32 s62, s0, 0x27000
  buffer_load_dwordx4 v1, s[44:47], s62 offen sc1 lds
  s_add_u32 m0, s61, 0x6000
  s_add_u32 s62, s0, 0xffffc000
  buffer_load_dwordx4 v1, s[44:47], s62 offen sc1 lds
  s_add_u32 m0, s61, 0x6400
  s_add_u32 s62, s0, 0x20000
  buffer_load_dwordx4 v1, s[44:47], s62 offen sc1 lds
  s_barrier
  s_add_u32 m0, s61, 0x18000
  s_add_u32 s62, s68, 0x0
  buffer_load_dwordx4 v4, s[20:23], s62 offen lds
  s_add_u32 m0, s61, 0x18400
  s_add_u32 s62, s68, 0x2000
  buffer_load_dwordx4 v4, s[20:23], s62 offen lds
  s_add_u32 m0, s61, 0x16000
  s_add_u32 s62, s68, 0xfff90000
  buffer_load_dwordx4 v4, s[20:23], s62 offen lds
  s_add_u32 m0, s61, 0x16400
  s_add_u32 s62, s68, 0xfff92000
  buffer_load_dwordx4 v4, s[20:23], s62 offen lds
  s_add_u32 m0, s61, 0xc000
  s_add_u32 s62, s0, 0x11000
  buffer_load_dwordx4 v1, s[44:47], s62 offen sc1 lds
  s_add_u32 m0, s61, 0xc400
  s_add_u32 s62, s0, 0x35000
  buffer_load_dwordx4 v1, s[44:47], s62 offen sc1 lds
  s_add_u32 m0, s61, 0xa000
  s_add_u32 s62, s0, 0xa000
  buffer_load_dwordx4 v1, s[44:47], s62 offen sc1 lds
  buffer_load_dword v210, v5, s[44:47], s67 offen offset:256 sc1
  s_waitcnt vmcnt(21)
  s_barrier
  s_add_u32 m0, s61, 0xa400
  s_add_u32 s62, s0, 0x2e000
  buffer_load_dwordx4 v1, s[44:47], s62 offen sc1 lds
  s_add_u32 m0, s61, 0x20000
  s_add_u32 s62, s68, 0xe0000
  buffer_load_dwordx4 v4, s[20:23], s62 offen lds
  s_add_u32 m0, s61, 0x20400
  s_add_u32 s62, s68, 0xe2000
  buffer_load_dwordx4 v4, s[20:23], s62 offen lds
  s_add_u32 m0, s61, 0x1e000
  s_add_u32 s62, s68, 0x70000
  buffer_load_dwordx4 v4, s[20:23], s62 offen lds
  s_add_u32 m0, s61, 0x1e400
  s_add_u32 s62, s68, 0x72000
  buffer_load_dwordx4 v4, s[20:23], s62 offen lds
  s_waitcnt vmcnt(5)
  v_cmp_ne_u32 vcc, 0, v210
  s_nop 0
  s_andn2_b32 s3, 0xffffffff, vcc_lo
  s_cbranch_scc1 L30
L31:
  s_add_u32 m0, s61, 0x10000
  s_add_u32 s62, s0, 0x0
  buffer_load_dwordx4 v1, s[44:47], s62 offen sc1 lds
  s_add_u32 m0, s61, 0x10400
  s_add_u32 s62, s0, 0x24000
  buffer_load_dwordx4 v1, s[44:47], s62 offen sc1 lds
  s_barrier
  s_add_u32 m0, s61, 0xe000
  s_add_u32 s62, s0, 0xffff9000
  buffer_load_dwordx4 v1, s[44:47], s62 offen sc1 lds
  s_add_u32 m0, s61, 0xe400
  s_add_u32 s62, s0, 0x1d000
  buffer_load_dwordx4 v1, s[44:47], s62 offen sc1 lds
  s_add_u32 m0, s61, 0x0
  s_add_u32 s62, s68, 0x60000
  buffer_load_dwordx4 v4, s[20:23], s62 offen lds
  s_add_u32 m0, s61, 0x400
  s_add_u32 s62, s68, 0x62000
  buffer_load_dwordx4 v4, s[20:23], s62 offen lds
  s_add_u32 m0, s61, 0xffffe000
  s_add_u32 s62, s68, 0xffff0000
  buffer_load_dwordx4 v4, s[20:23], s62 offen lds
  s_add_u32 m0, s61, 0xffffe400
  s_add_u32 s62, s68, 0xffff2000
  buffer_load_dwordx4 v4, s[20:23], s62 offen lds
  s_add_u32 m0, s61, 0x14000
  s_add_u32 s62, s0, 0xe000
  buffer_load_dwordx4 v1, s[44:47], s62 offen sc1 lds
  s_barrier
  s_add_u32 m0, s61, 0x14400
  s_add_u32 s62, s0, 0x32000
  buffer_load_dwordx4 v1, s[44:47], s62 offen sc1 lds
  s_add_u32 m0, s61, 0x12000
  s_add_u32 s62, s0, 0x7000
  buffer_load_dwordx4 v1, s[44:47], s62 offen sc1 lds
  s_add_u32 m0, s61, 0x12400
  s_add_u32 s62, s0, 0x2b000
  buffer_load_dwordx4 v1, s[44:47], s62 offen sc1 lds
  s_add_u32 m0, s61, 0x24000
  s_add_u32 s62, s68, 0x140000
  buffer_load_dwordx4 v4, s[20:23], s62 offen lds
  s_add_u32 m0, s61, 0x24400
  s_add_u32 s62, s68, 0x142000
  buffer_load_dwordx4 v4, s[20:23], s62 offen lds
  s_add_u32 m0, s61, 0x22000
  s_add_u32 s62, s68, 0xd0000
  buffer_load_dwordx4 v4, s[20:23], s62 offen lds
  s_add_u32 m0, s61, 0x22400
  s_add_u32 s62, s68, 0xd2000
  buffer_load_dwordx4 v4, s[20:23], s62 offen lds
  s_waitcnt vmcnt(20)
  s_waitcnt vmcnt(16)
  s_barrier
  s_add_u32 m0, s61, 0x1c000
  s_add_u32 s62, s0, 0x6000
  buffer_load_dwordx4 v1, s[44:47], s62 offen sc1 lds
  s_add_u32 m0, s61, 0x1c400
  s_add_u32 s62, s0, 0x2a000
  buffer_load_dwordx4 v1, s[44:47], s62 offen sc1 lds
  s_add_u32 m0, s61, 0x1a000
  s_add_u32 s62, s0, 0xfffff000
  buffer_load_dwordx4 v1, s[44:47], s62 offen sc1 lds
  s_add_u32 m0, s61, 0x1a400
  s_add_u32 s62, s0, 0x23000
  buffer_load_dwordx4 v1, s[44:47], s62 offen sc1 lds
  s_add_u32 m0, s61, 0x4000
  s_add_u32 s62, s69, 0x0
  buffer_load_dwordx4 v4, s[24:27], s62 offen lds
  s_add_u32 m0, s61, 0x4400
  s_add_u32 s62, s69, 0x2000
  buffer_load_dwordx4 v4, s[24:27], s62 offen lds
  s_add_u32 m0, s61, 0x2000
  s_add_u32 s62, s69, 0xfffe0000
  buffer_load_dwordx4 v4, s[24:27], s62 offen lds
  s_waitcnt vmcnt(19)
  s_waitcnt vmcnt(15)
  s_barrier
  buffer_load_dword v214, v5, s[44:47], s67 offen offset:512 sc1
  s_add_u32 m0, s61, 0x2400
  s_add_u32 s62, s69, 0xfffe2000
  buffer_load_dwordx4 v4, s[24:27], s62 offen lds
  s_add_u32 m0, s61, 0x8000
  s_add_u32 s62, s0, 0x14000
  buffer_load_dwordx4 v1, s[44:47], s62 offen sc1 lds
  s_add_u32 m0, s61, 0x8400
  s_add_u32 s62, s0, 0x38000
  buffer_load_dwordx4 v1, s[44:47], s62 offen sc1 lds
  s_add_u32 m0, s61, 0x6000
  s_add_u32 s62, s0, 0xd000
  buffer_load_dwordx4 v1, s[44:47], s62 offen sc1 lds
  s_add_u32 m0, s61, 0x6400
  s_add_u32 s62, s0, 0x31000
  buffer_load_dwordx4 v1, s[44:47], s62 offen sc1 lds
  s_add_u32 m0, s61, 0x18000
  s_add_u32 s62, s69, 0x40000
  buffer_load_dwordx4 v4, s[24:27], s62 offen lds
  s_add_u32 m0, s61, 0x18400
  s_add_u32 s62, s69, 0x42000
  buffer_load_dwordx4 v4, s[24:27], s62 offen lds
  s_waitcnt vmcnt(19)
  s_waitcnt vmcnt(15)
  s_barrier
  s_add_u32 m0, s61, 0x16000
  s_add_u32 s62, s69, 0x20000
  buffer_load_dwordx4 v4, s[24:27], s62 offen lds
  s_add_u32 m0, s61, 0x16400
  s_add_u32 s62, s69, 0x22000
  buffer_load_dwordx4 v4, s[24:27], s62 offen lds
  s_waitcnt vmcnt(9)
  v_cmp_ne_u32 vcc, 0, v214
  s_nop 0
  s_andn2_b32 s3, 0xffffffff, vcc_lo
  s_cbranch_scc1 L33
L34:
  s_add_u32 m0, s61, 0xc000
  s_add_u32 s62, s1, 0x0
  buffer_load_dwordx4 v1, s[44:47], s62 offen sc1 lds
  s_add_u32 m0, s61, 0xc400
  s_add_u32 s62, s1, 0x24000
  buffer_load_dwordx4 v1, s[44:47], s62 offen sc1 lds
  s_add_u32 m0, s61, 0xa000
  s_add_u32 s62, s1, 0xffffe000
  buffer_load_dwordx4 v1, s[44:47], s62 offen sc1 lds
  s_add_u32 m0, s61, 0xa400
  s_add_u32 s62, s1, 0x22000
  buffer_load_dwordx4 v1, s[44:47], s62 offen sc1 lds
  s_add_u32 m0, s61, 0x20000
  s_add_u32 s62, s69, 0x10000
  buffer_load_dwordx4 v4, s[24:27], s62 offen lds
  s_waitcnt vmcnt(13)
  s_barrier
  s_add_u32 m0, s61, 0x20400
  s_add_u32 s62, s69, 0x12000
  buffer_load_dwordx4 v4, s[24:27], s62 offen lds
  s_add_u32 m0, s61, 0x1e000
  s_add_u32 s62, s69, 0xffff0000
  buffer_load_dwordx4 v4, s[24:27], s62 offen lds
  s_add_u32 m0, s61, 0x1e400
  s_add_u32 s62, s69, 0xffff2000
  buffer_load_dwordx4 v4, s[24:27], s62 offen lds
  s_add_u32 m0, s61, 0x10000
  s_add_u32 s62, s1, 0x4000
  buffer_load_dwordx4 v1, s[44:47], s62 offen sc1 lds
  s_add_u32 m0, s61, 0x10400
  s_add_u32 s62, s1, 0x28000
  buffer_load_dwordx4 v1, s[44:47], s62 offen sc1 lds
  s_add_u32 m0, s61, 0xe000
  s_add_u32 s62, s1, 0x2000
  buffer_load_dwordx4 v1, s[44:47], s62 offen sc1 lds
  s_add_u32 m0, s61, 0xe400
  s_add_u32 s62, s1, 0x26000
  buffer_load_dwordx4 v1, s[44:47], s62 offen sc1 lds
  s_waitcnt vmcnt(16)
  s_waitcnt vmcnt(12)
  s_barrier
  s_add_u32 m0, s61, 0x0
  s_add_u32 s62, s69, 0x50000
  buffer_load_dwordx4 v4, s[24:27], s62 offen lds
  s_add_u32 m0, s61, 0x400
  s_add_u32 s62, s69, 0x52000
  buffer_load_dwordx4 v4, s[24:27], s62 offen lds
  s_add_u32 m0, s61, 0xffffe000
  s_add_u32 s62, s69, 0x30000
  buffer_load_dwordx4 v4, s[24:27], s62 offen lds
  s_add_u32 m0, s61, 0xffffe400
  s_add_u32 s62, s69, 0x32000
  buffer_load_dwordx4 v4, s[24:27], s62 offen lds
  s_add_u32 m0, s61, 0x14000
  s_add_u32 s62, s91, 0x0
  buffer_load_dwordx4 v4, s[8:11], s62 offen lds
  s_add_u32 m0, s61, 0x14400
  s_add_u32 s62, s91, 0x2000
  buffer_load_dwordx4 v4, s[8:11], s62 offen lds
  s_add_u32 m0, s61, 0x24000
  s_add_u32 s62, s1, 0x1000
  buffer_load_dwordx4 v1, s[44:47], s62 offen sc1 lds
  s_waitcnt vmcnt(15)
  s_waitcnt vmcnt(11)
  s_barrier
  s_add_u32 m0, s61, 0x24400
  s_add_u32 s62, s1, 0x25000
  buffer_load_dwordx4 v1, s[44:47], s62 offen sc1 lds
  s_add_u32 m0, s61, 0x22000
  s_add_u32 s62, s1, 0xfffff000
  buffer_load_dwordx4 v1, s[44:47], s62 offen sc1 lds
  s_add_u32 m0, s61, 0x22400
  s_add_u32 s62, s1, 0x23000
  buffer_load_dwordx4 v1, s[44:47], s62 offen sc1 lds
  s_add_u32 m0, s61, 0x1c000
  s_add_u32 s62, s1, 0x5000
  buffer_load_dwordx4 v1, s[44:47], s62 offen sc1 lds
  s_add_u32 m0, s61, 0x1c400
  s_add_u32 s62, s1, 0x29000
  buffer_load_dwordx4 v1, s[44:47], s62 offen sc1 lds
  s_add_u32 m0, s61, 0x1a000
  s_add_u32 s62, s1, 0x3000
  buffer_load_dwordx4 v1, s[44:47], s62 offen sc1 lds
  s_add_u32 m0, s61, 0x1a400
  s_add_u32 s62, s1, 0x27000
  buffer_load_dwordx4 v1, s[44:47], s62 offen sc1 lds
  s_waitcnt vmcnt(14)
  s_waitcnt vmcnt(10)
  s_barrier
  s_waitcnt vmcnt(4)
  s_barrier
  s_waitcnt vmcnt(0)
  s_barrier
  s_endpgm
L_typeA0:
  s_lshl_b32 s72, s48, 12
  s_add_u32 s72, s72, 32768
  s_waitcnt vmcnt(8)
  s_barrier
  s_and_b32 s3, s75, 7
  s_cmp_lg_u32 s3, 1
  s_cbranch_scc1 L36
  s_cmp_lg_u32 s48, 0
  s_cbranch_scc1 L36
  s_lshl_b32 s3, s87, 2
  buffer_store_dword v10, v28, s[40:43], s3 offen offset:128 sc1
L36:
  ds_read_b128 v[128:131], v64 offset:0
  ds_read_b128 v[132:135], v65 offset:0
  ds_read_b64_tr_b16 v[80:81], v6 offset:49152
  ds_read_b64_tr_b16 v[82:83], v6 offset:49664
  ds_read_b128 v[136:139], v66 offset:0
  ds_read_b128 v[140:143], v67 offset:0
  ds_read_b128 v[144:147], v68 offset:0
  ds_read_b64_tr_b16 v[84:85], v6 offset:51200
  ds_read_b64_tr_b16 v[86:87], v6 offset:51712
  ds_read_b128 v[148:151], v69 offset:0
  ds_read_b128 v[152:155], v70 offset:0
  ds_read_b128 v[156:159], v71 offset:0
  ds_read_b64_tr_b16 v[88:89], v7 offset:49152
  ds_read_b64_tr_b16 v[90:91], v7 offset:49664
  ds_read_b64_tr_b16 v[92:93], v7 offset:51200
  ds_read_b64_tr_b16 v[94:95], v7 offset:51712
  s_waitcnt lgkmcnt(12)
  v_mfma_f32_32x32x16_bf16 v[32:47], v[80:83], v[128:131], 0
  v_mfma_f32_16x16x32_bf16 v[124:127], v[120:123], v[80:83], 0
  s_waitcnt lgkmcnt(4)
  s_barrier
  ds_read_b64_tr_b16 v[80:81], v8 offset:49152
  ds_read_b64_tr_b16 v[82:83], v8 offset:49664
  s_add_u32 m0, s61, 0x0
  s_mul_i32 s89, s100, 256
  s_add_u32 s89, s89, s86
  s_add_u32 s62, s89, 0x0
  buffer_load_dwordx4 v72, s[8:11], s62 offen lds
  s_add_u32 m0, s61, 0x400
  s_add_u32 s62, s89, 0x0
  buffer_load_dwordx4 v73, s[8:11], s62 offen lds
  v_mfma_f32_32x32x16_bf16 v[32:47], v[84:87], v[132:135], v[32:47]
  v_mfma_f32_16x16x32_bf16 v[124:127], v[120:123], v[84:87], v[124:127]
  ds_read_b64_tr_b16 v[84:85], v8 offset:51200
  ds_read_b64_tr_b16 v[86:87], v8 offset:51712
  v_dot2_f32_bf16 v96, v128, s60, 0
  v_dot2_f32_bf16 v98, v128, v128, 0
  v_dot2_f32_bf16 v97, v129, s60, 0
  v_dot2_f32_bf16 v99, v129, v129, 0
  v_dot2_f32_bf16 v96, v130, s60, v96
  v_dot2_f32_bf16 v98, v130, v130, v98
  v_dot2_f32_bf16 v97, v131, s60, v97
  v_dot2_f32_bf16 v99, v131, v131, v99
  v_dot2_f32_bf16 v96, v136, s60, v96
  v_dot2_f32_bf16 v98, v136, v136, v98
  v_dot2_f32_bf16 v97, v137, s60, v97
  v_dot2_f32_bf16 v99, v137, v137, v99
  v_dot2_f32_bf16 v96, v138, s60, v96
  v_dot2_f32_bf16 v98, v138, v138, v98
  v_dot2_f32_bf16 v97, v139, s60, v97
  v_dot2_f32_bf16 v99, v139, v139, v99
  s_waitcnt lgkmcnt(6)
  v_mfma_f32_32x32x16_bf16 v[32:47], v[88:91], v[136:139], v[32:47]
  ds_read_b64_tr_b16 v[88:89], v9 offset:49152
  ds_read_b64_tr_b16 v[90:91], v9 offset:49664
  s_add_u32 m0, s61, 0x4000
  s_add_u32 s62, s89, 0x10000
  buffer_load_dwordx4 v72, s[8:11], s62 offen lds
  s_add_u32 m0, s61, 0x4400
  s_add_u32 s62, s89, 0x10000
  buffer_load_dwordx4 v73, s[8:11], s62 offen lds
  s_waitcnt lgkmcnt(6)
  v_mfma_f32_32x32x16_bf16 v[32:47], v[92:95], v[140:143], v[32:47]
  ds_read_b64_tr_b16 v[92:93], v9 offset:51200
  ds_read_b64_tr_b16 v[94:95], v9 offset:51712
  v_dot2_f32_bf16 v96, v144, s60, v96
  v_dot2_f32_bf16 v98, v144, v144, v98
  v_dot2_f32_bf16 v97, v145, s60, v97
  v_dot2_f32_bf16 v99, v145, v145, v99
  v_dot2_f32_bf16 v96, v146, s60, v96
  v_dot2_f32_bf16 v98, v146, v146, v98
  v_dot2_f32_bf16 v97, v147, s60, v97
  v_dot2_f32_bf16 v99, v147, v147, v99
  v_dot2_f32_bf16 v96, v152, s60, v96
  v_dot2_f32_bf16 v98, v152, v152, v98
  v_dot2_f32_bf16 v97, v153, s60, v97
  v_dot2_f32_bf16 v99, v153, v153, v99
  v_dot2_f32_bf16 v96, v154, s60, v96
  v_dot2_f32_bf16 v98, v154, v154, v98
  v_dot2_f32_bf16 v97, v155, s60, v97
  v_dot2_f32_bf16 v99, v155, v155, v99
  s_waitcnt lgkmcnt(6)
  v_mfma_f32_32x32x16_bf16 v[32:47], v[80:83], v[144:147], v[32:47]
  s_waitcnt vmcnt(6)
  s_barrier
  ds_read_b128 v[160:163], v64 offset:32768
  ds_read_b128 v[164:167], v65 offset:32768
  ds_read_b64_tr_b16 v[80:81], v10 offset:0
  ds_read_b64_tr_b16 v[82:83], v10 offset:512
  s_add_u32 m0, s61, 0x18000
  s_mul_i32 s89, s100, 393216
  s_add_u32 s89, s89, s63
  s_add_u32 s62, s89, 0x0
  buffer_load_dwordx4 v2, s[12:15], s62 offen lds
  s_add_u32 m0, s61, 0x18400
  s_add_u32 s62, s89, 0x6000
  buffer_load_dwordx4 v2, s[12:15], s62 offen lds
  s_waitcnt lgkmcnt(8)
  v_mfma_f32_32x32x16_bf16 v[32:47], v[84:87], v[148:151], v[32:47]
  ds_read_b128 v[168:171], v66 offset:32768
  ds_read_b128 v[172:175], v67 offset:32768
  ds_read_b128 v[176:179], v68 offset:32768
  ds_read_b64_tr_b16 v[84:85], v10 offset:2048
  ds_read_b64_tr_b16 v[86:87], v10 offset:2560
  s_waitcnt lgkmcnt(11)
  v_mfma_f32_32x32x16_bf16 v[32:47], v[88:91], v[152:155], v[32:47]
  ds_read_b128 v[180:183], v69 offset:32768
  ds_read_b128 v[184:187], v70 offset:32768
  ds_read_b128 v[188:191], v71 offset:32768
  ds_read_b64_tr_b16 v[88:89], v11 offset:0
  ds_read_b64_tr_b16 v[90:91], v11 offset:512
  s_add_u32 m0, s61, 0x1c000
  s_mul_i32 s89, s101, 393216
  s_add_u32 s89, s89, s63
  s_add_u32 s62, s89, 0x0
  buffer_load_dwordx4 v2, s[12:15], s62 offen lds
  s_add_u32 m0, s61, 0x1c400
  s_add_u32 s62, s89, 0x6000
  buffer_load_dwordx4 v2, s[12:15], s62 offen lds
  v_lshrrev_b32 v31, 1, v30
  buffer_load_ushort v23, v31, s[32:35], s92 offen
  s_lshl_b32 s3, s52, 11
  s_lshl_b32 s4, s57, 10
  s_add_u32 s3, s3, s4
  s_add_u32 m0, s4, 147456
  s_nop 0
  buffer_load_dwordx4 v1, s[28:31], s3 offen lds
  s_waitcnt lgkmcnt(14)
  v_mfma_f32_32x32x16_bf16 v[32:47], v[92:95], v[156:159], v[32:47]
  ds_read_b64_tr_b16 v[92:93], v11 offset:2048
  ds_read_b64_tr_b16 v[94:95], v11 offset:2560
  s_waitcnt lgkmcnt(12)
  v_mfma_f32_32x32x16_bf16 v[32:47], v[80:83], v[160:163], v[32:47]
  v_mfma_f32_16x16x32_bf16 v[124:127], v[120:123], v[80:83], v[124:127]
  s_waitcnt lgkmcnt(4)
  s_barrier
  ds_read_b64_tr_b16 v[80:81], v12 offset:0
  ds_read_b64_tr_b16 v[82:83], v12 offset:512
  s_add_u32 m0, s61, 0x8000
  s_mul_i32 s89, s101, 256
  s_add_u32 s89, s89, s86
  s_add_u32 s62, s89, 0x0
  buffer_load_dwordx4 v72, s[8:11], s62 offen lds
  s_add_u32 m0, s61, 0x8400
  s_add_u32 s62, s89, 0x0
  buffer_load_dwordx4 v73, s[8:11], s62 offen lds
  v_mfma_f32_32x32x16_bf16 v[32:47], v[84:87], v[164:167], v[32:47]
  v_mfma_f32_16x16x32_bf16 v[124:127], v[120:123], v[84:87], v[124:127]
  ds_read_b64_tr_b16 v[84:85], v12 offset:2048
  ds_read_b64_tr_b16 v[86:87], v12 offset:2560
  v_dot2_f32_bf16 v96, v160, s60, v96
  v_dot2_f32_bf16 v98, v160, v160, v98
  v_dot2_f32_bf16 v97, v161, s60, v97
  v_dot2_f32_bf16 v99, v161, v161, v99
  v_dot2_f32_bf16 v96, v162, s60, v96
  v_dot2_f32_bf16 v98, v162, v162, v98
  v_dot2_f32_bf16 v97, v163, s60, v97
  v_dot2_f32_bf16 v99, v163, v163, v99
  v_dot2_f32_bf16 v96, v168, s60, v96
  v_dot2_f32_bf16 v98, v168, v168, v98
  v_dot2_f32_bf16 v97, v169, s60, v97
  v_dot2_f32_bf16 v99, v169, v169, v99
  v_dot2_f32_bf16 v96, v170, s60, v96
  v_dot2_f32_bf16 v98, v170, v170, v98
  v_dot2_f32_bf16 v97, v171, s60, v97
  v_dot2_f32_bf16 v99, v171, v171, v99
  s_waitcnt lgkmcnt(6)
  v_mfma_f32_32x32x16_bf16 v[32:47], v[88:91], v[168:171], v[32:47]
  ds_read_b64_tr_b16 v[88:89], v13 offset:0
  ds_read_b64_tr_b16 v[90:91], v13 offset:512
  s_add_u32 m0, s61, 0xc000
  s_add_u32 s62, s89, 0x10000
  buffer_load_dwordx4 v72, s[8:11], s62 offen lds
  s_add_u32 m0, s61, 0xc400
  s_add_u32 s62, s89, 0x10000
  buffer_load_dwordx4 v73, s[8:11], s62 offen lds
  s_waitcnt lgkmcnt(6)
  v_mfma_f32_32x32x16_bf16 v[32:47], v[92:95], v[172:175], v[32:47]
  ds_read_b64_tr_b16 v[92:93], v13 offset:2048
  ds_read_b64_tr_b16 v[94:95], v13 offset:2560
  v_dot2_f32_bf16 v96, v176, s60, v96
  v_dot2_f32_bf16 v98, v176, v176, v98
  v_dot2_f32_bf16 v97, v177, s60, v97
  v_dot2_f32_bf16 v99, v177, v177, v99
  v_dot2_f32_bf16 v96, v178, s60, v96
  v_dot2_f32_bf16 v98, v178, v178, v98
  v_dot2_f32_bf16 v97, v179, s60, v97
  v_dot2_f32_bf16 v99, v179, v179, v99
  v_dot2_f32_bf16 v96, v184, s60, v96
  v_dot2_f32_bf16 v98, v184, v184, v98
  v_dot2_f32_bf16 v97, v185, s60, v97
  v_dot2_f32_bf16 v99, v185, v185, v99
  v_dot2_f32_bf16 v96, v186, s60, v96
  v_dot2_f32_bf16 v98, v186, v186, v98
  v_dot2_f32_bf16 v97, v187, s60, v97
  v_dot2_f32_bf16 v99, v187, v187, v99
  s_waitcnt lgkmcnt(6)
  v_mfma_f32_32x32x16_bf16 v[32:47], v[80:83], v[176:179], v[32:47]
  s_waitcnt vmcnt(8)
  s_barrier
  ds_read_b128 v[192:195], v64 offset:0
  ds_read_b128 v[196:199], v65 offset:0
  ds_read_b64_tr_b16 v[80:81], v10 offset:16384
  ds_read_b64_tr_b16 v[82:83], v10 offset:16896
  s_add_u32 m0, s61, 0x20000
  s_mul_i32 s89, s98, 393216
  s_add_u32 s89, s89, s6
  s_add_u32 s62, s89, 0x0
  buffer_load_dwordx4 v2, s[12:15], s62 offen lds
  s_add_u32 m0, s61, 0x20400
  s_add_u32 s62, s89, 0x6000
  buffer_load_dwordx4 v2, s[12:15], s62 offen lds
  s_waitcnt lgkmcnt(8)
  v_mfma_f32_32x32x16_bf16 v[32:47], v[84:87], v[180:183], v[32:47]
  ds_read_b128 v[200:203], v66 offset:0
  ds_read_b128 v[204:207], v67 offset:0
  ds_read_b128 v[208:211], v68 offset:0
  ds_read_b64_tr_b16 v[84:85], v10 offset:18432
  ds_read_b64_tr_b16 v[86:87], v10 offset:18944
  s_waitcnt lgkmcnt(11)
  v_mfma_f32_32x32x16_bf16 v[32:47], v[88:91], v[184:187], v[32:47]
  ds_read_b128 v[212:215], v69 offset:0
  ds_read_b128 v[216:219], v70 offset:0
  ds_read_b128 v[220:223], v71 offset:0
  ds_read_b64_tr_b16 v[88:89], v11 offset:16384
  ds_read_b64_tr_b16 v[90:91], v11 offset:16896
  s_add_u32 m0, s61, 0x10000
  s_mul_i32 s89, s99, 393216
  s_add_u32 s89, s89, s6
  s_add_u32 s62, s89, 0x0
  buffer_load_dwordx4 v2, s[12:15], s62 offen lds
  s_add_u32 m0, s61, 0x10400
  s_add_u32 s62, s89, 0x6000
  buffer_load_dwordx4 v2, s[12:15], s62 offen lds
  s_waitcnt lgkmcnt(14)
  v_mfma_f32_32x32x16_bf16 v[32:47], v[92:95], v[188:191], v[32:47]
  ds_read_b64_tr_b16 v[92:93], v11 offset:18432
  ds_read_b64_tr_b16 v[94:95], v11 offset:18944
  s_waitcnt lgkmcnt(12)
  v_mfma_f32_32x32x16_bf16 v[32:47], v[80:83], v[192:195], v[32:47]
  v_mfma_f32_16x16x32_bf16 v[124:127], v[120:123], v[80:83], v[124:127]
  ds_read_b64_tr_b16 v[80:81], v12 offset:16384
  ds_read_b64_tr_b16 v[82:83], v12 offset:16896
  s_waitcnt lgkmcnt(9)
  v_mfma_f32_32x32x16_bf16 v[32:47], v[84:87], v[196:199], v[32:47]
  v_mfma_f32_16x16x32_bf16 v[124:127], v[120:123], v[84:87], v[124:127]
  ds_read_b64_tr_b16 v[84:85], v12 offset:18432
  ds_read_b64_tr_b16 v[86:87], v12 offset:18944
  v_dot2_f32_bf16 v96, v192, s60, v96
  v_dot2_f32_bf16 v98, v192, v192, v98
  v_dot2_f32_bf16 v97, v193, s60, v97
  v_dot2_f32_bf16 v99, v193, v193, v99
  v_dot2_f32_bf16 v96, v194, s60, v96
  v_dot2_f32_bf16 v98, v194, v194, v98
  v_dot2_f32_bf16 v97, v195, s60, v97
  v_dot2_f32_bf16 v99, v195, v195, v99
  v_dot2_f32_bf16 v96, v200, s60, v96
  v_dot2_f32_bf16 v98, v200, v200, v98
  v_dot2_f32_bf16 v97, v201, s60, v97
  v_dot2_f32_bf16 v99, v201, v201, v99
  v_dot2_f32_bf16 v96, v202, s60, v96
  v_dot2_f32_bf16 v98, v202, v202, v98
  v_dot2_f32_bf16 v97, v203, s60, v97
  v_dot2_f32_bf16 v99, v203, v203, v99
  s_waitcnt lgkmcnt(6)
  v_mfma_f32_32x32x16_bf16 v[32:47], v[88:91], v[200:203], v[32:47]
  ds_read_b64_tr_b16 v[88:89], v13 offset:16384
  ds_read_b64_tr_b16 v[90:91], v13 offset:16896
  s_waitcnt lgkmcnt(6)
  v_mfma_f32_32x32x16_bf16 v[32:47], v[92:95], v[204:207], v[32:47]
  ds_read_b64_tr_b16 v[92:93], v13 offset:18432
  ds_read_b64_tr_b16 v[94:95], v13 offset:18944
  v_dot2_f32_bf16 v96, v208, s60, v96
  v_dot2_f32_bf16 v98, v208, v208, v98
  v_dot2_f32_bf16 v97, v209, s60, v97
  v_dot2_f32_bf16 v99, v209, v209, v99
  v_dot2_f32_bf16 v96, v210, s60, v96
  v_dot2_f32_bf16 v98, v210, v210, v98
  v_dot2_f32_bf16 v97, v211, s60, v97
  v_dot2_f32_bf16 v99, v211, v211, v99
  v_dot2_f32_bf16 v96, v216, s60, v96
  v_dot2_f32_bf16 v98, v216, v216, v98
  v_dot2_f32_bf16 v97, v217, s60, v97
  v_dot2_f32_bf16 v99, v217, v217, v99
  v_dot2_f32_bf16 v96, v218, s60, v96
  v_dot2_f32_bf16 v98, v218, v218, v98
  v_dot2_f32_bf16 v97, v219, s60, v97
  v_dot2_f32_bf16 v99, v219, v219, v99
  s_waitcnt lgkmcnt(6)
  v_mfma_f32_32x32x16_bf16 v[32:47], v[80:83], v[208:211], v[32:47]
  s_waitcnt vmcnt(8)
  s_waitcnt vmcnt(6)
  s_waitcnt vmcnt(4)
  s_waitcnt vmcnt(2)
  s_barrier
  ds_read_b128 v[224:227], v64 offset:32768
  ds_read_b128 v[228:231], v65 offset:32768
  ds_read_b64_tr_b16 v[80:81], v10 offset:32768
  ds_read_b64_tr_b16 v[82:83], v10 offset:33280
  s_add_u32 m0, s61, 0x14000
  s_mul_i32 s89, s100, 393216
  s_add_u32 s89, s89, s6
  s_add_u32 s62, s89, 0x0
  buffer_load_dwordx4 v2, s[12:15], s62 offen lds
  s_add_u32 m0, s61, 0x14400
  s_add_u32 s62, s89, 0x6000
  buffer_load_dwordx4 v2, s[12:15], s62 offen lds
  s_waitcnt lgkmcnt(8)
  v_mfma_f32_32x32x16_bf16 v[32:47], v[84:87], v[212:215], v[32:47]
  ds_read_b128 v[232:235], v66 offset:32768
  ds_read_b128 v[236:239], v67 offset:32768
  ds_read_b128 v[240:243], v68 offset:32768
  ds_read_b64_tr_b16 v[84:85], v10 offset:34816
  ds_read_b64_tr_b16 v[86:87], v10 offset:35328
  s_waitcnt lgkmcnt(11)
  v_mfma_f32_32x32x16_bf16 v[32:47], v[88:91], v[216:219], v[32:47]
  ds_read_b128 v[244:247], v69 offset:32768
  ds_read_b128 v[248:251], v70 offset:32768
  ds_read_b128 v[252:255], v71 offset:32768
  ds_read_b64_tr_b16 v[88:89], v11 offset:32768
  ds_read_b64_tr_b16 v[90:91], v11 offset:33280
  s_add_u32 m0, s61, 0x4000
  s_mul_i32 s89, s101, 393216
  s_add_u32 s89, s89, s6
  s_add_u32 s62, s89, 0x0
  buffer_load_dwordx4 v2, s[12:15], s62 offen lds
  s_add_u32 m0, s61, 0x4400
  s_add_u32 s62, s89, 0x6000
  buffer_load_dwordx4 v2, s[12:15], s62 offen lds
  s_waitcnt lgkmcnt(14)
  v_mfma_f32_32x32x16_bf16 v[32:47], v[92:95], v[220:223], v[32:47]
  ds_read_b64_tr_b16 v[92:93], v11 offset:34816
  ds_read_b64_tr_b16 v[94:95], v11 offset:35328
  s_waitcnt lgkmcnt(12)
  v_mfma_f32_32x32x16_bf16 v[32:47], v[80:83], v[224:227], v[32:47]
  v_mfma_f32_16x16x32_bf16 v[124:127], v[120:123], v[80:83], v[124:127]
  ds_read_b64_tr_b16 v[80:81], v12 offset:32768
  ds_read_b64_tr_b16 v[82:83], v12 offset:33280
  s_add_u32 m0, s61, 0x0
  s_add_u32 s62, s68, 0x10000
  buffer_load_dwordx4 v4, s[20:23], s62 offen lds
  s_add_u32 m0, s61, 0x400
  s_add_u32 s62, s68, 0x12000
  buffer_load_dwordx4 v4, s[20:23], s62 offen lds
  s_waitcnt lgkmcnt(9)
  v_mfma_f32_32x32x16_bf16 v[32:47], v[84:87], v[228:231], v[32:47]
  v_mfma_f32_16x16x32_bf16 v[124:127], v[120:123], v[84:87], v[124:127]
  ds_read_b64_tr_b16 v[84:85], v12 offset:34816
  ds_read_b64_tr_b16 v[86:87], v12 offset:35328
  v_dot2_f32_bf16 v96, v224, s60, v96
  v_dot2_f32_bf16 v98, v224, v224, v98
  v_dot2_f32_bf16 v97, v225, s60, v97
  v_dot2_f32_bf16 v99, v225, v225, v99
  v_dot2_f32_bf16 v96, v226, s60, v96
  v_dot2_f32_bf16 v98, v226, v226, v98
  v_dot2_f32_bf16 v97, v227, s60, v97
  v_dot2_f32_bf16 v99, v227, v227, v99
  v_dot2_f32_bf16 v96, v232, s60, v96
  v_dot2_f32_bf16 v98, v232, v232, v98
  v_dot2_f32_bf16 v97, v233, s60, v97
  v_dot2_f32_bf16 v99, v233, v233, v99
  v_dot2_f32_bf16 v96, v234, s60, v96
  v_dot2_f32_bf16 v98, v234, v234, v98
  v_dot2_f32_bf16 v97, v235, s60, v97
  v_dot2_f32_bf16 v99, v235, v235, v99
  s_waitcnt lgkmcnt(6)
  v_mfma_f32_32x32x16_bf16 v[32:47], v[88:91], v[232:235], v[32:47]
  ds_read_b64_tr_b16 v[88:89], v13 offset:32768
  ds_read_b64_tr_b16 v[90:91], v13 offset:33280
  s_waitcnt lgkmcnt(6)
  v_mfma_f32_32x32x16_bf16 v[32:47], v[92:95], v[236:239], v[32:47]
  ds_read_b64_tr_b16 v[92:93], v13 offset:34816
  ds_read_b64_tr_b16 v[94:95], v13 offset:35328
  s_lshl_b32 s3, s49, 2
  s_add_u32 s3, s3, 154112
  v_add_u32 v125, s3, v1
  ds_write_b32 v125, v124
  v_dot2_f32_bf16 v96, v240, s60, v96
  v_dot2_f32_bf16 v98, v240, v240, v98
  v_dot2_f32_bf16 v97, v241, s60, v97
  v_dot2_f32_bf16 v99, v241, v241, v99
  v_dot2_f32_bf16 v96, v242, s60, v96
  v_dot2_f32_bf16 v98, v242, v242, v98
  v_dot2_f32_bf16 v97, v243, s60, v97
  v_dot2_f32_bf16 v99, v243, v243, v99
  v_dot2_f32_bf16 v96, v248, s60, v96
  v_dot2_f32_bf16 v98, v248, v248, v98
  v_dot2_f32_bf16 v97, v249, s60, v97
  v_dot2_f32_bf16 v99, v249, v249, v99
  v_dot2_f32_bf16 v96, v250, s60, v96
  v_dot2_f32_bf16 v98, v250, v250, v98
  v_dot2_f32_bf16 v97, v251, s60, v97
  v_dot2_f32_bf16 v99, v251, v251, v99
  s_nop 1
  v_add_f32 v96, v96, v97
  v_add_f32 v97, v98, v99
  v_lshrrev_b32 v98, 5, v0
  v_lshlrev_b32 v98, 3, v98
  v_lshl_add_u32 v98, v30, 3, v98
  s_lshl_b32 s3, s49, 10
  s_add_u32 s3, s3, 150016
  v_add_u32 v98, s3, v98
  ds_write_b64 v98, v[96:97]
  s_waitcnt lgkmcnt(8)
  v_mfma_f32_32x32x16_bf16 v[32:47], v[80:83], v[240:243], v[32:47]
  ds_read_b64_tr_b16 v[80:81], v10 offset:49152
  ds_read_b64_tr_b16 v[82:83], v10 offset:49664
  s_lshl_b32 s4, s75, 3
  s_add_u32 s4, s4, s48
  s_mul_i32 s5, s4, 896
  s_lshl_b32 s4, s4, 8
  s_mov_b32 m0, 162816
  v_min_u32 v31, 6, v0
  v_lshlrev_b32 v31, 7, v31
  buffer_load_dword v31, s[20:23], s5 offen lds
  v_min_u32 v31, 1, v0
  v_lshlrev_b32 v31, 7, v31
  buffer_load_dword v31, s[24:27], s4 offen lds
  s_waitcnt lgkmcnt(8)
  v_mfma_f32_32x32x16_bf16 v[32:47], v[84:87], v[244:247], v[32:47]
  ds_read_b64_tr_b16 v[84:85], v10 offset:51200
  ds_read_b64_tr_b16 v[86:87], v10 offset:51712
  v_bfe_u32 v25, v0, 2, 2
  v_lshrrev_b32 v26, 5, v0
  v_lshl_add_u32 v25, v26, 2, v25
  v_lshlrev_b32 v25, 5, v25
  v_bfe_u32 v26, v0, 4, 1
  v_lshl_add_u32 v25, v26, 4, v25
  v_bfe_u32 v26, v0, 1, 1
  v_lshl_add_u32 v25, v26, 3, v25
  s_lshl_b32 s4, s50, 10
  s_add_u32 s4, s4, 147456
  v_add_u32 v25, s4, v25
  ds_read_b64_tr_b16 v[112:113], v25 offset:0
  ds_read_b64_tr_b16 v[114:115], v25 offset:256
  ds_read_b64_tr_b16 v[116:117], v25 offset:512
  ds_read_b64_tr_b16 v[118:119], v25 offset:768
  v_bfe_u32 v26, v0, 2, 1
  v_mul_u32_u24 v26, 0x8000, v26
  v_lshl_or_b32 v26, v26, 16, v26
  s_waitcnt lgkmcnt(3)
  v_xor_b32 v112, v26, v112
  v_xor_b32 v113, v26, v113
  s_waitcnt lgkmcnt(2)
  v_xor_b32 v114, v26, v114
  v_xor_b32 v115, v26, v115
  s_waitcnt lgkmcnt(1)
  v_xor_b32 v116, v26, v116
  v_xor_b32 v117, v26, v117
  s_waitcnt lgkmcnt(0)
  v_xor_b32 v118, v26, v118
  v_xor_b32 v119, v26, v119
  v_mfma_f32_32x32x16_bf16 v[32:47], v[88:91], v[248:251], v[32:47]
  ds_read_b64_tr_b16 v[88:89], v11 offset:49152
  ds_read_b64_tr_b16 v[90:91], v11 offset:49664
  s_cmp_lg_u32 s48, 0
  s_cbranch_scc1 L37
  s_mul_i32 s90, s87, 57344
  s_add_u32 s90, s90, 384
  s_mov_b32 m0, 162816
  v_min_u32 v127, 27, v0
  v_lshlrev_b32 v127, 10, v127
  buffer_load_dword v127, s[20:23], s90 offen lds
L37:
  v_mfma_f32_32x32x16_bf16 v[32:47], v[92:95], v[252:255], v[32:47]
  ds_read_b64_tr_b16 v[92:93], v11 offset:51200
  ds_read_b64_tr_b16 v[94:95], v11 offset:51712
  v_mfma_f32_32x32x16_bf16 v[48:63], v[128:131], v[80:83], 0
  v_mfma_f32_16x16x32_bf16 v[124:127], v[120:123], v[80:83], 0
  ds_read_b64_tr_b16 v[80:81], v12 offset:49152
  ds_read_b64_tr_b16 v[82:83], v12 offset:49664
  v_mfma_f32_32x32x16_bf16 v[48:63], v[132:135], v[84:87], v[48:63]
  v_mfma_f32_16x16x32_bf16 v[124:127], v[120:123], v[84:87], v[124:127]
  ds_read_b64_tr_b16 v[84:85], v12 offset:51200
  ds_read_b64_tr_b16 v[86:87], v12 offset:51712
  s_waitcnt lgkmcnt(6)
  v_mfma_f32_32x32x16_bf16 v[48:63], v[136:139], v[88:91], v[48:63]
  s_waitcnt vmcnt(8)
  s_waitcnt vmcnt(6)
  s_barrier
  ds_read_b64_tr_b16 v[88:89], v13 offset:49152
  ds_read_b64_tr_b16 v[90:91], v13 offset:49664
  s_add_u32 m0, s61, 0x1c000
  s_mul_i32 s89, s98, 458752
  s_add_u32 s89, s89, s7
  s_add_u32 s62, s89, 0x0
  buffer_load_dwordx4 v3, s[16:19], s62 offen lds
  s_add_u32 m0, s61, 0x1c400
  s_add_u32 s62, s89, 0x7000
  buffer_load_dwordx4 v3, s[16:19], s62 offen lds
  s_lshl_b32 s4, s49, 10
  s_add_u32 s4, s4, 150016
  v_lshlrev_b32 v31, 3, v30
  v_add_u32 v31, s4, v31
  ds_read_b128 v[96:99], v31
  ds_read_b128 v[100:103], v31 offset:16
  v_lshlrev_b32 v104, 2, v30
  v_add_u32 v104, 154112, v104
  ds_read_b128 v[104:107], v104
  s_lshl_b32 s4, s49, 7
  s_add_u32 s4, s4, 149504
  v_add_u32 v31, s4, v30
  v_cmp_gt_u32 s[94:95], 32, v0
  s_waitcnt lgkmcnt(9)
  v_mfma_f32_32x32x16_bf16 v[48:63], v[140:143], v[92:95], v[48:63]
  ds_read_b64_tr_b16 v[92:93], v13 offset:51200
  ds_read_b64_tr_b16 v[94:95], v13 offset:51712
  s_waitcnt lgkmcnt(9)
  v_mfma_f32_32x32x16_bf16 v[48:63], v[144:147], v[80:83], v[48:63]
  ds_read_b64_tr_b16 v[80:81], v6 offset:49152
  ds_read_b64_tr_b16 v[82:83], v6 offset:49664
  s_add_u32 m0, s61, 0x18000
  s_mul_i32 s89, s99, 458752
  s_add_u32 s89, s89, s7
  s_add_u32 s62, s89, 0x0
  buffer_load_dwordx4 v3, s[16:19], s62 offen lds
  s_cmp_lg_u32 s48, 1
  s_cbranch_scc1 L38
  s_mul_i32 s90, s87, 57344
  s_add_u32 s90, s90, 29056
  s_mov_b32 m0, 162816
  v_min_u32 v127, 27, v0
  v_lshlrev_b32 v127, 10, v127
  buffer_load_dword v127, s[20:23], s90 offen lds
L38:
  s_waitcnt lgkmcnt(6)
  v_add_f32 v96, v96, v98
  v_add_f32 v97, v97, v99
  s_waitcnt lgkmcnt(4)
  v_add_f32 v104, v104, v105
  v_add_f32 v100, v100, v102
  v_add_f32 v101, v101, v103
  v_add_f32 v106, v106, v107
  v_add_f32 v96, v96, v100
  v_add_f32 v97, v97, v101
  v_add_f32 v104, v104, v106
  v_mul_f32 v96, 0xbb000000, v96
  v_mul_f32 v97, 0x3b000000, v97
  v_cvt_pk_bf16_f32 v105, v104, v104
  v_mfma_f32_32x32x16_bf16 v[48:63], v[148:151], v[84:87], v[48:63]
  ds_read_b64_tr_b16 v[84:85], v6 offset:51200
  ds_read_b64_tr_b16 v[86:87], v6 offset:51712
  v_fma_f32 v97, -v96, v96, v97
  v_max_f32 v97, 0, v97
  v_and_b32 v16, 0xffff0000, v105
  v_cvt_pk_bf16_f32 v97, v97, v97
  v_lshlrev_b32 v97, 16, v97
  v_sub_f32 v104, v104, v16
  v_mfma_f32_32x32x16_bf16 v[48:63], v[152:155], v[88:91], v[48:63]
  ds_read_b64_tr_b16 v[88:89], v7 offset:49152
  ds_read_b64_tr_b16 v[90:91], v7 offset:49664
  s_add_u32 m0, s61, 0x18400
  s_add_u32 s62, s89, 0x7000
  buffer_load_dwordx4 v3, s[16:19], s62 offen lds
  s_cmp_lg_u32 s48, 2
  s_cbranch_scc1 L39
  s_mul_i32 s90, s87, 16384
  s_add_u32 s90, s90, 384
  s_mov_b32 m0, 162816
  v_min_u32 v127, 15, v0
  v_lshlrev_b32 v127, 10, v127
  buffer_load_dword v127, s[24:27], s90 offen lds
L39:
  v_add_f32 v97, 0x3727c5ac, v97
  v_cvt_pk_bf16_f32 v97, v97, v97
  v_cvt_pk_bf16_f32 v17, v104, v104
  v_lshlrev_b32 v97, 16, v97
  v_sqrt_f32 v97, v97
  s_waitcnt lgkmcnt(6)
  v_mfma_f32_32x32x16_bf16 v[48:63], v[156:159], v[92:95], v[48:63]
  ds_read_b64_tr_b16 v[92:93], v7 offset:51200
  ds_read_b64_tr_b16 v[94:95], v7 offset:51712
  v_cvt_pk_bf16_f32 v97, v97, v96
  v_lshlrev_b32 v14, 16, v97
  v_rcp_f32 v14, v14
  v_cndmask_b32 v18, 0, v97, s[94:95]
  v_lshrrev_b32 v19, 16, v18
  s_waitcnt lgkmcnt(6)
  v_mfma_f32_32x32x16_bf16 v[48:63], v[160:163], v[80:83], v[48:63]
  v_mfma_f32_16x16x32_bf16 v[124:127], v[120:123], v[80:83], v[124:127]
  ds_read_b64_tr_b16 v[80:81], v8 offset:49152
  ds_read_b64_tr_b16 v[82:83], v8 offset:49664
  v_mul_f32 v15, 0x3fb8aa3b, v14
  v_mul_f32 v22, -2.0, v14
  ds_write_b32 v31, v14
  v_mfma_f32_32x32x16_bf16 v[32:47], v[16:19], v[18:21], v[32:47]
  v_lshrrev_b32 v26, 5, v0
  v_lshlrev_b32 v26, 1, v26
  v_bfe_u32 v25, v0, 1, 2
  s_waitcnt lgkmcnt(7)
  v_mfma_f32_32x32x16_bf16 v[48:63], v[164:167], v[84:87], v[48:63]
  v_mfma_f32_16x16x32_bf16 v[124:127], v[120:123], v[84:87], v[124:127]
  ds_read_b64_tr_b16 v[84:85], v8 offset:51200
  ds_read_b64_tr_b16 v[86:87], v8 offset:51712
  v_xor_b32 v26, v25, v26
  v_lshlrev_b32 v25, 4, v30
  v_lshl_add_u32 v25, v26, 4, v25
  v_add_u32 v25, s72, v25
  v_xor_b32 v24, 16, v25
  v_cvt_pk_bf16_f32 v32, v32, v33
  s_waitcnt lgkmcnt(7)
  v_mfma_f32_32x32x16_bf16 v[48:63], v[168:171], v[88:91], v[48:63]
  ds_read_b64_tr_b16 v[88:89], v9 offset:49152
  ds_read_b64_tr_b16 v[90:91], v9 offset:49664
  v_cvt_pk_bf16_f32 v33, v34, v35
  v_cvt_pk_bf16_f32 v34, v36, v37
  v_cvt_pk_bf16_f32 v35, v38, v39
  v_cvt_pk_bf16_f32 v36, v40, v41
  v_cvt_pk_bf16_f32 v37, v42, v43
  v_cvt_pk_bf16_f32 v38, v44, v45
  s_waitcnt lgkmcnt(7)
  v_mfma_f32_32x32x16_bf16 v[48:63], v[172:175], v[92:95], v[48:63]
  ds_read_b64_tr_b16 v[92:93], v9 offset:51200
  ds_read_b64_tr_b16 v[94:95], v9 offset:51712
  v_cvt_pk_bf16_f32 v39, v46, v47
  v_mfma_f32_32x32x16_bf16 v[96:111], v[112:115], v[32:35], 0
  s_nop 0
  v_mfma_f32_32x32x16_bf16 v[64:79], v[116:119], v[36:39], 0
  s_waitcnt lgkmcnt(7)
  v_mfma_f32_32x32x16_bf16 v[48:63], v[176:179], v[80:83], v[48:63]
  ds_read_b64_tr_b16 v[80:81], v10 offset:0
  ds_read_b64_tr_b16 v[82:83], v10 offset:512
  s_waitcnt lgkmcnt(6)
  v_mfma_f32_32x32x16_bf16 v[48:63], v[180:183], v[84:87], v[48:63]
  ds_read_b64_tr_b16 v[84:85], v10 offset:2048
  ds_read_b64_tr_b16 v[86:87], v10 offset:2560
  s_waitcnt lgkmcnt(6)
  v_mfma_f32_32x32x16_bf16 v[48:63], v[184:187], v[88:91], v[48:63]
  ds_read_b64_tr_b16 v[88:89], v11 offset:0
  ds_read_b64_tr_b16 v[90:91], v11 offset:512
  v_max3_f32 v26, v96, v97, v98
  v_max3_f32 v31, v99, v100, v101
  v_max3_f32 v26, v26, v102, v103
  v_max3_f32 v31, v31, v104, v105
  v_max3_f32 v26, v26, v106, v107
  v_max3_f32 v31, v31, v108, v109
  s_waitcnt lgkmcnt(6)
  v_mfma_f32_32x32x16_bf16 v[48:63], v[188:191], v[92:95], v[48:63]
  ds_read_b64_tr_b16 v[92:93], v11 offset:2048
  ds_read_b64_tr_b16 v[94:95], v11 offset:2560
  v_max3_f32 v26, v26, v110, v111
  v_max_f32 v26, v26, v31
  v_mul_f32_e64 v26, -v26, v15
  v_fma_f32 v96, v96, v15, v26
  v_fma_f32 v97, v97, v15, v26
  v_fma_f32 v98, v98, v15, v26
  s_waitcnt lgkmcnt(6)
  v_mfma_f32_32x32x16_bf16 v[48:63], v[192:195], v[80:83], v[48:63]
  v_mfma_f32_16x16x32_bf16 v[124:127], v[120:123], v[80:83], v[124:127]
  ds_read_b64_tr_b16 v[80:81], v12 offset:0
  ds_read_b64_tr_b16 v[82:83], v12 offset:512
  v_fma_f32 v99, v99, v15, v26
  v_fma_f32 v100, v100, v15, v26
  v_fma_f32 v101, v101, v15, v26
  v_fma_f32 v102, v102, v15, v26
  v_fma_f32 v103, v103, v15, v26
  v_fma_f32 v104, v104, v15, v26
  s_waitcnt lgkmcnt(6)
  v_mfma_f32_32x32x16_bf16 v[48:63], v[196:199], v[84:87], v[48:63]
  v_mfma_f32_16x16x32_bf16 v[124:127], v[120:123], v[84:87], v[124:127]
  ds_read_b64_tr_b16 v[84:85], v12 offset:2048
  ds_read_b64_tr_b16 v[86:87], v12 offset:2560
  v_fma_f32 v105, v105, v15, v26
  v_fma_f32 v106, v106, v15, v26
  v_fma_f32 v107, v107, v15, v26
  v_fma_f32 v108, v108, v15, v26
  v_fma_f32 v109, v109, v15, v26
  v_fma_f32 v110, v110, v15, v26
  s_waitcnt lgkmcnt(6)
  v_mfma_f32_32x32x16_bf16 v[48:63], v[200:203], v[88:91], v[48:63]
  s_waitcnt vmcnt(8)
  s_waitcnt vmcnt(2)
  s_barrier
  ds_read_b64_tr_b16 v[88:89], v13 offset:0
  ds_read_b64_tr_b16 v[90:91], v13 offset:512
  s_add_u32 m0, s61, 0x20000
  s_mul_i32 s89, s100, 458752
  s_add_u32 s89, s89, s7
  s_add_u32 s62, s89, 0x0
  buffer_load_dwordx4 v3, s[16:19], s62 offen lds
  s_add_u32 m0, s61, 0x20400
  s_add_u32 s62, s89, 0x7000
  buffer_load_dwordx4 v3, s[16:19], s62 offen lds
  v_fma_f32 v111, v111, v15, v26
  v_exp_f32 v96, v96
  v_exp_f32 v97, v97
  v_exp_f32 v98, v98
  s_waitcnt lgkmcnt(6)
  v_mfma_f32_32x32x16_bf16 v[48:63], v[204:207], v[92:95], v[48:63]
  ds_read_b64_tr_b16 v[92:93], v13 offset:2048
  ds_read_b64_tr_b16 v[94:95], v13 offset:2560
  v_exp_f32 v99, v99
  v_exp_f32 v100, v100
  v_exp_f32 v101, v101
  s_waitcnt lgkmcnt(6)
  v_mfma_f32_32x32x16_bf16 v[48:63], v[208:211], v[80:83], v[48:63]
  ds_read_b64_tr_b16 v[80:81], v6 offset:0
  ds_read_b64_tr_b16 v[82:83], v6 offset:512
  s_add_u32 m0, s61, 0x10000
  s_mul_i32 s89, s101, 458752
  s_add_u32 s89, s89, s7
  s_add_u32 s62, s89, 0x0
  buffer_load_dwordx4 v3, s[16:19], s62 offen lds
  v_exp_f32 v102, v102
  v_exp_f32 v103, v103
  v_exp_f32 v104, v104
  s_waitcnt lgkmcnt(6)
  v_mfma_f32_32x32x16_bf16 v[48:63], v[212:215], v[84:87], v[48:63]
  ds_read_b64_tr_b16 v[84:85], v6 offset:2048
  ds_read_b64_tr_b16 v[86:87], v6 offset:2560
  v_exp_f32 v105, v105
  v_exp_f32 v106, v106
  v_exp_f32 v107, v107
  s_waitcnt lgkmcnt(6)
  v_mfma_f32_32x32x16_bf16 v[48:63], v[216:219], v[88:91], v[48:63]
  ds_read_b64_tr_b16 v[88:89], v7 offset:0
  ds_read_b64_tr_b16 v[90:91], v7 offset:512
  s_add_u32 m0, s61, 0x10400
  s_add_u32 s62, s89, 0x7000
  buffer_load_dwordx4 v3, s[16:19], s62 offen lds
  v_exp_f32 v108, v108
  v_exp_f32 v109, v109
  v_exp_f32 v110, v110
  s_waitcnt lgkmcnt(6)
  v_mfma_f32_32x32x16_bf16 v[48:63], v[220:223], v[92:95], v[48:63]
  ds_read_b64_tr_b16 v[92:93], v7 offset:2048
  ds_read_b64_tr_b16 v[94:95], v7 offset:2560
  v_exp_f32 v111, v111
  v_add_f32 v26, v96, v97
  v_add_f32 v31, v98, v99
  v_add_f32 v26, v26, v100
  v_add_f32 v31, v31, v101
  s_waitcnt lgkmcnt(6)
  v_mfma_f32_32x32x16_bf16 v[48:63], v[224:227], v[80:83], v[48:63]
  v_mfma_f32_16x16x32_bf16 v[124:127], v[120:123], v[80:83], v[124:127]
  ds_read_b64_tr_b16 v[80:81], v8 offset:0
  ds_read_b64_tr_b16 v[82:83], v8 offset:512
  v_add_f32 v26, v26, v102
  v_add_f32 v31, v31, v103
  v_add_f32 v26, v26, v104
  v_add_f32 v31, v31, v105
  v_add_f32 v26, v26, v106
  v_add_f32 v31, v31, v107
  s_waitcnt lgkmcnt(6)
  v_mfma_f32_32x32x16_bf16 v[48:63], v[228:231], v[84:87], v[48:63]
  v_mfma_f32_16x16x32_bf16 v[124:127], v[120:123], v[84:87], v[124:127]
  ds_read_b64_tr_b16 v[84:85], v8 offset:2048
  ds_read_b64_tr_b16 v[86:87], v8 offset:2560
  v_add_f32 v26, v26, v108
  v_add_f32 v31, v31, v109
  v_add_f32 v26, v26, v110
  v_add_f32 v31, v31, v111
  v_add_f32 v26, v26, v31
  v_rcp_f32 v26, v26
  s_waitcnt lgkmcnt(6)
  v_mfma_f32_32x32x16_bf16 v[48:63], v[232:235], v[88:91], v[48:63]
  ds_read_b64_tr_b16 v[88:89], v9 offset:0
  ds_read_b64_tr_b16 v[90:91], v9 offset:512
  v_mul_f32 v96, v96, v26
  v_mul_f32 v97, v97, v26
  v_mul_f32 v98, v98, v26
  v_mul_f32 v99, v99, v26
  v_mul_f32 v100, v100, v26
  v_mul_f32 v101, v101, v26
  s_waitcnt lgkmcnt(6)
  v_mfma_f32_32x32x16_bf16 v[48:63], v[236:239], v[92:95], v[48:63]
  ds_read_b64_tr_b16 v[92:93], v9 offset:2048
  ds_read_b64_tr_b16 v[94:95], v9 offset:2560
  s_lshl_b32 s3, s49, 2
  s_add_u32 s3, s3, 156160
  v_add_u32 v125, s3, v1
  ds_write_b32 v125, v124
  v_mul_f32 v102, v102, v26
  v_mul_f32 v103, v103, v26
  v_mul_f32 v104, v104, v26
  v_mul_f32 v105, v105, v26
  v_mul_f32 v106, v106, v26
  v_mul_f32 v107, v107, v26
  s_waitcnt lgkmcnt(7)
  v_mfma_f32_32x32x16_bf16 v[48:63], v[240:243], v[80:83], v[48:63]
  v_mul_f32 v108, v108, v26
  v_mul_f32 v109, v109, v26
  v_mul_f32 v110, v110, v26
  v_mul_f32 v111, v111, v26
  v_cvt_pk_bf16_f32 v40, v96, v97
  v_cvt_pk_bf16_f32 v41, v98, v99
  s_waitcnt lgkmcnt(5)
  v_mfma_f32_32x32x16_bf16 v[48:63], v[244:247], v[84:87], v[48:63]
  v_cvt_pk_bf16_f32 v42, v100, v101
  v_cvt_pk_bf16_f32 v43, v102, v103
  v_cvt_pk_bf16_f32 v44, v104, v105
  v_cvt_pk_bf16_f32 v45, v106, v107
  v_cvt_pk_bf16_f32 v46, v108, v109
  v_cvt_pk_bf16_f32 v47, v110, v111
  s_waitcnt lgkmcnt(3)
  v_mfma_f32_32x32x16_bf16 v[48:63], v[248:251], v[88:91], v[48:63]
  buffer_load_dword v27, v30, s[40:43], 0 offen offset:128 sc1
  ds_write_b128 v25, v[40:43] offset:0
  ds_write_b128 v24, v[44:47] offset:0
  v_max3_f32 v26, v64, v65, v66
  v_max3_f32 v31, v67, v68, v69
  v_max3_f32 v26, v26, v70, v71
  v_max3_f32 v31, v31, v72, v73
  v_max3_f32 v26, v26, v74, v75
  s_waitcnt lgkmcnt(3)
  v_mfma_f32_32x32x16_bf16 v[48:63], v[252:255], v[92:95], v[48:63]
  v_max3_f32 v31, v31, v76, v77
  v_max3_f32 v26, v26, v78, v79
  v_max_f32 v26, v26, v31
  v_mul_f32_e64 v26, -v26, v15
  s_waitcnt lgkmcnt(0)
  s_barrier
  v_lshlrev_b32 v80, 2, v30
  s_add_u32 m0, s61, 0x14000
  s_add_u32 s62, s68, 0xf0000
  buffer_load_dwordx4 v4, s[20:23], s62 offen lds
  s_add_u32 m0, s61, 0x14400
  s_add_u32 s62, s68, 0xf2000
  buffer_load_dwordx4 v4, s[20:23], s62 offen lds
  s_add_u32 m0, s61, 0x4000
  s_add_u32 s62, s68, 0x40000
  buffer_load_dwordx4 v4, s[20:23], s62 offen lds
  v_add_u32 v80, 156160, v80
  ds_read_b128 v[80:83], v80
  s_waitcnt lgkmcnt(0)
  v_add_f32 v80, v80, v81
  v_add_f32 v82, v82, v83
  v_add_f32 v80, v80, v82
  v_cvt_pk_bf16_f32 v81, v80, v80
  v_and_b32 v16, 0xffff0000, v81
  v_sub_f32 v80, v80, v16
  v_cvt_pk_bf16_f32 v17, v80, v80
  s_nop 1
  v_mfma_f32_32x32x16_bf16 v[48:63], v[18:21], v[16:19], v[48:63]
  s_waitcnt vmcnt(3)
  v_pk_fma_f32 v[64:65], v[64:65], v[14:15], v[26:27] op_sel:[0,1,0] op_sel_hi:[1,1,0]
  v_pk_fma_f32 v[66:67], v[66:67], v[14:15], v[26:27] op_sel:[0,1,0] op_sel_hi:[1,1,0]
  v_pk_fma_f32 v[68:69], v[68:69], v[14:15], v[26:27] op_sel:[0,1,0] op_sel_hi:[1,1,0]
  v_pk_fma_f32 v[70:71], v[70:71], v[14:15], v[26:27] op_sel:[0,1,0] op_sel_hi:[1,1,0]
  v_pk_fma_f32 v[72:73], v[72:73], v[14:15], v[26:27] op_sel:[0,1,0] op_sel_hi:[1,1,0]
  v_pk_fma_f32 v[74:75], v[74:75], v[14:15], v[26:27] op_sel:[0,1,0] op_sel_hi:[1,1,0]
  v_pk_fma_f32 v[76:77], v[76:77], v[14:15], v[26:27] op_sel:[0,1,0] op_sel_hi:[1,1,0]
  v_pk_fma_f32 v[78:79], v[78:79], v[14:15], v[26:27] op_sel:[0,1,0] op_sel_hi:[1,1,0]
  v_exp_f32 v64, v64
  v_exp_f32 v65, v65
  v_exp_f32 v66, v66
  v_exp_f32 v67, v67
  s_add_u32 m0, s61, 0x4400
  s_add_u32 s62, s68, 0x42000
  buffer_load_dwordx4 v4, s[20:23], s62 offen lds
  v_exp_f32 v68, v68
  v_exp_f32 v69, v69
  v_exp_f32 v70, v70
  v_exp_f32 v71, v71
  v_exp_f32 v72, v72
  v_exp_f32 v73, v73
  v_exp_f32 v74, v74
  v_exp_f32 v75, v75
  v_exp_f32 v76, v76
  v_exp_f32 v77, v77
  v_exp_f32 v78, v78
  v_exp_f32 v79, v79
  v_pk_add_f32 v[112:113], v[64:65], v[66:67] op_sel:[0,0] op_sel_hi:[1,1]
  v_pk_add_f32 v[114:115], v[68:69], v[70:71] op_sel:[0,0] op_sel_hi:[1,1]
  v_pk_add_f32 v[112:113], v[112:113], v[72:73] op_sel:[0,0] op_sel_hi:[1,1]
  v_pk_add_f32 v[114:115], v[114:115], v[74:75] op_sel:[0,0] op_sel_hi:[1,1]
  v_pk_add_f32 v[112:113], v[112:113], v[76:77] op_sel:[0,0] op_sel_hi:[1,1]
  v_pk_add_f32 v[114:115], v[114:115], v[78:79] op_sel:[0,0] op_sel_hi:[1,1]
  v_pk_add_f32 v[112:113], v[112:113], v[114:115] op_sel:[0,0] op_sel_hi:[1,1]
  v_add_f32 v26, v112, v113
  v_rcp_f32 v26, v26
  s_nop 0
  v_pk_mul_f32 v[64:65], v[64:65], v[26:27] op_sel:[0,0] op_sel_hi:[1,0]
  v_pk_mul_f32 v[66:67], v[66:67], v[26:27] op_sel:[0,0] op_sel_hi:[1,0]
  v_pk_mul_f32 v[68:69], v[68:69], v[26:27] op_sel:[0,0] op_sel_hi:[1,0]
  v_pk_mul_f32 v[70:71], v[70:71], v[26:27] op_sel:[0,0] op_sel_hi:[1,0]
  v_pk_mul_f32 v[72:73], v[72:73], v[26:27] op_sel:[0,0] op_sel_hi:[1,0]
  v_pk_mul_f32 v[74:75], v[74:75], v[26:27] op_sel:[0,0] op_sel_hi:[1,0]
  v_pk_mul_f32 v[76:77], v[76:77], v[26:27] op_sel:[0,0] op_sel_hi:[1,0]
  v_pk_mul_f32 v[78:79], v[78:79], v[26:27] op_sel:[0,0] op_sel_hi:[1,0]
  v_cvt_pk_bf16_f32 v40, v64, v65
  v_cvt_pk_bf16_f32 v41, v66, v67
  v_cvt_pk_bf16_f32 v42, v68, v69
  v_cvt_pk_bf16_f32 v43, v70, v71
  v_cvt_pk_bf16_f32 v44, v72, v73
  v_cvt_pk_bf16_f32 v45, v74, v75
  v_cvt_pk_bf16_f32 v46, v76, v77
  v_cvt_pk_bf16_f32 v47, v78, v79
  ds_write_b128 v25, v[40:43] offset:2048
  ds_write_b128 v24, v[44:47] offset:2048
  v_lshrrev_b32 v26, 5, v0
  v_lshlrev_b32 v26, 4, v26
  s_lshl_b32 s4, s49, 7
  s_add_u32 s4, s4, 149504
  v_add_u32 v31, s4, v26
  ds_read_b128 v[96:99], v31 offset:0
  ds_read_b128 v[100:103], v31 offset:32
  ds_read_b128 v[104:107], v31 offset:64
  ds_read_b128 v[108:111], v31 offset:96
  v_bfe_u32 v25, v0, 2, 2
  v_lshlrev_b32 v25, 6, v25
  v_lshl_add_u32 v25, v26, 4, v25
  v_bfe_u32 v31, v0, 4, 1
  v_cmp_eq_u32 s[94:95], 1, v31
  v_lshrrev_b32 v24, 5, v0
  v_xor_b32 v31, v24, v31
  v_lshl_add_u32 v25, v31, 5, v25
  v_lshrrev_b32 v24, 2, v0
  v_xor_b32 v24, v24, v0
  v_bfe_u32 v24, v24, 1, 1
  v_lshl_add_u32 v25, v24, 4, v25
  v_and_b32 v31, 1, v0
  v_lshl_add_u32 v25, v31, 3, v25
  v_add_u32 v25, s72, v25
  v_mov_b32 v31, s60
  ds_read_b64_tr_b16 v[112:113], v25 offset:2048
  ds_read_b64_tr_b16 v[114:115], v25 offset:2560
  ds_read_b64_tr_b16 v[116:117], v25 offset:3072
  ds_read_b64_tr_b16 v[118:119], v25 offset:3584
  s_waitcnt lgkmcnt(7)
  v_pk_mul_f32 v[48:49], v[48:49], v[96:97] op_sel:[0,0] op_sel_hi:[1,1]
  v_pk_mul_f32 v[50:51], v[50:51], v[98:99] op_sel:[0,0] op_sel_hi:[1,1]
  s_waitcnt lgkmcnt(6)
  v_pk_mul_f32 v[52:53], v[52:53], v[100:101] op_sel:[0,0] op_sel_hi:[1,1]
  v_pk_mul_f32 v[54:55], v[54:55], v[102:103] op_sel:[0,0] op_sel_hi:[1,1]
  s_waitcnt lgkmcnt(5)
  v_pk_mul_f32 v[56:57], v[56:57], v[104:105] op_sel:[0,0] op_sel_hi:[1,1]
  v_pk_mul_f32 v[58:59], v[58:59], v[106:107] op_sel:[0,0] op_sel_hi:[1,1]
  s_waitcnt lgkmcnt(4)
  v_pk_mul_f32 v[60:61], v[60:61], v[108:109] op_sel:[0,0] op_sel_hi:[1,1]
  v_pk_mul_f32 v[62:63], v[62:63], v[110:111] op_sel:[0,0] op_sel_hi:[1,1]
  v_cvt_pk_bf16_f32 v48, v48, v49
  v_cvt_pk_bf16_f32 v49, v50, v51
  v_cvt_pk_bf16_f32 v50, v52, v53
  v_cvt_pk_bf16_f32 v51, v54, v55
  v_cvt_pk_bf16_f32 v52, v56, v57
  v_cvt_pk_bf16_f32 v53, v58, v59
  v_cvt_pk_bf16_f32 v54, v60, v61
  v_cvt_pk_bf16_f32 v55, v62, v63
  ds_read_b64_tr_b16 v[56:57], v25 offset:0
  ds_read_b64_tr_b16 v[58:59], v25 offset:512
  ds_read_b64_tr_b16 v[60:61], v25 offset:1024
  ds_read_b64_tr_b16 v[62:63], v25 offset:1536
  v_cndmask_b32 v40, v31, v48, s[94:95]
  v_cndmask_b32 v41, v31, v49, s[94:95]
  v_cndmask_b32 v42, v31, v50, s[94:95]
  v_cndmask_b32 v43, v31, v51, s[94:95]
  v_cndmask_b32 v44, v31, v52, s[94:95]
  v_cndmask_b32 v45, v31, v53, s[94:95]
  v_cndmask_b32 v46, v31, v54, s[94:95]
  v_cndmask_b32 v47, v31, v55, s[94:95]
  v_cndmask_b32 v32, v48, v31, s[94:95]
  v_cndmask_b32 v33, v49, v31, s[94:95]
  v_cndmask_b32 v34, v50, v31, s[94:95]
  v_cndmask_b32 v35, v51, v31, s[94:95]
  v_cndmask_b32 v36, v52, v31, s[94:95]
  v_cndmask_b32 v37, v53, v31, s[94:95]
  v_cndmask_b32 v38, v54, v31, s[94:95]
  v_cndmask_b32 v39, v55, v31, s[94:95]
  s_waitcnt lgkmcnt(2)
  v_mfma_f32_32x32x16_bf16 v[96:111], v[32:35], v[56:59], 0
  s_waitcnt lgkmcnt(0)
  v_mfma_f32_32x32x16_bf16 v[96:111], v[36:39], v[60:63], v[96:111]
  v_mfma_f32_32x32x16_bf16 v[48:63], v[40:43], v[112:115], 0
  v_mfma_f32_32x32x16_bf16 v[48:63], v[44:47], v[116:119], v[48:63]
  v_add_u32 v25, s72, v1
  s_lshl_b32 s4, s48, 9
  s_add_u32 s4, s4, 158208
  v_lshlrev_b32 v26, 2, v0
  v_add_u32 v26, s4, v26
  s_nop 4
  ds_write_b128 v25, v[96:99]
  ds_write_b128 v25, v[100:103] offset:1024
  ds_write_b32 v26, v104
  ds_write_b128 v25, v[56:59] offset:2048
  ds_write_b128 v25, v[60:63] offset:3072
  ds_write_b32 v26, v48 offset:256
  s_lshl_b32 s4, s49, 10
  s_add_u32 s4, s4, 32768
  v_add_u32 v25, s4, v1
  s_lshr_b32 s4, s49, 1
  s_lshl_b32 s4, s4, 8
  s_add_u32 s4, s4, 158208
  v_add_u32 v26, s4, v30
  v_cmp_ne_u32 vcc, 0, v27
  s_nop 0
  s_andn2_b32 s3, 0xffffffff, vcc_lo
  s_cbranch_scc1 L40
L41:
  ds_read_b64_tr_b16 v[80:81], v10 offset:32768
  ds_read_b64_tr_b16 v[82:83], v10 offset:33280
  ds_read_b64_tr_b16 v[84:85], v10 offset:34816
  ds_read_b64_tr_b16 v[86:87], v10 offset:35328
  ds_read_b64_tr_b16 v[88:89], v11 offset:32768
  ds_read_b64_tr_b16 v[90:91], v11 offset:33280
  ds_read_b64_tr_b16 v[92:93], v11 offset:34816
  ds_read_b64_tr_b16 v[94:95], v11 offset:35328
  s_waitcnt vmcnt(2)
  s_waitcnt lgkmcnt(8)
  s_barrier
  s_waitcnt lgkmcnt(6)
  v_mfma_f32_32x32x16_bf16 v[64:79], v[80:83], v[128:131], 0
  v_mfma_f32_16x16x32_bf16 v[124:127], v[120:123], v[80:83], 0
  ds_read_b64_tr_b16 v[80:81], v12 offset:32768
  ds_read_b64_tr_b16 v[82:83], v12 offset:33280
  ds_read_b128 v[96:99], v25 offset:0
  ds_read_b128 v[100:103], v25 offset:4096
  ds_read_b128 v[104:107], v25 offset:8192
  ds_read_b128 v[108:111], v25 offset:12288
  ds_read_b32 v32, v26 offset:0
  ds_read_b32 v33, v26 offset:512
  ds_read_b32 v34, v26 offset:1024
  ds_read_b32 v35, v26 offset:1536
  v_lshrrev_b32 v25, 5, v0
  v_lshl_add_u32 v25, v25, 9, v30
  s_lshl_b32 s5, s57, 10
  v_add_u32 v25, s5, v25
  v_lshrrev_b32 v31, 4, v0
  s_waitcnt lgkmcnt(14)
  v_mfma_f32_32x32x16_bf16 v[64:79], v[84:87], v[132:135], v[64:79]
  v_mfma_f32_16x16x32_bf16 v[124:127], v[120:123], v[84:87], v[124:127]
  ds_read_b64_tr_b16 v[84:85], v12 offset:34816
  ds_read_b64_tr_b16 v[86:87], v12 offset:35328
  v_cmp_eq_u32 s[94:95], s57, v31
  v_mov_b32 v31, 1073741824
  s_and_b32 s5, s52, 1
  s_mul_i32 s5, s5, 10240
  s_add_u32 s5, s5, 0
  s_add_u32 s2, s74, s5
  s_lshl_b32 s4, s51, 7
  s_add_u32 s71, s71, s4
  v_cndmask_b32 v26, v31, v30, s[94:95]
  s_waitcnt lgkmcnt(8)
  v_add_f32 v96, v96, v100
  s_waitcnt lgkmcnt(6)
  v_add_f32 v104, v104, v108
  v_mfma_f32_32x32x16_bf16 v[64:79], v[88:91], v[136:139], v[64:79]
  ds_read_b64_tr_b16 v[88:89], v13 offset:32768
  ds_read_b64_tr_b16 v[90:91], v13 offset:33280
  v_add_f32 v97, v97, v101
  v_add_f32 v105, v105, v109
  v_add_f32 v98, v98, v102
  v_add_f32 v106, v106, v110
  v_add_f32 v99, v99, v103
  v_add_f32 v107, v107, v111
  v_add_f32 v96, v96, v104
  v_add_f32 v97, v97, v105
  v_mfma_f32_32x32x16_bf16 v[64:79], v[92:95], v[140:143], v[64:79]
  ds_read_b64_tr_b16 v[92:93], v13 offset:34816
  ds_read_b64_tr_b16 v[94:95], v13 offset:35328
  v_add_f32 v98, v98, v106
  v_add_f32 v99, v99, v107
  s_waitcnt lgkmcnt(8)
  v_add_f32 v32, v32, v33
  s_waitcnt lgkmcnt(6)
  v_add_f32 v34, v34, v35
  v_add_f32 v32, v32, v34
  buffer_atomic_add_f32 v96, v25, s[44:47], s70 offen offset:0
  buffer_atomic_add_f32 v97, v25, s[44:47], s70 offen offset:128
  buffer_atomic_add_f32 v98, v25, s[44:47], s70 offen offset:256
  buffer_atomic_add_f32 v99, v25, s[44:47], s70 offen offset:384
  buffer_atomic_add_f32 v32, v26, s[44:47], s70 offen offset:2048
  v_mfma_f32_32x32x16_bf16 v[64:79], v[80:83], v[144:147], v[64:79]
  ds_read_b64_tr_b16 v[80:81], v10 offset:16384
  ds_read_b64_tr_b16 v[82:83], v10 offset:16896
  s_waitcnt lgkmcnt(6)
  v_mfma_f32_32x32x16_bf16 v[64:79], v[84:87], v[148:151], v[64:79]
  ds_read_b64_tr_b16 v[84:85], v10 offset:18432
  ds_read_b64_tr_b16 v[86:87], v10 offset:18944
  s_waitcnt lgkmcnt(6)
  v_mfma_f32_32x32x16_bf16 v[64:79], v[88:91], v[152:155], v[64:79]
  ds_read_b64_tr_b16 v[88:89], v11 offset:16384
  ds_read_b64_tr_b16 v[90:91], v11 offset:16896
  v_bfe_u32 v5, v0, 2, 2
  v_lshrrev_b32 v24, 5, v0
  v_lshl_add_u32 v5, v24, 2, v5
  v_lshlrev_b32 v5, 7, v5
  v_bfe_u32 v24, v0, 3, 1
  v_lshl_add_u32 v5, v24, 6, v5
  v_bfe_u32 v24, v0, 4, 1
  v_lshl_add_u32 v5, v24, 5, v5
  v_and_b32 v24, 3, v0
  v_lshl_add_u32 v5, v24, 3, v5
  s_lshl_b32 s3, s56, 6
  v_xor_b32 v5, s3, v5
  s_lshl_b32 s3, s57, 10
  v_add_u32 v24, s3, v1
  s_waitcnt lgkmcnt(6)
  v_mfma_f32_32x32x16_bf16 v[64:79], v[92:95], v[156:159], v[64:79]
  ds_read_b64_tr_b16 v[92:93], v11 offset:18432
  ds_read_b64_tr_b16 v[94:95], v11 offset:18944
  ds_read_b64_tr_b16 v[128:129], v5 offset:0
  ds_read_b64_tr_b16 v[130:131], v5 offset:1024
  ds_read_b64_tr_b16 v[132:133], v5 offset:2048
  ds_read_b64_tr_b16 v[134:135], v5 offset:3072
  ds_read_b64_tr_b16 v[136:137], v5 offset:4096
  ds_read_b64_tr_b16 v[138:139], v5 offset:5120
  ds_read_b64_tr_b16 v[140:141], v5 offset:6144
  ds_read_b64_tr_b16 v[142:143], v5 offset:7168
  s_waitcnt lgkmcnt(14)
  v_mfma_f32_32x32x16_bf16 v[64:79], v[80:83], v[160:163], v[64:79]
  v_mfma_f32_16x16x32_bf16 v[124:127], v[120:123], v[80:83], v[124:127]
  ds_read_b64_tr_b16 v[80:81], v12 offset:16384
  ds_read_b64_tr_b16 v[82:83], v12 offset:16896
  ds_read_b64_tr_b16 v[144:145], v5 offset:8192
  ds_read_b64_tr_b16 v[146:147], v5 offset:9216
  ds_read_b64_tr_b16 v[148:149], v5 offset:10240
  ds_read_b64_tr_b16 v[150:151], v5 offset:11264
  ds_read_b64_tr_b16 v[152:153], v5 offset:12288
  ds_read_b64_tr_b16 v[154:155], v5 offset:13312
  ds_read_b64_tr_b16 v[156:157], v5 offset:14336
  ds_read_b64_tr_b16 v[158:159], v5 offset:15360
  s_waitcnt lgkmcnt(15)
  v_mfma_f32_32x32x16_bf16 v[64:79], v[84:87], v[164:167], v[64:79]
  v_mfma_f32_16x16x32_bf16 v[124:127], v[120:123], v[84:87], v[124:127]
  ds_read_b64_tr_b16 v[84:85], v12 offset:18432
  ds_read_b64_tr_b16 v[86:87], v12 offset:18944
  v_mfma_f32_32x32x16_bf16 v[64:79], v[88:91], v[168:171], v[64:79]
  ds_read_b64_tr_b16 v[88:89], v13 offset:16384
  ds_read_b64_tr_b16 v[90:91], v13 offset:16896
  v_mfma_f32_32x32x16_bf16 v[64:79], v[92:95], v[172:175], v[64:79]
  s_waitcnt lgkmcnt(4)
  s_barrier
  ds_read_b64_tr_b16 v[92:93], v13 offset:18432
  ds_read_b64_tr_b16 v[94:95], v13 offset:18944
  v_mfma_f32_32x32x16_bf16 v[64:79], v[80:83], v[176:179], v[64:79]
  ds_read_b64_tr_b16 v[80:81], v10 offset:49152
  ds_read_b64_tr_b16 v[82:83], v10 offset:49664
  s_add_u32 m0, s61, 0x0
  s_add_u32 s62, s68, 0x120000
  buffer_load_dwordx4 v4, s[20:23], s62 offen lds
  s_add_u32 m0, s61, 0x400
  s_add_u32 s62, s68, 0x122000
  buffer_load_dwordx4 v4, s[20:23], s62 offen lds
  s_waitcnt lgkmcnt(6)
  v_mfma_f32_32x32x16_bf16 v[64:79], v[84:87], v[180:183], v[64:79]
  ds_read_b64_tr_b16 v[84:85], v10 offset:51200
  ds_read_b64_tr_b16 v[86:87], v10 offset:51712
  s_waitcnt lgkmcnt(6)
  v_mfma_f32_32x32x16_bf16 v[64:79], v[88:91], v[184:187], v[64:79]
  ds_read_b64_tr_b16 v[88:89], v11 offset:49152
  ds_read_b64_tr_b16 v[90:91], v11 offset:49664
  s_add_u32 m0, s61, 0x1c000
  s_add_u32 s62, s68, 0x20000
  buffer_load_dwordx4 v4, s[20:23], s62 offen lds
  s_waitcnt lgkmcnt(6)
  v_mfma_f32_32x32x16_bf16 v[64:79], v[92:95], v[188:191], v[64:79]
  ds_read_b64_tr_b16 v[92:93], v11 offset:51200
  ds_read_b64_tr_b16 v[94:95], v11 offset:51712
  v_add_u32 v5, 0x14000, v5
  ds_read_b64_tr_b16 v[160:161], v5 offset:0
  ds_read_b64_tr_b16 v[162:163], v5 offset:1024
  ds_read_b64_tr_b16 v[164:165], v5 offset:2048
  ds_read_b64_tr_b16 v[166:167], v5 offset:3072
  ds_read_b64_tr_b16 v[168:169], v5 offset:4096
  ds_read_b64_tr_b16 v[170:171], v5 offset:5120
  ds_read_b64_tr_b16 v[172:173], v5 offset:6144
  ds_read_b64_tr_b16 v[174:175], v5 offset:7168
  s_waitcnt lgkmcnt(14)
  v_mfma_f32_32x32x16_bf16 v[64:79], v[80:83], v[192:195], v[64:79]
  v_mfma_f32_16x16x32_bf16 v[124:127], v[120:123], v[80:83], v[124:127]
  ds_read_b64_tr_b16 v[80:81], v12 offset:49152
  ds_read_b64_tr_b16 v[82:83], v12 offset:49664
  s_add_u32 m0, s61, 0x1c400
  s_add_u32 s62, s68, 0x22000
  buffer_load_dwordx4 v4, s[20:23], s62 offen lds
  ds_read_b64_tr_b16 v[176:177], v5 offset:8192
  ds_read_b64_tr_b16 v[178:179], v5 offset:9216
  ds_read_b64_tr_b16 v[180:181], v5 offset:10240
  ds_read_b64_tr_b16 v[182:183], v5 offset:11264
  ds_read_b64_tr_b16 v[184:185], v5 offset:12288
  ds_read_b64_tr_b16 v[186:187], v5 offset:13312
  ds_read_b64_tr_b16 v[188:189], v5 offset:14336
  ds_read_b64_tr_b16 v[190:191], v5 offset:15360
  s_waitcnt lgkmcnt(15)
  v_mfma_f32_32x32x16_bf16 v[64:79], v[84:87], v[196:199], v[64:79]
  v_mfma_f32_16x16x32_bf16 v[124:127], v[120:123], v[84:87], v[124:127]
  ds_read_b64_tr_b16 v[84:85], v12 offset:51200
  ds_read_b64_tr_b16 v[86:87], v12 offset:51712
  s_waitcnt vmcnt(4)
  buffer_store_dword v10, v28, s[44:47], s71 offen offset:0 sc1
  v_mfma_f32_32x32x16_bf16 v[64:79], v[88:91], v[200:203], v[64:79]
  ds_read_b64_tr_b16 v[88:89], v13 offset:49152
  ds_read_b64_tr_b16 v[90:91], v13 offset:49664
  s_add_u32 m0, s61, 0x8000
  s_add_u32 s62, s68, 0x100000
  buffer_load_dwordx4 v4, s[20:23], s62 offen lds
  v_mfma_f32_32x32x16_bf16 v[64:79], v[92:95], v[204:207], v[64:79]
  ds_read_b64_tr_b16 v[92:93], v13 offset:51200
  ds_read_b64_tr_b16 v[94:95], v13 offset:51712
  s_waitcnt lgkmcnt(14)
  v_mfma_f32_32x32x16_bf16 v[64:79], v[80:83], v[208:211], v[64:79]
  s_waitcnt lgkmcnt(6)
  s_barrier
  ds_read_b64_tr_b16 v[80:81], v6 offset:49152
  ds_read_b64_tr_b16 v[82:83], v6 offset:49664
  s_add_u32 m0, s61, 0x8400
  s_add_u32 s62, s68, 0x102000
  buffer_load_dwordx4 v4, s[20:23], s62 offen lds
  s_waitcnt lgkmcnt(6)
  v_mfma_f32_32x32x16_bf16 v[64:79], v[84:87], v[212:215], v[64:79]
  ds_read_b64_tr_b16 v[84:85], v6 offset:51200
  ds_read_b64_tr_b16 v[86:87], v6 offset:51712
  s_waitcnt lgkmcnt(6)
  v_mfma_f32_32x32x16_bf16 v[64:79], v[88:91], v[216:219], v[64:79]
  ds_read_b64_tr_b16 v[88:89], v7 offset:49152
  ds_read_b64_tr_b16 v[90:91], v7 offset:49664
  s_add_u32 m0, s61, 0xc000
  s_add_u32 s62, s68, 0x50000
  buffer_load_dwordx4 v4, s[20:23], s62 offen lds
  s_waitcnt lgkmcnt(6)
  v_mfma_f32_32x32x16_bf16 v[64:79], v[92:95], v[220:223], v[64:79]
  ds_read_b64_tr_b16 v[92:93], v7 offset:51200
  ds_read_b64_tr_b16 v[94:95], v7 offset:51712
  v_add_u32 v5, 0xffff0000, v5
  ds_read_b64_tr_b16 v[192:193], v5 offset:0
  ds_read_b64_tr_b16 v[194:195], v5 offset:1024
  ds_read_b64_tr_b16 v[196:197], v5 offset:2048
  ds_read_b64_tr_b16 v[198:199], v5 offset:3072
  ds_read_b64_tr_b16 v[200:201], v5 offset:4096
  ds_read_b64_tr_b16 v[202:203], v5 offset:5120
  ds_read_b64_tr_b16 v[204:205], v5 offset:6144
  ds_read_b64_tr_b16 v[206:207], v5 offset:7168
  s_waitcnt lgkmcnt(14)
  v_mfma_f32_32x32x16_bf16 v[64:79], v[80:83], v[224:227], v[64:79]
  v_mfma_f32_16x16x32_bf16 v[124:127], v[120:123], v[80:83], v[124:127]
  ds_read_b64_tr_b16 v[80:81], v8 offset:49152
  ds_read_b64_tr_b16 v[82:83], v8 offset:49664
  s_add_u32 m0, s61, 0xc400
  s_add_u32 s62, s68, 0x52000
  buffer_load_dwordx4 v4, s[20:23], s62 offen lds
  ds_read_b64_tr_b16 v[208:209], v5 offset:8192
  ds_read_b64_tr_b16 v[210:211], v5 offset:9216
  ds_read_b64_tr_b16 v[212:213], v5 offset:10240
  ds_read_b64_tr_b16 v[214:215], v5 offset:11264
  ds_read_b64_tr_b16 v[216:217], v5 offset:12288
  ds_read_b64_tr_b16 v[218:219], v5 offset:13312
  ds_read_b64_tr_b16 v[220:221], v5 offset:14336
  ds_read_b64_tr_b16 v[222:223], v5 offset:15360
  s_waitcnt lgkmcnt(15)
  v_mfma_f32_32x32x16_bf16 v[64:79], v[84:87], v[228:231], v[64:79]
  v_mfma_f32_16x16x32_bf16 v[124:127], v[120:123], v[84:87], v[124:127]
  ds_read_b64_tr_b16 v[84:85], v8 offset:51200
  ds_read_b64_tr_b16 v[86:87], v8 offset:51712
  v_mfma_f32_32x32x16_bf16 v[64:79], v[88:91], v[232:235], v[64:79]
  ds_read_b64_tr_b16 v[88:89], v9 offset:49152
  ds_read_b64_tr_b16 v[90:91], v9 offset:49664
  v_mfma_f32_32x32x16_bf16 v[64:79], v[92:95], v[236:239], v[64:79]
  ds_read_b64_tr_b16 v[92:93], v9 offset:51200
  ds_read_b64_tr_b16 v[94:95], v9 offset:51712
  s_lshl_b32 s3, s49, 2
  s_add_u32 s3, s3, 154112
  v_add_u32 v125, s3, v1
  ds_write_b32 v125, v124
  s_waitcnt lgkmcnt(15)
  v_mfma_f32_32x32x16_bf16 v[64:79], v[80:83], v[240:243], v[64:79]
  s_add_u32 m0, s61, 0x18000
  s_add_u32 s62, s68, 0x130000
  buffer_load_dwordx4 v4, s[20:23], s62 offen lds
  s_waitcnt lgkmcnt(5)
  v_mfma_f32_32x32x16_bf16 v[64:79], v[84:87], v[244:247], v[64:79]
  s_waitcnt lgkmcnt(3)
  v_mfma_f32_32x32x16_bf16 v[64:79], v[88:91], v[248:251], v[64:79]
  s_add_u32 m0, s61, 0x18400
  s_add_u32 s62, s68, 0x132000
  buffer_load_dwordx4 v4, s[20:23], s62 offen lds
  s_waitcnt lgkmcnt(1)
  v_mfma_f32_32x32x16_bf16 v[64:79], v[92:95], v[252:255], v[64:79]
  s_waitcnt lgkmcnt(0)
  s_barrier
  s_lshl_b32 s7, s54, 16
  s_lshl_b32 s4, s57, 15
  s_add_u32 s7, s7, s4
  s_lshl_b32 s4, s55, 7
  s_add_u32 s7, s7, s4
  s_lshl_b32 s4, s56, 6
  s_add_u32 s7, s7, s4
  v_lshlrev_b32 v112, 2, v30
  v_add_u32 v112, 154112, v112
  ds_read_b128 v[112:115], v112
  s_waitcnt lgkmcnt(0)
  v_add_f32 v112, v112, v113
  v_add_f32 v114, v114, v115
  v_add_f32 v112, v112, v114
  v_cvt_pk_bf16_f32 v113, v112, v112
  v_and_b32 v16, 0xffff0000, v113
  v_sub_f32 v112, v112, v16
  v_cvt_pk_bf16_f32 v17, v112, v112
  v_or_b32 v16, v16, v23
  s_nop 1
  v_mfma_f32_32x32x16_bf16 v[64:79], v[16:19], v[18:21], v[64:79]
  s_nop 11
  v_pk_mul_f32 v[104:105], v[64:65], v[14:15] op_sel:[0,1] op_sel_hi:[1,1]
  v_pk_mul_f32 v[106:107], v[66:67], v[14:15] op_sel:[0,1] op_sel_hi:[1,1]
  v_pk_mul_f32 v[108:109], v[68:69], v[14:15] op_sel:[0,1] op_sel_hi:[1,1]
  v_pk_mul_f32 v[110:111], v[70:71], v[14:15] op_sel:[0,1] op_sel_hi:[1,1]
  v_exp_f32 v104, v104
  v_exp_f32 v105, v105
  v_exp_f32 v106, v106
  v_exp_f32 v107, v107
  v_exp_f32 v108, v108
  v_exp_f32 v109, v109
  v_exp_f32 v110, v110
  v_exp_f32 v111, v111
  v_pk_add_f32 v[104:105], v[104:105], 1.0 op_sel:[0,0] op_sel_hi:[1,0]
  v_pk_add_f32 v[106:107], v[106:107], 1.0 op_sel:[0,0] op_sel_hi:[1,0]
  v_pk_add_f32 v[108:109], v[108:109], 1.0 op_sel:[0,0] op_sel_hi:[1,0]
  v_pk_add_f32 v[110:111], v[110:111], 1.0 op_sel:[0,0] op_sel_hi:[1,0]
  v_pk_fma_f32 v[104:105], v[104:105], v[104:105], 1.0 op_sel:[0,0,0] op_sel_hi:[1,1,0]
  v_pk_fma_f32 v[106:107], v[106:107], v[106:107], 1.0 op_sel:[0,0,0] op_sel_hi:[1,1,0]
  v_pk_fma_f32 v[108:109], v[108:109], v[108:109], 1.0 op_sel:[0,0,0] op_sel_hi:[1,1,0]
  v_pk_fma_f32 v[110:111], v[110:111], v[110:111], 1.0 op_sel:[0,0,0] op_sel_hi:[1,1,0]
  v_rcp_f32 v104, v104
  v_rcp_f32 v105, v105
  v_rcp_f32 v106, v106
  v_rcp_f32 v107, v107
  v_rcp_f32 v108, v108
  v_rcp_f32 v109, v109
  v_rcp_f32 v110, v110
  v_rcp_f32 v111, v111
  v_pk_fma_f32 v[104:105], v[104:105], v[22:23], v[14:15] op_sel:[0,0,0] op_sel_hi:[1,0,0]
  v_pk_fma_f32 v[106:107], v[106:107], v[22:23], v[14:15] op_sel:[0,0,0] op_sel_hi:[1,0,0]
  v_pk_fma_f32 v[108:109], v[108:109], v[22:23], v[14:15] op_sel:[0,0,0] op_sel_hi:[1,0,0]
  v_pk_fma_f32 v[110:111], v[110:111], v[22:23], v[14:15] op_sel:[0,0,0] op_sel_hi:[1,0,0]
  v_pk_mul_f32 v[104:105], v[104:105], v[64:65] op_sel:[0,0] op_sel_hi:[1,1]
  v_pk_mul_f32 v[106:107], v[106:107], v[66:67] op_sel:[0,0] op_sel_hi:[1,1]
  v_pk_mul_f32 v[108:109], v[108:109], v[68:69] op_sel:[0,0] op_sel_hi:[1,1]
  v_pk_mul_f32 v[110:111], v[110:111], v[70:71] op_sel:[0,0] op_sel_hi:[1,1]
  v_cvt_pk_bf16_f32 v64, v104, v105
  v_cvt_pk_bf16_f32 v65, v106, v107
  v_cvt_pk_bf16_f32 v66, v108, v109
  v_cvt_pk_bf16_f32 v67, v110, v111
  buffer_store_dwordx4 v[64:67], v1, s[44:47], s2 offen offset:0 sc1
  v_pk_mul_f32 v[104:105], v[72:73], v[14:15] op_sel:[0,1] op_sel_hi:[1,1]
  v_pk_mul_f32 v[106:107], v[74:75], v[14:15] op_sel:[0,1] op_sel_hi:[1,1]
  s_barrier
  v_add_u32 v24, 0x14000, v24
  ds_read_b128 v[240:243], v24 offset:0
  ds_read_b128 v[244:247], v24 offset:2048
  ds_read_b128 v[248:251], v24 offset:4096
  ds_read_b128 v[252:255], v24 offset:6144
  s_waitcnt lgkmcnt(3)
  v_mfma_f32_32x32x16_bf16 v[224:239], v[128:131], v[240:243], 0
  ds_read_b128 v[240:243], v24 offset:8192
  v_pk_mul_f32 v[108:109], v[76:77], v[14:15] op_sel:[0,1] op_sel_hi:[1,1]
  v_pk_mul_f32 v[110:111], v[78:79], v[14:15] op_sel:[0,1] op_sel_hi:[1,1]
  v_exp_f32 v104, v104
  v_exp_f32 v105, v105
  v_exp_f32 v106, v106
  v_exp_f32 v107, v107
  v_exp_f32 v108, v108
  s_waitcnt lgkmcnt(3)
  v_mfma_f32_32x32x16_bf16 v[224:239], v[132:135], v[244:247], v[224:239]
  ds_read_b128 v[244:247], v24 offset:10240
  v_exp_f32 v109, v109
  v_exp_f32 v110, v110
  v_exp_f32 v111, v111
  v_pk_add_f32 v[104:105], v[104:105], 1.0 op_sel:[0,0] op_sel_hi:[1,0]
  v_pk_add_f32 v[106:107], v[106:107], 1.0 op_sel:[0,0] op_sel_hi:[1,0]
  v_pk_add_f32 v[108:109], v[108:109], 1.0 op_sel:[0,0] op_sel_hi:[1,0]
  v_pk_add_f32 v[110:111], v[110:111], 1.0 op_sel:[0,0] op_sel_hi:[1,0]
  v_pk_fma_f32 v[104:105], v[104:105], v[104:105], 1.0 op_sel:[0,0,0] op_sel_hi:[1,1,0]
  s_waitcnt lgkmcnt(3)
  v_mfma_f32_32x32x16_bf16 v[224:239], v[136:139], v[248:251], v[224:239]
  ds_read_b128 v[248:251], v24 offset:12288
  v_pk_fma_f32 v[106:107], v[106:107], v[106:107], 1.0 op_sel:[0,0,0] op_sel_hi:[1,1,0]
  v_pk_fma_f32 v[108:109], v[108:109], v[108:109], 1.0 op_sel:[0,0,0] op_sel_hi:[1,1,0]
  v_pk_fma_f32 v[110:111], v[110:111], v[110:111], 1.0 op_sel:[0,0,0] op_sel_hi:[1,1,0]
  v_rcp_f32 v104, v104
  v_rcp_f32 v105, v105
  v_rcp_f32 v106, v106
  v_rcp_f32 v107, v107
  s_waitcnt lgkmcnt(3)
  v_mfma_f32_32x32x16_bf16 v[224:239], v[140:143], v[252:255], v[224:239]
  ds_read_b128 v[252:255], v24 offset:14336
  v_rcp_f32 v108, v108
  v_rcp_f32 v109, v109
  v_rcp_f32 v110, v110
  v_rcp_f32 v111, v111
  v_pk_fma_f32 v[104:105], v[104:105], v[22:23], v[14:15] op_sel:[0,0,0] op_sel_hi:[1,0,0]
  v_pk_fma_f32 v[106:107], v[106:107], v[22:23], v[14:15] op_sel:[0,0,0] op_sel_hi:[1,0,0]
  v_pk_fma_f32 v[108:109], v[108:109], v[22:23], v[14:15] op_sel:[0,0,0] op_sel_hi:[1,0,0]
  s_waitcnt lgkmcnt(3)
  v_mfma_f32_32x32x16_bf16 v[224:239], v[144:147], v[240:243], v[224:239]
  s_waitcnt vmcnt(10)
  s_waitcnt lgkmcnt(0)
  s_barrier
  v_add_u32 v24, 0xc000, v24
  ds_read_b128 v[240:243], v24 offset:0
  v_add_u32 v5, 0xffffc000, v5
  ds_read_b64_tr_b16 v[128:129], v5 offset:0
  ds_read_b64_tr_b16 v[130:131], v5 offset:1024
  v_pk_fma_f32 v[110:111], v[110:111], v[22:23], v[14:15] op_sel:[0,0,0] op_sel_hi:[1,0,0]
  v_pk_mul_f32 v[104:105], v[104:105], v[72:73] op_sel:[0,0] op_sel_hi:[1,1]
  v_pk_mul_f32 v[106:107], v[106:107], v[74:75] op_sel:[0,0] op_sel_hi:[1,1]
  v_pk_mul_f32 v[108:109], v[108:109], v[76:77] op_sel:[0,0] op_sel_hi:[1,1]
  v_pk_mul_f32 v[110:111], v[110:111], v[78:79] op_sel:[0,0] op_sel_hi:[1,1]
  v_cvt_pk_bf16_f32 v72, v104, v105
  v_cvt_pk_bf16_f32 v73, v106, v107
  v_cvt_pk_bf16_f32 v74, v108, v109
  v_cvt_pk_bf16_f32 v75, v110, v111
  buffer_store_dwordx4 v[72:75], v1, s[44:47], s2 offen offset:1024 sc1
  v_mfma_f32_32x32x16_bf16 v[224:239], v[148:151], v[244:247], v[224:239]
  ds_read_b128 v[244:247], v24 offset:2048
  ds_read_b64_tr_b16 v[132:133], v5 offset:2048
  ds_read_b64_tr_b16 v[134:135], v5 offset:3072
  v_mfma_f32_32x32x16_bf16 v[224:239], v[152:155], v[248:251], v[224:239]
  ds_read_b128 v[248:251], v24 offset:4096
  ds_read_b64_tr_b16 v[136:137], v5 offset:4096
  ds_read_b64_tr_b16 v[138:139], v5 offset:5120
  v_mfma_f32_32x32x16_bf16 v[224:239], v[156:159], v[252:255], v[224:239]
  ds_read_b128 v[252:255], v24 offset:6144
  ds_read_b64_tr_b16 v[140:141], v5 offset:6144
  ds_read_b64_tr_b16 v[142:143], v5 offset:7168
  s_waitcnt lgkmcnt(11)
  v_mfma_f32_32x32x16_bf16 v[224:239], v[160:163], v[240:243], v[224:239]
  ds_read_b128 v[240:243], v24 offset:8192
  ds_read_b64_tr_b16 v[144:145], v5 offset:8192
  ds_read_b64_tr_b16 v[146:147], v5 offset:9216
  s_waitcnt lgkmcnt(11)
  v_mfma_f32_32x32x16_bf16 v[224:239], v[164:167], v[244:247], v[224:239]
  ds_read_b128 v[244:247], v24 offset:10240
  ds_read_b64_tr_b16 v[148:149], v5 offset:10240
  ds_read_b64_tr_b16 v[150:151], v5 offset:11264
  s_waitcnt lgkmcnt(11)
  v_mfma_f32_32x32x16_bf16 v[224:239], v[168:171], v[248:251], v[224:239]
  ds_read_b128 v[248:251], v24 offset:12288
  ds_read_b64_tr_b16 v[152:153], v5 offset:12288
  ds_read_b64_tr_b16 v[154:155], v5 offset:13312
  s_waitcnt lgkmcnt(11)
  v_mfma_f32_32x32x16_bf16 v[224:239], v[172:175], v[252:255], v[224:239]
  ds_read_b128 v[252:255], v24 offset:14336
  ds_read_b64_tr_b16 v[156:157], v5 offset:14336
  ds_read_b64_tr_b16 v[158:159], v5 offset:15360
  s_waitcnt lgkmcnt(11)
  v_mfma_f32_32x32x16_bf16 v[224:239], v[176:179], v[240:243], v[224:239]
  s_waitcnt vmcnt(9)
  s_waitcnt lgkmcnt(0)
  s_barrier
  v_add_u32 v24, 0xffff0000, v24
  ds_read_b128 v[240:243], v24 offset:0
  v_add_u32 v5, 0x1c000, v5
  ds_read_b64_tr_b16 v[160:161], v5 offset:0
  ds_read_b64_tr_b16 v[162:163], v5 offset:1024
  v_mfma_f32_32x32x16_bf16 v[224:239], v[180:183], v[244:247], v[224:239]
  ds_read_b128 v[244:247], v24 offset:2048
  ds_read_b64_tr_b16 v[164:165], v5 offset:2048
  ds_read_b64_tr_b16 v[166:167], v5 offset:3072
  s_waitcnt vmcnt(0)
  buffer_store_dword v10, v28, s[44:47], s65 offen offset:256 sc1
  v_mfma_f32_32x32x16_bf16 v[224:239], v[184:187], v[248:251], v[224:239]
  ds_read_b128 v[248:251], v24 offset:4096
  ds_read_b64_tr_b16 v[168:169], v5 offset:4096
  ds_read_b64_tr_b16 v[170:171], v5 offset:5120
  v_mfma_f32_32x32x16_bf16 v[224:239], v[188:191], v[252:255], v[224:239]
  ds_read_b128 v[252:255], v24 offset:6144
  ds_read_b64_tr_b16 v[172:173], v5 offset:6144
  ds_read_b64_tr_b16 v[174:175], v5 offset:7168
  s_waitcnt lgkmcnt(11)
  v_mfma_f32_32x32x16_bf16 v[224:239], v[192:195], v[240:243], v[224:239]
  ds_read_b128 v[240:243], v24 offset:8192
  ds_read_b64_tr_b16 v[176:177], v5 offset:8192
  ds_read_b64_tr_b16 v[178:179], v5 offset:9216
  s_waitcnt lgkmcnt(11)
  v_mfma_f32_32x32x16_bf16 v[224:239], v[196:199], v[244:247], v[224:239]
  ds_read_b128 v[244:247], v24 offset:10240
  ds_read_b64_tr_b16 v[180:181], v5 offset:10240
  ds_read_b64_tr_b16 v[182:183], v5 offset:11264
  s_waitcnt lgkmcnt(11)
  v_mfma_f32_32x32x16_bf16 v[224:239], v[200:203], v[248:251], v[224:239]
  ds_read_b128 v[248:251], v24 offset:12288
  ds_read_b64_tr_b16 v[184:185], v5 offset:12288
  ds_read_b64_tr_b16 v[186:187], v5 offset:13312
  s_waitcnt lgkmcnt(11)
  v_mfma_f32_32x32x16_bf16 v[224:239], v[204:207], v[252:255], v[224:239]
  ds_read_b128 v[252:255], v24 offset:14336
  ds_read_b64_tr_b16 v[188:189], v5 offset:14336
  ds_read_b64_tr_b16 v[190:191], v5 offset:15360
  s_waitcnt lgkmcnt(11)
  v_mfma_f32_32x32x16_bf16 v[224:239], v[208:211], v[240:243], v[224:239]
  s_waitcnt lgkmcnt(0)
  s_barrier
  v_add_u32 v24, 0xffff4000, v24
  ds_read_b128 v[240:243], v24 offset:0
  v_add_u32 v5, 0xfffec000, v5
  ds_read_b64_tr_b16 v[192:193], v5 offset:0
  ds_read_b64_tr_b16 v[194:195], v5 offset:1024
  v_mfma_f32_32x32x16_bf16 v[224:239], v[212:215], v[244:247], v[224:239]
  ds_read_b128 v[244:247], v24 offset:2048
  ds_read_b64_tr_b16 v[196:197], v5 offset:2048
  ds_read_b64_tr_b16 v[198:199], v5 offset:3072
  v_mfma_f32_32x32x16_bf16 v[224:239], v[216:219], v[248:251], v[224:239]
  ds_read_b128 v[248:251], v24 offset:4096
  ds_read_b64_tr_b16 v[200:201], v5 offset:4096
  ds_read_b64_tr_b16 v[202:203], v5 offset:5120
  v_mfma_f32_32x32x16_bf16 v[224:239], v[220:223], v[252:255], v[224:239]
  ds_read_b128 v[252:255], v24 offset:6144
  ds_read_b64_tr_b16 v[204:205], v5 offset:6144
  ds_read_b64_tr_b16 v[206:207], v5 offset:7168
  s_waitcnt lgkmcnt(11)
  v_mfma_f32_32x32x16_bf16 v[224:239], v[128:131], v[240:243], v[224:239]
  ds_read_b128 v[240:243], v24 offset:8192
  ds_read_b64_tr_b16 v[208:209], v5 offset:8192
  ds_read_b64_tr_b16 v[210:211], v5 offset:9216
  s_waitcnt lgkmcnt(11)
  v_mfma_f32_32x32x16_bf16 v[224:239], v[132:135], v[244:247], v[224:239]
  ds_read_b128 v[244:247], v24 offset:10240
  ds_read_b64_tr_b16 v[212:213], v5 offset:10240
  ds_read_b64_tr_b16 v[214:215], v5 offset:11264
  s_waitcnt lgkmcnt(11)
  v_mfma_f32_32x32x16_bf16 v[224:239], v[136:139], v[248:251], v[224:239]
  ds_read_b128 v[248:251], v24 offset:12288
  ds_read_b64_tr_b16 v[216:217], v5 offset:12288
  ds_read_b64_tr_b16 v[218:219], v5 offset:13312
  s_waitcnt lgkmcnt(11)
  v_mfma_f32_32x32x16_bf16 v[224:239], v[140:143], v[252:255], v[224:239]
  ds_read_b128 v[252:255], v24 offset:14336
  ds_read_b64_tr_b16 v[220:221], v5 offset:14336
  ds_read_b64_tr_b16 v[222:223], v5 offset:15360
  s_waitcnt lgkmcnt(11)
  v_mfma_f32_32x32x16_bf16 v[224:239], v[144:147], v[240:243], v[224:239]
  s_waitcnt lgkmcnt(0)
  s_barrier
  v_add_u32 v24, 0x10000, v24
  ds_read_b128 v[240:243], v24 offset:0
  v_add_u32 v5, 0x4000, v5
  ds_read_b64_tr_b16 v[128:129], v5 offset:0
  ds_read_b64_tr_b16 v[130:131], v5 offset:1024
  v_mfma_f32_32x32x16_bf16 v[224:239], v[148:151], v[244:247], v[224:239]
  ds_read_b128 v[244:247], v24 offset:2048
  ds_read_b64_tr_b16 v[132:133], v5 offset:2048
  ds_read_b64_tr_b16 v[134:135], v5 offset:3072
  v_mfma_f32_32x32x16_bf16 v[224:239], v[152:155], v[248:251], v[224:239]
  ds_read_b128 v[248:251], v24 offset:4096
  ds_read_b64_tr_b16 v[136:137], v5 offset:4096
  ds_read_b64_tr_b16 v[138:139], v5 offset:5120
  v_mfma_f32_32x32x16_bf16 v[224:239], v[156:159], v[252:255], v[224:239]
  ds_read_b128 v[252:255], v24 offset:6144
  ds_read_b64_tr_b16 v[140:141], v5 offset:6144
  ds_read_b64_tr_b16 v[142:143], v5 offset:7168
  s_waitcnt lgkmcnt(11)
  v_mfma_f32_32x32x16_bf16 v[224:239], v[160:163], v[240:243], v[224:239]
  ds_read_b128 v[240:243], v24 offset:8192
  ds_read_b64_tr_b16 v[144:145], v5 offset:8192
  ds_read_b64_tr_b16 v[146:147], v5 offset:9216
  s_waitcnt lgkmcnt(11)
  v_mfma_f32_32x32x16_bf16 v[224:239], v[164:167], v[244:247], v[224:239]
  ds_read_b128 v[244:247], v24 offset:10240
  ds_read_b64_tr_b16 v[148:149], v5 offset:10240
  ds_read_b64_tr_b16 v[150:151], v5 offset:11264
  s_waitcnt lgkmcnt(11)
  v_mfma_f32_32x32x16_bf16 v[224:239], v[168:171], v[248:251], v[224:239]
  ds_read_b128 v[248:251], v24 offset:12288
  ds_read_b64_tr_b16 v[152:153], v5 offset:12288
  ds_read_b64_tr_b16 v[154:155], v5 offset:13312
  s_waitcnt lgkmcnt(11)
  v_mfma_f32_32x32x16_bf16 v[224:239], v[172:175], v[252:255], v[224:239]
  ds_read_b128 v[252:255], v24 offset:14336
  ds_read_b64_tr_b16 v[156:157], v5 offset:14336
  ds_read_b64_tr_b16 v[158:159], v5 offset:15360
  s_waitcnt lgkmcnt(11)
  v_mfma_f32_32x32x16_bf16 v[224:239], v[176:179], v[240:243], v[224:239]
  s_waitcnt lgkmcnt(0)
  s_barrier
  v_add_u32 v24, 0xc000, v24
  ds_read_b128 v[240:243], v24 offset:0
  v_add_u32 v5, 0xc000, v5
  ds_read_b64_tr_b16 v[160:161], v5 offset:0
  ds_read_b64_tr_b16 v[162:163], v5 offset:1024
  v_mfma_f32_32x32x16_bf16 v[224:239], v[180:183], v[244:247], v[224:239]
  ds_read_b128 v[244:247], v24 offset:2048
  ds_read_b64_tr_b16 v[164:165], v5 offset:2048
  ds_read_b64_tr_b16 v[166:167], v5 offset:3072
  v_mfma_f32_32x32x16_bf16 v[224:239], v[184:187], v[248:251], v[224:239]
  ds_read_b128 v[248:251], v24 offset:4096
  ds_read_b64_tr_b16 v[168:169], v5 offset:4096
  ds_read_b64_tr_b16 v[170:171], v5 offset:5120
  v_mfma_f32_32x32x16_bf16 v[224:239], v[188:191], v[252:255], v[224:239]
  ds_read_b128 v[252:255], v24 offset:6144
  ds_read_b64_tr_b16 v[172:173], v5 offset:6144
  ds_read_b64_tr_b16 v[174:175], v5 offset:7168
  s_waitcnt lgkmcnt(11)
  v_mfma_f32_32x32x16_bf16 v[224:239], v[192:195], v[240:243], v[224:239]
  ds_read_b128 v[240:243], v24 offset:8192
  ds_read_b64_tr_b16 v[176:177], v5 offset:8192
  ds_read_b64_tr_b16 v[178:179], v5 offset:9216
  s_waitcnt lgkmcnt(11)
  v_mfma_f32_32x32x16_bf16 v[224:239], v[196:199], v[244:247], v[224:239]
  ds_read_b128 v[244:247], v24 offset:10240
  ds_read_b64_tr_b16 v[180:181], v5 offset:10240
  ds_read_b64_tr_b16 v[182:183], v5 offset:11264
  s_waitcnt lgkmcnt(11)
  v_mfma_f32_32x32x16_bf16 v[224:239], v[200:203], v[248:251], v[224:239]
  ds_read_b128 v[248:251], v24 offset:12288
  ds_read_b64_tr_b16 v[184:185], v5 offset:12288
  ds_read_b64_tr_b16 v[186:187], v5 offset:13312
  s_waitcnt lgkmcnt(11)
  v_mfma_f32_32x32x16_bf16 v[224:239], v[204:207], v[252:255], v[224:239]
  ds_read_b128 v[252:255], v24 offset:14336
  ds_read_b64_tr_b16 v[188:189], v5 offset:14336
  ds_read_b64_tr_b16 v[190:191], v5 offset:15360
  s_waitcnt lgkmcnt(11)
  v_mfma_f32_32x32x16_bf16 v[224:239], v[208:211], v[240:243], v[224:239]
  s_waitcnt lgkmcnt(0)
  s_barrier
  v_add_u32 v24, 0xfffe0000, v24
  ds_read_b128 v[240:243], v24 offset:0
  v_add_u32 v5, 0xffff8000, v5
  ds_read_b64_tr_b16 v[192:193], v5 offset:0
  ds_read_b64_tr_b16 v[194:195], v5 offset:1024
  v_mfma_f32_32x32x16_bf16 v[224:239], v[212:215], v[244:247], v[224:239]
  ds_read_b128 v[244:247], v24 offset:2048
  ds_read_b64_tr_b16 v[196:197], v5 offset:2048
  ds_read_b64_tr_b16 v[198:199], v5 offset:3072
  v_mfma_f32_32x32x16_bf16 v[224:239], v[216:219], v[248:251], v[224:239]
  ds_read_b128 v[248:251], v24 offset:4096
  ds_read_b64_tr_b16 v[200:201], v5 offset:4096
  ds_read_b64_tr_b16 v[202:203], v5 offset:5120
  v_mfma_f32_32x32x16_bf16 v[224:239], v[220:223], v[252:255], v[224:239]
  ds_read_b128 v[252:255], v24 offset:6144
  ds_read_b64_tr_b16 v[204:205], v5 offset:6144
  ds_read_b64_tr_b16 v[206:207], v5 offset:7168
  s_waitcnt lgkmcnt(11)
  v_mfma_f32_32x32x16_bf16 v[224:239], v[128:131], v[240:243], v[224:239]
  ds_read_b128 v[240:243], v24 offset:8192
  ds_read_b64_tr_b16 v[208:209], v5 offset:8192
  ds_read_b64_tr_b16 v[210:211], v5 offset:9216
  s_waitcnt lgkmcnt(11)
  v_mfma_f32_32x32x16_bf16 v[224:239], v[132:135], v[244:247], v[224:239]
  ds_read_b128 v[244:247], v24 offset:10240
  ds_read_b64_tr_b16 v[212:213], v5 offset:10240
  ds_read_b64_tr_b16 v[214:215], v5 offset:11264
  s_waitcnt lgkmcnt(11)
  v_mfma_f32_32x32x16_bf16 v[224:239], v[136:139], v[248:251], v[224:239]
  ds_read_b128 v[248:251], v24 offset:12288
  ds_read_b64_tr_b16 v[216:217], v5 offset:12288
  ds_read_b64_tr_b16 v[218:219], v5 offset:13312
  s_waitcnt lgkmcnt(11)
  v_mfma_f32_32x32x16_bf16 v[224:239], v[140:143], v[252:255], v[224:239]
  ds_read_b128 v[252:255], v24 offset:14336
  ds_read_b64_tr_b16 v[220:221], v5 offset:14336
  ds_read_b64_tr_b16 v[222:223], v5 offset:15360
  s_waitcnt lgkmcnt(11)
  v_mfma_f32_32x32x16_bf16 v[224:239], v[144:147], v[240:243], v[224:239]
  s_waitcnt lgkmcnt(0)
  s_barrier
  v_add_u32 v24, 0x1c000, v24
  ds_read_b128 v[240:243], v24 offset:0
  v_add_u32 v5, 0xffff4000, v5
  ds_read_b64_tr_b16 v[128:129], v5 offset:0
  ds_read_b64_tr_b16 v[130:131], v5 offset:1024
  v_mfma_f32_32x32x16_bf16 v[224:239], v[148:151], v[244:247], v[224:239]
  ds_read_b128 v[244:247], v24 offset:2048
  ds_read_b64_tr_b16 v[132:133], v5 offset:2048
  ds_read_b64_tr_b16 v[134:135], v5 offset:3072
  v_mfma_f32_32x32x16_bf16 v[224:239], v[152:155], v[248:251], v[224:239]
  ds_read_b128 v[248:251], v24 offset:4096
  ds_read_b64_tr_b16 v[136:137], v5 offset:4096
  ds_read_b64_tr_b16 v[138:139], v5 offset:5120
  v_mfma_f32_32x32x16_bf16 v[224:239], v[156:159], v[252:255], v[224:239]
  ds_read_b128 v[252:255], v24 offset:6144
  ds_read_b64_tr_b16 v[140:141], v5 offset:6144
  ds_read_b64_tr_b16 v[142:143], v5 offset:7168
  s_waitcnt lgkmcnt(11)
  v_mfma_f32_32x32x16_bf16 v[224:239], v[160:163], v[240:243], v[224:239]
  ds_read_b128 v[240:243], v24 offset:8192
  ds_read_b64_tr_b16 v[144:145], v5 offset:8192
  ds_read_b64_tr_b16 v[146:147], v5 offset:9216
  s_waitcnt lgkmcnt(11)
  v_mfma_f32_32x32x16_bf16 v[224:239], v[164:167], v[244:247], v[224:239]
  ds_read_b128 v[244:247], v24 offset:10240
  ds_read_b64_tr_b16 v[148:149], v5 offset:10240
  ds_read_b64_tr_b16 v[150:151], v5 offset:11264
  s_waitcnt lgkmcnt(11)
  v_mfma_f32_32x32x16_bf16 v[224:239], v[168:171], v[248:251], v[224:239]
  ds_read_b128 v[248:251], v24 offset:12288
  ds_read_b64_tr_b16 v[152:153], v5 offset:12288
  ds_read_b64_tr_b16 v[154:155], v5 offset:13312
  s_waitcnt lgkmcnt(11)
  v_mfma_f32_32x32x16_bf16 v[224:239], v[172:175], v[252:255], v[224:239]
  ds_read_b128 v[252:255], v24 offset:14336
  ds_read_b64_tr_b16 v[156:157], v5 offset:14336
  ds_read_b64_tr_b16 v[158:159], v5 offset:15360
  s_waitcnt lgkmcnt(11)
  v_mfma_f32_32x32x16_bf16 v[224:239], v[176:179], v[240:243], v[224:239]
  s_waitcnt lgkmcnt(0)
  s_barrier
  v_add_u32 v24, 0xfffec000, v24
  ds_read_b128 v[240:243], v24 offset:0
  v_add_u32 v5, 0x20000, v5
  ds_read_b64_tr_b16 v[160:161], v5 offset:0
  ds_read_b64_tr_b16 v[162:163], v5 offset:1024
  v_lshlrev_b32 v20, 8, v30
  v_lshrrev_b32 v21, 5, v0
  v_lshl_add_u32 v20, v21, 4, v20
  v_lshlrev_b32 v19, 5, v30
  v_lshl_add_u32 v19, v21, 4, v19
  v_mfma_f32_32x32x16_bf16 v[224:239], v[180:183], v[244:247], v[224:239]
  ds_read_b128 v[244:247], v24 offset:2048
  ds_read_b64_tr_b16 v[164:165], v5 offset:2048
  ds_read_b64_tr_b16 v[166:167], v5 offset:3072
  v_bfe_u32 v21, v0, 1, 1
  v_xor_b32 v21, s56, v21
  v_lshl_add_u32 v19, v21, 6, v19
  v_mfma_f32_32x32x16_bf16 v[224:239], v[184:187], v[248:251], v[224:239]
  ds_read_b128 v[248:251], v24 offset:4096
  ds_read_b64_tr_b16 v[168:169], v5 offset:4096
  ds_read_b64_tr_b16 v[170:171], v5 offset:5120
  v_mfma_f32_32x32x16_bf16 v[224:239], v[188:191], v[252:255], v[224:239]
  ds_read_b128 v[252:255], v24 offset:6144
  ds_read_b64_tr_b16 v[172:173], v5 offset:6144
  ds_read_b64_tr_b16 v[174:175], v5 offset:7168
  s_waitcnt lgkmcnt(11)
  v_mfma_f32_32x32x16_bf16 v[224:239], v[192:195], v[240:243], v[224:239]
  ds_read_b128 v[240:243], v24 offset:8192
  ds_read_b64_tr_b16 v[176:177], v5 offset:8192
  ds_read_b64_tr_b16 v[178:179], v5 offset:9216
  s_waitcnt lgkmcnt(11)
  v_mfma_f32_32x32x16_bf16 v[224:239], v[196:199], v[244:247], v[224:239]
  ds_read_b128 v[244:247], v24 offset:10240
  ds_read_b64_tr_b16 v[180:181], v5 offset:10240
  ds_read_b64_tr_b16 v[182:183], v5 offset:11264
  s_waitcnt lgkmcnt(11)
  v_mfma_f32_32x32x16_bf16 v[224:239], v[200:203], v[248:251], v[224:239]
  ds_read_b128 v[248:251], v24 offset:12288
  ds_read_b64_tr_b16 v[184:185], v5 offset:12288
  ds_read_b64_tr_b16 v[186:187], v5 offset:13312
  s_waitcnt lgkmcnt(11)
  v_mfma_f32_32x32x16_bf16 v[224:239], v[204:207], v[252:255], v[224:239]
  ds_read_b128 v[252:255], v24 offset:14336
  ds_read_b64_tr_b16 v[188:189], v5 offset:14336
  ds_read_b64_tr_b16 v[190:191], v5 offset:15360
  s_waitcnt lgkmcnt(11)
  v_mfma_f32_32x32x16_bf16 v[224:239], v[208:211], v[240:243], v[224:239]
  s_waitcnt lgkmcnt(0)
  s_barrier
  v_add_u32 v24, 0xc000, v24
  ds_read_b128 v[240:243], v24 offset:0
  v_add_u32 v5, 0xfffe8000, v5
  ds_read_b64_tr_b16 v[192:193], v5 offset:0
  ds_read_b64_tr_b16 v[194:195], v5 offset:1024
  v_mfma_f32_32x32x16_bf16 v[224:239], v[212:215], v[244:247], v[224:239]
  ds_read_b128 v[244:247], v24 offset:2048
  ds_read_b64_tr_b16 v[196:197], v5 offset:2048
  ds_read_b64_tr_b16 v[198:199], v5 offset:3072
  v_mfma_f32_32x32x16_bf16 v[224:239], v[216:219], v[248:251], v[224:239]
  ds_read_b128 v[248:251], v24 offset:4096
  ds_read_b64_tr_b16 v[200:201], v5 offset:4096
  ds_read_b64_tr_b16 v[202:203], v5 offset:5120
  v_mfma_f32_32x32x16_bf16 v[224:239], v[220:223], v[252:255], v[224:239]
  ds_read_b128 v[252:255], v24 offset:6144
  ds_read_b64_tr_b16 v[204:205], v5 offset:6144
  ds_read_b64_tr_b16 v[206:207], v5 offset:7168
  s_waitcnt lgkmcnt(11)
  v_mfma_f32_32x32x16_bf16 v[224:239], v[128:131], v[240:243], v[224:239]
  ds_read_b128 v[240:243], v24 offset:8192
  ds_read_b64_tr_b16 v[208:209], v5 offset:8192
  ds_read_b64_tr_b16 v[210:211], v5 offset:9216
  s_waitcnt lgkmcnt(11)
  v_mfma_f32_32x32x16_bf16 v[224:239], v[132:135], v[244:247], v[224:239]
  ds_read_b128 v[244:247], v24 offset:10240
  ds_read_b64_tr_b16 v[212:213], v5 offset:10240
  ds_read_b64_tr_b16 v[214:215], v5 offset:11264
  s_waitcnt lgkmcnt(11)
  v_mfma_f32_32x32x16_bf16 v[224:239], v[136:139], v[248:251], v[224:239]
  ds_read_b128 v[248:251], v24 offset:12288
  ds_read_b64_tr_b16 v[216:217], v5 offset:12288
  ds_read_b64_tr_b16 v[218:219], v5 offset:13312
  s_waitcnt lgkmcnt(11)
  v_mfma_f32_32x32x16_bf16 v[224:239], v[140:143], v[252:255], v[224:239]
  ds_read_b128 v[252:255], v24 offset:14336
  ds_read_b64_tr_b16 v[220:221], v5 offset:14336
  ds_read_b64_tr_b16 v[222:223], v5 offset:15360
  s_waitcnt lgkmcnt(11)
  v_mfma_f32_32x32x16_bf16 v[224:239], v[144:147], v[240:243], v[224:239]
  s_waitcnt lgkmcnt(0)
  s_barrier
  v_add_u32 v24, 0xc000, v24
  ds_read_b128 v[240:243], v24 offset:0
  v_add_u32 v5, 0xc000, v5
  ds_read_b64_tr_b16 v[128:129], v5 offset:0
  ds_read_b64_tr_b16 v[130:131], v5 offset:1024
  v_mfma_f32_32x32x16_bf16 v[224:239], v[148:151], v[244:247], v[224:239]
  ds_read_b128 v[244:247], v24 offset:2048
  ds_read_b64_tr_b16 v[132:133], v5 offset:2048
  ds_read_b64_tr_b16 v[134:135], v5 offset:3072
  v_mfma_f32_32x32x16_bf16 v[224:239], v[152:155], v[248:251], v[224:239]
  ds_read_b128 v[248:251], v24 offset:4096
  ds_read_b64_tr_b16 v[136:137], v5 offset:4096
  ds_read_b64_tr_b16 v[138:139], v5 offset:5120
  v_mfma_f32_32x32x16_bf16 v[224:239], v[156:159], v[252:255], v[224:239]
  ds_read_b128 v[252:255], v24 offset:6144
  ds_read_b64_tr_b16 v[140:141], v5 offset:6144
  ds_read_b64_tr_b16 v[142:143], v5 offset:7168
  s_waitcnt lgkmcnt(11)
  v_mfma_f32_32x32x16_bf16 v[224:239], v[160:163], v[240:243], v[224:239]
  ds_read_b128 v[240:243], v24 offset:8192
  ds_read_b64_tr_b16 v[144:145], v5 offset:8192
  ds_read_b64_tr_b16 v[146:147], v5 offset:9216
  s_waitcnt lgkmcnt(11)
  v_mfma_f32_32x32x16_bf16 v[224:239], v[164:167], v[244:247], v[224:239]
  ds_read_b128 v[244:247], v24 offset:10240
  ds_read_b64_tr_b16 v[148:149], v5 offset:10240
  ds_read_b64_tr_b16 v[150:151], v5 offset:11264
  s_waitcnt lgkmcnt(11)
  v_mfma_f32_32x32x16_bf16 v[224:239], v[168:171], v[248:251], v[224:239]
  ds_read_b128 v[248:251], v24 offset:12288
  ds_read_b64_tr_b16 v[152:153], v5 offset:12288
  ds_read_b64_tr_b16 v[154:155], v5 offset:13312
  s_waitcnt lgkmcnt(11)
  v_mfma_f32_32x32x16_bf16 v[224:239], v[172:175], v[252:255], v[224:239]
  ds_read_b128 v[252:255], v24 offset:14336
  ds_read_b64_tr_b16 v[156:157], v5 offset:14336
  ds_read_b64_tr_b16 v[158:159], v5 offset:15360
  s_waitcnt lgkmcnt(11)
  v_mfma_f32_32x32x16_bf16 v[224:239], v[176:179], v[240:243], v[224:239]
  s_waitcnt lgkmcnt(0)
  s_barrier
  v_add_u32 v24, 0xfffe0000, v24
  ds_read_b128 v[240:243], v24 offset:0
  v_add_u32 v5, 0xffff8000, v5
  ds_read_b64_tr_b16 v[160:161], v5 offset:0
  ds_read_b64_tr_b16 v[162:163], v5 offset:1024
  v_mfma_f32_32x32x16_bf16 v[224:239], v[180:183], v[244:247], v[224:239]
  ds_read_b128 v[244:247], v24 offset:2048
  ds_read_b64_tr_b16 v[164:165], v5 offset:2048
  ds_read_b64_tr_b16 v[166:167], v5 offset:3072
  v_mfma_f32_32x32x16_bf16 v[224:239], v[184:187], v[248:251], v[224:239]
  ds_read_b128 v[248:251], v24 offset:4096
  ds_read_b64_tr_b16 v[168:169], v5 offset:4096
  ds_read_b64_tr_b16 v[170:171], v5 offset:5120
  v_mfma_f32_32x32x16_bf16 v[224:239], v[188:191], v[252:255], v[224:239]
  ds_read_b128 v[252:255], v24 offset:6144
  ds_read_b64_tr_b16 v[172:173], v5 offset:6144
  ds_read_b64_tr_b16 v[174:175], v5 offset:7168
  s_waitcnt lgkmcnt(11)
  v_mfma_f32_32x32x16_bf16 v[224:239], v[192:195], v[240:243], v[224:239]
  ds_read_b128 v[240:243], v24 offset:8192
  ds_read_b64_tr_b16 v[176:177], v5 offset:8192
  ds_read_b64_tr_b16 v[178:179], v5 offset:9216
  s_waitcnt lgkmcnt(11)
  v_mfma_f32_32x32x16_bf16 v[224:239], v[196:199], v[244:247], v[224:239]
  ds_read_b128 v[244:247], v24 offset:10240
  ds_read_b64_tr_b16 v[180:181], v5 offset:10240
  ds_read_b64_tr_b16 v[182:183], v5 offset:11264
  s_waitcnt lgkmcnt(11)
  v_mfma_f32_32x32x16_bf16 v[224:239], v[200:203], v[248:251], v[224:239]
  ds_read_b128 v[248:251], v24 offset:12288
  ds_read_b64_tr_b16 v[184:185], v5 offset:12288
  ds_read_b64_tr_b16 v[186:187], v5 offset:13312
  s_waitcnt lgkmcnt(11)
  v_mfma_f32_32x32x16_bf16 v[224:239], v[204:207], v[252:255], v[224:239]
  ds_read_b128 v[252:255], v24 offset:14336
  ds_read_b64_tr_b16 v[188:189], v5 offset:14336
  ds_read_b64_tr_b16 v[190:191], v5 offset:15360
  s_waitcnt lgkmcnt(11)
  v_mfma_f32_32x32x16_bf16 v[224:239], v[208:211], v[240:243], v[224:239]
  s_waitcnt lgkmcnt(0)
  s_barrier
  v_add_u32 v24, 0x1c000, v24
  ds_read_b128 v[240:243], v24 offset:0
  v_add_u32 v5, 0xffff4000, v5
  ds_read_b64_tr_b16 v[192:193], v5 offset:0
  ds_read_b64_tr_b16 v[194:195], v5 offset:1024
  v_mfma_f32_32x32x16_bf16 v[224:239], v[212:215], v[244:247], v[224:239]
  ds_read_b128 v[244:247], v24 offset:2048
  ds_read_b64_tr_b16 v[196:197], v5 offset:2048
  ds_read_b64_tr_b16 v[198:199], v5 offset:3072
  v_mfma_f32_32x32x16_bf16 v[224:239], v[216:219], v[248:251], v[224:239]
  ds_read_b128 v[248:251], v24 offset:4096
  ds_read_b64_tr_b16 v[200:201], v5 offset:4096
  ds_read_b64_tr_b16 v[202:203], v5 offset:5120
  v_mfma_f32_32x32x16_bf16 v[224:239], v[220:223], v[252:255], v[224:239]
  ds_read_b128 v[252:255], v24 offset:6144
  ds_read_b64_tr_b16 v[204:205], v5 offset:6144
  ds_read_b64_tr_b16 v[206:207], v5 offset:7168
  s_waitcnt lgkmcnt(11)
  v_mfma_f32_32x32x16_bf16 v[224:239], v[128:131], v[240:243], v[224:239]
  ds_read_b128 v[240:243], v24 offset:8192
  ds_read_b64_tr_b16 v[208:209], v5 offset:8192
  ds_read_b64_tr_b16 v[210:211], v5 offset:9216
  s_waitcnt lgkmcnt(11)
  v_mfma_f32_32x32x16_bf16 v[224:239], v[132:135], v[244:247], v[224:239]
  ds_read_b128 v[244:247], v24 offset:10240
  ds_read_b64_tr_b16 v[212:213], v5 offset:10240
  ds_read_b64_tr_b16 v[214:215], v5 offset:11264
  s_waitcnt lgkmcnt(11)
  v_mfma_f32_32x32x16_bf16 v[224:239], v[136:139], v[248:251], v[224:239]
  ds_read_b128 v[248:251], v24 offset:12288
  ds_read_b64_tr_b16 v[216:217], v5 offset:12288
  ds_read_b64_tr_b16 v[218:219], v5 offset:13312
  s_waitcnt lgkmcnt(11)
  v_mfma_f32_32x32x16_bf16 v[224:239], v[140:143], v[252:255], v[224:239]
  ds_read_b128 v[252:255], v24 offset:14336
  ds_read_b64_tr_b16 v[220:221], v5 offset:14336
  ds_read_b64_tr_b16 v[222:223], v5 offset:15360
  s_waitcnt lgkmcnt(11)
  v_mfma_f32_32x32x16_bf16 v[224:239], v[144:147], v[240:243], v[224:239]
  s_waitcnt lgkmcnt(0)
  s_barrier
  v_add_u32 v24, 0xfffec000, v24
  ds_read_b128 v[240:243], v24 offset:0
  v_add_u32 v5, 0x20000, v5
  ds_read_b64_tr_b16 v[128:129], v5 offset:0
  ds_read_b64_tr_b16 v[130:131], v5 offset:1024
  v_mfma_f32_32x32x16_bf16 v[224:239], v[148:151], v[244:247], v[224:239]
  ds_read_b128 v[244:247], v24 offset:2048
  ds_read_b64_tr_b16 v[132:133], v5 offset:2048
  ds_read_b64_tr_b16 v[134:135], v5 offset:3072
  v_mfma_f32_32x32x16_bf16 v[224:239], v[152:155], v[248:251], v[224:239]
  ds_read_b128 v[248:251], v24 offset:4096
  ds_read_b64_tr_b16 v[136:137], v5 offset:4096
  ds_read_b64_tr_b16 v[138:139], v5 offset:5120
  v_mfma_f32_32x32x16_bf16 v[224:239], v[156:159], v[252:255], v[224:239]
  ds_read_b128 v[252:255], v24 offset:6144
  ds_read_b64_tr_b16 v[140:141], v5 offset:6144
  ds_read_b64_tr_b16 v[142:143], v5 offset:7168
  s_waitcnt lgkmcnt(11)
  v_mfma_f32_32x32x16_bf16 v[224:239], v[160:163], v[240:243], v[224:239]
  ds_read_b128 v[240:243], v24 offset:8192
  ds_read_b64_tr_b16 v[144:145], v5 offset:8192
  ds_read_b64_tr_b16 v[146:147], v5 offset:9216
  s_waitcnt lgkmcnt(11)
  v_mfma_f32_32x32x16_bf16 v[224:239], v[164:167], v[244:247], v[224:239]
  ds_read_b128 v[244:247], v24 offset:10240
  ds_read_b64_tr_b16 v[148:149], v5 offset:10240
  ds_read_b64_tr_b16 v[150:151], v5 offset:11264
  s_waitcnt lgkmcnt(11)
  v_mfma_f32_32x32x16_bf16 v[224:239], v[168:171], v[248:251], v[224:239]
  ds_read_b128 v[248:251], v24 offset:12288
  ds_read_b64_tr_b16 v[152:153], v5 offset:12288
  ds_read_b64_tr_b16 v[154:155], v5 offset:13312
  s_waitcnt lgkmcnt(11)
  v_mfma_f32_32x32x16_bf16 v[224:239], v[172:175], v[252:255], v[224:239]
  ds_read_b128 v[252:255], v24 offset:14336
  ds_read_b64_tr_b16 v[156:157], v5 offset:14336
  ds_read_b64_tr_b16 v[158:159], v5 offset:15360
  s_waitcnt lgkmcnt(11)
  v_mfma_f32_32x32x16_bf16 v[224:239], v[176:179], v[240:243], v[224:239]
  s_barrier
  v_add_u32 v24, 0xc000, v24
  ds_read_b128 v[240:243], v24 offset:0
  v_add_u32 v5, 0xfffe8000, v5
  ds_read_b64_tr_b16 v[160:161], v5 offset:0
  ds_read_b64_tr_b16 v[162:163], v5 offset:1024
  s_waitcnt lgkmcnt(11)
  v_mfma_f32_32x32x16_bf16 v[224:239], v[180:183], v[244:247], v[224:239]
  ds_read_b128 v[244:247], v24 offset:2048
  ds_read_b64_tr_b16 v[164:165], v5 offset:2048
  ds_read_b64_tr_b16 v[166:167], v5 offset:3072
  s_waitcnt lgkmcnt(11)
  v_mfma_f32_32x32x16_bf16 v[224:239], v[184:187], v[248:251], v[224:239]
  ds_read_b128 v[248:251], v24 offset:4096
  ds_read_b64_tr_b16 v[168:169], v5 offset:4096
  ds_read_b64_tr_b16 v[170:171], v5 offset:5120
  s_waitcnt lgkmcnt(11)
  v_mfma_f32_32x32x16_bf16 v[224:239], v[188:191], v[252:255], v[224:239]
  ds_read_b128 v[252:255], v24 offset:6144
  ds_read_b64_tr_b16 v[172:173], v5 offset:6144
  ds_read_b64_tr_b16 v[174:175], v5 offset:7168
  s_waitcnt lgkmcnt(11)
  v_mfma_f32_32x32x16_bf16 v[32:47], v[192:195], v[240:243], 0
  ds_read_b128 v[240:243], v24 offset:8192
  ds_read_b64_tr_b16 v[176:177], v5 offset:8192
  ds_read_b64_tr_b16 v[178:179], v5 offset:9216
  s_waitcnt lgkmcnt(11)
  v_mfma_f32_32x32x16_bf16 v[32:47], v[196:199], v[244:247], v[32:47]
  ds_read_b128 v[244:247], v24 offset:10240
  ds_read_b64_tr_b16 v[180:181], v5 offset:10240
  ds_read_b64_tr_b16 v[182:183], v5 offset:11264
  v_mul_f32 v80, 0xbfb8aa3b, v224
  v_mul_f32 v81, 0xbfb8aa3b, v225
  v_mul_f32 v82, 0xbfb8aa3b, v226
  v_mul_f32 v83, 0xbfb8aa3b, v227
  v_mul_f32 v84, 0xbfb8aa3b, v228
  s_waitcnt lgkmcnt(11)
  v_mfma_f32_32x32x16_bf16 v[32:47], v[200:203], v[248:251], v[32:47]
  ds_read_b128 v[248:251], v24 offset:12288
  ds_read_b64_tr_b16 v[184:185], v5 offset:12288
  ds_read_b64_tr_b16 v[186:187], v5 offset:13312
  v_mul_f32 v85, 0xbfb8aa3b, v229
  v_mul_f32 v86, 0xbfb8aa3b, v230
  v_mul_f32 v87, 0xbfb8aa3b, v231
  v_mul_f32 v88, 0xbfb8aa3b, v232
  v_mul_f32 v89, 0xbfb8aa3b, v233
  s_waitcnt lgkmcnt(11)
  v_mfma_f32_32x32x16_bf16 v[32:47], v[204:207], v[252:255], v[32:47]
  ds_read_b128 v[252:255], v24 offset:14336
  ds_read_b64_tr_b16 v[188:189], v5 offset:14336
  ds_read_b64_tr_b16 v[190:191], v5 offset:15360
  v_mul_f32 v90, 0xbfb8aa3b, v234
  v_mul_f32 v91, 0xbfb8aa3b, v235
  v_mul_f32 v92, 0xbfb8aa3b, v236
  v_mul_f32 v93, 0xbfb8aa3b, v237
  v_mul_f32 v94, 0xbfb8aa3b, v238
  s_waitcnt lgkmcnt(11)
  v_mfma_f32_32x32x16_bf16 v[32:47], v[208:211], v[240:243], v[32:47]
  s_barrier
  v_add_u32 v24, 0xc000, v24
  ds_read_b128 v[240:243], v24 offset:0
  v_add_u32 v5, 0xc000, v5
  ds_read_b64_tr_b16 v[192:193], v5 offset:0
  ds_read_b64_tr_b16 v[194:195], v5 offset:1024
  v_mul_f32 v95, 0xbfb8aa3b, v239
  v_exp_f32 v80, v80
  v_exp_f32 v81, v81
  s_waitcnt lgkmcnt(11)
  v_mfma_f32_32x32x16_bf16 v[32:47], v[212:215], v[244:247], v[32:47]
  ds_read_b128 v[244:247], v24 offset:2048
  ds_read_b64_tr_b16 v[196:197], v5 offset:2048
  ds_read_b64_tr_b16 v[198:199], v5 offset:3072
  v_exp_f32 v82, v82
  v_exp_f32 v83, v83
  v_exp_f32 v84, v84
  s_waitcnt lgkmcnt(11)
  v_mfma_f32_32x32x16_bf16 v[32:47], v[216:219], v[248:251], v[32:47]
  ds_read_b128 v[248:251], v24 offset:4096
  ds_read_b64_tr_b16 v[200:201], v5 offset:4096
  ds_read_b64_tr_b16 v[202:203], v5 offset:5120
  v_exp_f32 v85, v85
  v_exp_f32 v86, v86
  v_exp_f32 v87, v87
  s_waitcnt lgkmcnt(11)
  v_mfma_f32_32x32x16_bf16 v[32:47], v[220:223], v[252:255], v[32:47]
  ds_read_b128 v[252:255], v24 offset:6144
  ds_read_b64_tr_b16 v[204:205], v5 offset:6144
  ds_read_b64_tr_b16 v[206:207], v5 offset:7168
  v_exp_f32 v88, v88
  v_exp_f32 v89, v89
  v_exp_f32 v90, v90
  s_waitcnt lgkmcnt(11)
  v_mfma_f32_32x32x16_bf16 v[32:47], v[128:131], v[240:243], v[32:47]
  ds_read_b128 v[240:243], v24 offset:8192
  ds_read_b64_tr_b16 v[208:209], v5 offset:8192
  ds_read_b64_tr_b16 v[210:211], v5 offset:9216
  v_exp_f32 v91, v91
  v_exp_f32 v92, v92
  v_exp_f32 v93, v93
  s_waitcnt lgkmcnt(11)
  v_mfma_f32_32x32x16_bf16 v[32:47], v[132:135], v[244:247], v[32:47]
  ds_read_b128 v[244:247], v24 offset:10240
  ds_read_b64_tr_b16 v[212:213], v5 offset:10240
  ds_read_b64_tr_b16 v[214:215], v5 offset:11264
  v_exp_f32 v94, v94
  v_exp_f32 v95, v95
  v_add_f32 v80, 1.0, v80
  s_waitcnt lgkmcnt(11)
  v_mfma_f32_32x32x16_bf16 v[32:47], v[136:139], v[248:251], v[32:47]
  ds_read_b128 v[248:251], v24 offset:12288
  ds_read_b64_tr_b16 v[216:217], v5 offset:12288
  ds_read_b64_tr_b16 v[218:219], v5 offset:13312
  v_add_f32 v81, 1.0, v81
  v_add_f32 v82, 1.0, v82
  v_add_f32 v83, 1.0, v83
  v_add_f32 v84, 1.0, v84
  v_add_f32 v85, 1.0, v85
  s_waitcnt lgkmcnt(11)
  v_mfma_f32_32x32x16_bf16 v[32:47], v[140:143], v[252:255], v[32:47]
  ds_read_b128 v[252:255], v24 offset:14336
  ds_read_b64_tr_b16 v[220:221], v5 offset:14336
  ds_read_b64_tr_b16 v[222:223], v5 offset:15360
  v_add_f32 v86, 1.0, v86
  v_add_f32 v87, 1.0, v87
  v_add_f32 v88, 1.0, v88
  v_add_f32 v89, 1.0, v89
  v_add_f32 v90, 1.0, v90
  s_waitcnt lgkmcnt(11)
  v_mfma_f32_32x32x16_bf16 v[32:47], v[144:147], v[240:243], v[32:47]
  s_barrier
  v_add_u32 v24, 0xffff0000, v24
  ds_read_b128 v[240:243], v24 offset:0
  v_add_f32 v91, 1.0, v91
  v_add_f32 v92, 1.0, v92
  v_add_f32 v93, 1.0, v93
  v_add_f32 v94, 1.0, v94
  v_add_f32 v95, 1.0, v95
  s_waitcnt lgkmcnt(9)
  v_mfma_f32_32x32x16_bf16 v[32:47], v[148:151], v[244:247], v[32:47]
  ds_read_b128 v[244:247], v24 offset:2048
  v_rcp_f32 v80, v80
  v_rcp_f32 v81, v81
  v_rcp_f32 v82, v82
  s_waitcnt lgkmcnt(7)
  v_mfma_f32_32x32x16_bf16 v[32:47], v[152:155], v[248:251], v[32:47]
  ds_read_b128 v[248:251], v24 offset:4096
  s_lshl_b32 s4, s57, 12
  s_add_u32 s4, s4, 8192
  v_add_u32 v19, s4, v19
  ds_read_b128 v[48:51], v19
  ds_read_b128 v[52:55], v19 offset:32
  v_rcp_f32 v83, v83
  v_rcp_f32 v84, v84
  v_rcp_f32 v85, v85
  s_waitcnt lgkmcnt(7)
  v_mfma_f32_32x32x16_bf16 v[32:47], v[156:159], v[252:255], v[32:47]
  ds_read_b128 v[252:255], v24 offset:6144
  v_rcp_f32 v86, v86
  v_rcp_f32 v87, v87
  v_rcp_f32 v88, v88
  s_waitcnt lgkmcnt(5)
  v_mfma_f32_32x32x16_bf16 v[32:47], v[160:163], v[240:243], v[32:47]
  ds_read_b128 v[240:243], v24 offset:8192
  v_rcp_f32 v89, v89
  v_rcp_f32 v90, v90
  v_rcp_f32 v91, v91
  s_waitcnt lgkmcnt(5)
  v_mfma_f32_32x32x16_bf16 v[32:47], v[164:167], v[244:247], v[32:47]
  ds_read_b128 v[244:247], v24 offset:10240
  v_rcp_f32 v92, v92
  v_rcp_f32 v93, v93
  v_rcp_f32 v94, v94
  s_waitcnt lgkmcnt(5)
  v_mfma_f32_32x32x16_bf16 v[32:47], v[168:171], v[248:251], v[32:47]
  ds_read_b128 v[248:251], v24 offset:12288
  v_rcp_f32 v95, v95
  v_mul_f32 v224, v224, v80
  v_mul_f32 v225, v225, v81
  v_mul_f32 v226, v226, v82
  s_waitcnt lgkmcnt(3)
  v_mfma_f32_32x32x16_bf16 v[32:47], v[172:175], v[252:255], v[32:47]
  ds_read_b128 v[252:255], v24 offset:14336
  v_mul_f32 v227, v227, v83
  v_mul_f32 v228, v228, v84
  v_mul_f32 v229, v229, v85
  v_mul_f32 v230, v230, v86
  v_mul_f32 v231, v231, v87
  s_waitcnt lgkmcnt(3)
  v_mfma_f32_32x32x16_bf16 v[32:47], v[176:179], v[240:243], v[32:47]
  s_barrier
  v_add_u32 v24, 0xc000, v24
  ds_read_b128 v[240:243], v24 offset:0
  v_mul_f32 v232, v232, v88
  v_mul_f32 v233, v233, v89
  v_mul_f32 v234, v234, v90
  v_mul_f32 v235, v235, v91
  v_mul_f32 v236, v236, v92
  s_waitcnt lgkmcnt(3)
  v_mfma_f32_32x32x16_bf16 v[32:47], v[180:183], v[244:247], v[32:47]
  ds_read_b128 v[244:247], v24 offset:2048
  v_mul_f32 v237, v237, v93
  v_mul_f32 v238, v238, v94
  v_mul_f32 v239, v239, v95
  v_permlane32_swap_b32 v48, v50
  v_permlane32_swap_b32 v49, v51
  s_waitcnt lgkmcnt(3)
  v_mfma_f32_32x32x16_bf16 v[32:47], v[184:187], v[248:251], v[32:47]
  ds_read_b128 v[248:251], v24 offset:4096
  v_permlane32_swap_b32 v52, v54
  v_permlane32_swap_b32 v53, v55
  v_lshlrev_b32 v64, 16, v48
  v_and_b32 v65, 0xffff0000, v48
  v_lshlrev_b32 v66, 16, v49
  s_waitcnt lgkmcnt(3)
  v_mfma_f32_32x32x16_bf16 v[32:47], v[188:191], v[252:255], v[32:47]
  ds_read_b128 v[252:255], v24 offset:6144
  v_and_b32 v67, 0xffff0000, v49
  v_lshlrev_b32 v68, 16, v50
  v_and_b32 v69, 0xffff0000, v50
  v_lshlrev_b32 v70, 16, v51
  v_and_b32 v71, 0xffff0000, v51
  s_waitcnt lgkmcnt(3)
  v_mfma_f32_32x32x16_bf16 v[32:47], v[192:195], v[240:243], v[32:47]
  ds_read_b128 v[240:243], v24 offset:8192
  v_lshlrev_b32 v72, 16, v52
  v_and_b32 v73, 0xffff0000, v52
  v_lshlrev_b32 v74, 16, v53
  v_and_b32 v75, 0xffff0000, v53
  v_lshlrev_b32 v76, 16, v54
  s_waitcnt lgkmcnt(3)
  v_mfma_f32_32x32x16_bf16 v[32:47], v[196:199], v[244:247], v[32:47]
  ds_read_b128 v[244:247], v24 offset:10240
  v_and_b32 v77, 0xffff0000, v54
  v_lshlrev_b32 v78, 16, v55
  v_and_b32 v79, 0xffff0000, v55
  s_waitcnt lgkmcnt(3)
  v_mfma_f32_32x32x16_bf16 v[32:47], v[200:203], v[248:251], v[32:47]
  ds_read_b128 v[248:251], v24 offset:12288
  s_waitcnt lgkmcnt(3)
  v_mfma_f32_32x32x16_bf16 v[32:47], v[204:207], v[252:255], v[32:47]
  ds_read_b128 v[252:255], v24 offset:14336
  s_waitcnt lgkmcnt(3)
  v_mfma_f32_32x32x16_bf16 v[32:47], v[208:211], v[240:243], v[32:47]
  s_waitcnt lgkmcnt(2)
  v_mfma_f32_32x32x16_bf16 v[32:47], v[212:215], v[244:247], v[32:47]
  s_waitcnt lgkmcnt(1)
  v_mfma_f32_32x32x16_bf16 v[32:47], v[216:219], v[248:251], v[32:47]
  s_waitcnt lgkmcnt(0)
  v_mfma_f32_32x32x16_bf16 v[32:47], v[220:223], v[252:255], v[32:47]
  s_nop 11
  v_fma_f32 v32, v32, v224, v64
  v_fma_f32 v33, v33, v225, v65
  v_fma_f32 v34, v34, v226, v66
  v_fma_f32 v35, v35, v227, v67
  v_fma_f32 v36, v36, v228, v68
  v_fma_f32 v37, v37, v229, v69
  v_fma_f32 v38, v38, v230, v70
  v_fma_f32 v39, v39, v231, v71
  v_cvt_pk_bf16_f32 v48, v32, v33
  v_cvt_pk_bf16_f32 v49, v34, v35
  v_cvt_pk_bf16_f32 v50, v36, v37
  v_cvt_pk_bf16_f32 v51, v38, v39
  s_nop 0
  v_permlane32_swap_b32 v48, v50
  v_permlane32_swap_b32 v49, v51
  buffer_store_dwordx4 v[48:51], v20, s[36:39], s7 offen offset:0
  v_fma_f32 v40, v40, v232, v72
  v_fma_f32 v41, v41, v233, v73
  v_fma_f32 v42, v42, v234, v74
  v_fma_f32 v43, v43, v235, v75
  v_fma_f32 v44, v44, v236, v76
  v_fma_f32 v45, v45, v237, v77
  v_fma_f32 v46, v46, v238, v78
  v_fma_f32 v47, v47, v239, v79
  v_cvt_pk_bf16_f32 v52, v40, v41
  v_cvt_pk_bf16_f32 v53, v42, v43
  v_cvt_pk_bf16_f32 v54, v44, v45
  v_cvt_pk_bf16_f32 v55, v46, v47
  s_nop 0
  v_permlane32_swap_b32 v52, v54
  v_permlane32_swap_b32 v53, v55
  buffer_store_dwordx4 v[52:55], v20, s[36:39], s7 offen offset:32
  s_endpgm
L_typeA1:
  s_lshl_b32 s72, s48, 12
  s_add_u32 s72, s72, 32768
  s_waitcnt vmcnt(8)
  s_barrier
  ds_read_b128 v[128:131], v64 offset:0
  ds_read_b128 v[132:135], v65 offset:0
  ds_read_b64_tr_b16 v[80:81], v6 offset:49152
  ds_read_b64_tr_b16 v[82:83], v6 offset:49664
  ds_read_b128 v[136:139], v66 offset:0
  ds_read_b128 v[140:143], v67 offset:0
  ds_read_b128 v[144:147], v68 offset:0
  ds_read_b64_tr_b16 v[84:85], v6 offset:51200
  ds_read_b64_tr_b16 v[86:87], v6 offset:51712
  ds_read_b128 v[148:151], v69 offset:0
  ds_read_b128 v[152:155], v70 offset:0
  ds_read_b128 v[156:159], v71 offset:0
  ds_read_b64_tr_b16 v[88:89], v7 offset:49152
  ds_read_b64_tr_b16 v[90:91], v7 offset:49664
  ds_read_b64_tr_b16 v[92:93], v7 offset:51200
  ds_read_b64_tr_b16 v[94:95], v7 offset:51712
  s_waitcnt lgkmcnt(12)
  v_mfma_f32_32x32x16_bf16 v[32:47], v[80:83], v[128:131], 0
  v_mfma_f32_16x16x32_bf16 v[124:127], v[120:123], v[80:83], 0
  s_waitcnt lgkmcnt(4)
  s_barrier
  ds_read_b64_tr_b16 v[80:81], v8 offset:49152
  ds_read_b64_tr_b16 v[82:83], v8 offset:49664
  v_mfma_f32_32x32x16_bf16 v[32:47], v[84:87], v[132:135], v[32:47]
  v_mfma_f32_16x16x32_bf16 v[124:127], v[120:123], v[84:87], v[124:127]
  ds_read_b64_tr_b16 v[84:85], v8 offset:51200
  ds_read_b64_tr_b16 v[86:87], v8 offset:51712
  s_add_u32 m0, s61, 0x0
  s_mul_i32 s89, s100, 256
  s_add_u32 s89, s89, s86
  s_add_u32 s62, s89, 0x0
  buffer_load_dwordx4 v72, s[8:11], s62 offen lds
  s_add_u32 m0, s61, 0x400
  s_add_u32 s62, s89, 0x0
  buffer_load_dwordx4 v73, s[8:11], s62 offen lds
  v_dot2_f32_bf16 v96, v132, s60, 0
  v_dot2_f32_bf16 v98, v132, v132, 0
  v_dot2_f32_bf16 v97, v133, s60, 0
  v_dot2_f32_bf16 v99, v133, v133, 0
  v_dot2_f32_bf16 v96, v134, s60, v96
  v_dot2_f32_bf16 v98, v134, v134, v98
  v_dot2_f32_bf16 v97, v135, s60, v97
  v_dot2_f32_bf16 v99, v135, v135, v99
  v_dot2_f32_bf16 v96, v140, s60, v96
  v_dot2_f32_bf16 v98, v140, v140, v98
  v_dot2_f32_bf16 v97, v141, s60, v97
  v_dot2_f32_bf16 v99, v141, v141, v99
  v_dot2_f32_bf16 v96, v142, s60, v96
  v_dot2_f32_bf16 v98, v142, v142, v98
  v_dot2_f32_bf16 v97, v143, s60, v97
  v_dot2_f32_bf16 v99, v143, v143, v99
  s_waitcnt lgkmcnt(6)
  v_mfma_f32_32x32x16_bf16 v[32:47], v[88:91], v[136:139], v[32:47]
  ds_read_b64_tr_b16 v[88:89], v9 offset:49152
  ds_read_b64_tr_b16 v[90:91], v9 offset:49664
  s_waitcnt lgkmcnt(6)
  v_mfma_f32_32x32x16_bf16 v[32:47], v[92:95], v[140:143], v[32:47]
  ds_read_b64_tr_b16 v[92:93], v9 offset:51200
  ds_read_b64_tr_b16 v[94:95], v9 offset:51712
  s_add_u32 m0, s61, 0x4000
  s_add_u32 s62, s89, 0x10000
  buffer_load_dwordx4 v72, s[8:11], s62 offen lds
  s_add_u32 m0, s61, 0x4400
  s_add_u32 s62, s89, 0x10000
  buffer_load_dwordx4 v73, s[8:11], s62 offen lds
  v_dot2_f32_bf16 v96, v148, s60, v96
  v_dot2_f32_bf16 v98, v148, v148, v98
  v_dot2_f32_bf16 v97, v149, s60, v97
  v_dot2_f32_bf16 v99, v149, v149, v99
  v_dot2_f32_bf16 v96, v150, s60, v96
  v_dot2_f32_bf16 v98, v150, v150, v98
  v_dot2_f32_bf16 v97, v151, s60, v97
  v_dot2_f32_bf16 v99, v151, v151, v99
  v_dot2_f32_bf16 v96, v156, s60, v96
  v_dot2_f32_bf16 v98, v156, v156, v98
  v_dot2_f32_bf16 v97, v157, s60, v97
  v_dot2_f32_bf16 v99, v157, v157, v99
  v_dot2_f32_bf16 v96, v158, s60, v96
  v_dot2_f32_bf16 v98, v158, v158, v98
  v_dot2_f32_bf16 v97, v159, s60, v97
  v_dot2_f32_bf16 v99, v159, v159, v99
  s_waitcnt lgkmcnt(6)
  v_mfma_f32_32x32x16_bf16 v[32:47], v[80:83], v[144:147], v[32:47]
  s_waitcnt vmcnt(6)
  s_barrier
  ds_read_b128 v[160:163], v64 offset:32768
  ds_read_b128 v[164:167], v65 offset:32768
  ds_read_b64_tr_b16 v[80:81], v10 offset:0
  ds_read_b64_tr_b16 v[82:83], v10 offset:512
  s_waitcnt lgkmcnt(8)
  v_mfma_f32_32x32x16_bf16 v[32:47], v[84:87], v[148:151], v[32:47]
  ds_read_b128 v[168:171], v66 offset:32768
  ds_read_b128 v[172:175], v67 offset:32768
  ds_read_b128 v[176:179], v68 offset:32768
  ds_read_b64_tr_b16 v[84:85], v10 offset:2048
  ds_read_b64_tr_b16 v[86:87], v10 offset:2560
  s_add_u32 m0, s61, 0x18000
  s_mul_i32 s89, s100, 393216
  s_add_u32 s89, s89, s63
  s_add_u32 s62, s89, 0x0
  buffer_load_dwordx4 v2, s[12:15], s62 offen lds
  s_add_u32 m0, s61, 0x18400
  s_add_u32 s62, s89, 0x6000
  buffer_load_dwordx4 v2, s[12:15], s62 offen lds
  s_waitcnt lgkmcnt(11)
  v_mfma_f32_32x32x16_bf16 v[32:47], v[88:91], v[152:155], v[32:47]
  ds_read_b128 v[180:183], v69 offset:32768
  ds_read_b128 v[184:187], v70 offset:32768
  ds_read_b128 v[188:191], v71 offset:32768
  ds_read_b64_tr_b16 v[88:89], v11 offset:0
  ds_read_b64_tr_b16 v[90:91], v11 offset:512
  v_lshrrev_b32 v31, 1, v30
  buffer_load_ushort v23, v31, s[32:35], s92 offen
  s_lshl_b32 s3, s52, 11
  s_lshl_b32 s4, s57, 10
  s_add_u32 s3, s3, s4
  s_add_u32 m0, s4, 147456
  s_nop 0
  buffer_load_dwordx4 v1, s[28:31], s3 offen lds
  s_waitcnt lgkmcnt(14)
  v_mfma_f32_32x32x16_bf16 v[32:47], v[92:95], v[156:159], v[32:47]
  ds_read_b64_tr_b16 v[92:93], v11 offset:2048
  ds_read_b64_tr_b16 v[94:95], v11 offset:2560
  s_add_u32 m0, s61, 0x1c000
  s_mul_i32 s89, s101, 393216
  s_add_u32 s89, s89, s63
  s_add_u32 s62, s89, 0x0
  buffer_load_dwordx4 v2, s[12:15], s62 offen lds
  s_add_u32 m0, s61, 0x1c400
  s_add_u32 s62, s89, 0x6000
  buffer_load_dwordx4 v2, s[12:15], s62 offen lds
  s_waitcnt lgkmcnt(12)
  v_mfma_f32_32x32x16_bf16 v[32:47], v[80:83], v[160:163], v[32:47]
  v_mfma_f32_16x16x32_bf16 v[124:127], v[120:123], v[80:83], v[124:127]
  s_waitcnt lgkmcnt(4)
  s_barrier
  ds_read_b64_tr_b16 v[80:81], v12 offset:0
  ds_read_b64_tr_b16 v[82:83], v12 offset:512
  v_mfma_f32_32x32x16_bf16 v[32:47], v[84:87], v[164:167], v[32:47]
  v_mfma_f32_16x16x32_bf16 v[124:127], v[120:123], v[84:87], v[124:127]
  ds_read_b64_tr_b16 v[84:85], v12 offset:2048
  ds_read_b64_tr_b16 v[86:87], v12 offset:2560
  s_add_u32 m0, s61, 0x8000
  s_mul_i32 s89, s101, 256
  s_add_u32 s89, s89, s86
  s_add_u32 s62, s89, 0x0
  buffer_load_dwordx4 v72, s[8:11], s62 offen lds
  s_add_u32 m0, s61, 0x8400
  s_add_u32 s62, s89, 0x0
  buffer_load_dwordx4 v73, s[8:11], s62 offen lds
  v_dot2_f32_bf16 v96, v164, s60, v96
  v_dot2_f32_bf16 v98, v164, v164, v98
  v_dot2_f32_bf16 v97, v165, s60, v97
  v_dot2_f32_bf16 v99, v165, v165, v99
  v_dot2_f32_bf16 v96, v166, s60, v96
  v_dot2_f32_bf16 v98, v166, v166, v98
  v_dot2_f32_bf16 v97, v167, s60, v97
  v_dot2_f32_bf16 v99, v167, v167, v99
  v_dot2_f32_bf16 v96, v172, s60, v96
  v_dot2_f32_bf16 v98, v172, v172, v98
  v_dot2_f32_bf16 v97, v173, s60, v97
  v_dot2_f32_bf16 v99, v173, v173, v99
  v_dot2_f32_bf16 v96, v174, s60, v96
  v_dot2_f32_bf16 v98, v174, v174, v98
  v_dot2_f32_bf16 v97, v175, s60, v97
  v_dot2_f32_bf16 v99, v175, v175, v99
  s_waitcnt lgkmcnt(6)
  v_mfma_f32_32x32x16_bf16 v[32:47], v[88:91], v[168:171], v[32:47]
  ds_read_b64_tr_b16 v[88:89], v13 offset:0
  ds_read_b64_tr_b16 v[90:91], v13 offset:512
  s_waitcnt lgkmcnt(6)
  v_mfma_f32_32x32x16_bf16 v[32:47], v[92:95], v[172:175], v[32:47]
  ds_read_b64_tr_b16 v[92:93], v13 offset:2048
  ds_read_b64_tr_b16 v[94:95], v13 offset:2560
  s_add_u32 m0, s61, 0xc000
  s_add_u32 s62, s89, 0x10000
  buffer_load_dwordx4 v72, s[8:11], s62 offen lds
  s_add_u32 m0, s61, 0xc400
  s_add_u32 s62, s89, 0x10000
  buffer_load_dwordx4 v73, s[8:11], s62 offen lds
  v_dot2_f32_bf16 v96, v180, s60, v96
  v_dot2_f32_bf16 v98, v180, v180, v98
  v_dot2_f32_bf16 v97, v181, s60, v97
  v_dot2_f32_bf16 v99, v181, v181, v99
  v_dot2_f32_bf16 v96, v182, s60, v96
  v_dot2_f32_bf16 v98, v182, v182, v98
  v_dot2_f32_bf16 v97, v183, s60, v97
  v_dot2_f32_bf16 v99, v183, v183, v99
  v_dot2_f32_bf16 v96, v188, s60, v96
  v_dot2_f32_bf16 v98, v188, v188, v98
  v_dot2_f32_bf16 v97, v189, s60, v97
  v_dot2_f32_bf16 v99, v189, v189, v99
  v_dot2_f32_bf16 v96, v190, s60, v96
  v_dot2_f32_bf16 v98, v190, v190, v98
  v_dot2_f32_bf16 v97, v191, s60, v97
  v_dot2_f32_bf16 v99, v191, v191, v99
  s_waitcnt lgkmcnt(6)
  v_mfma_f32_32x32x16_bf16 v[32:47], v[80:83], v[176:179], v[32:47]
  s_waitcnt vmcnt(8)
  s_barrier
  ds_read_b128 v[192:195], v64 offset:0
  ds_read_b128 v[196:199], v65 offset:0
  ds_read_b64_tr_b16 v[80:81], v10 offset:16384
  ds_read_b64_tr_b16 v[82:83], v10 offset:16896
  s_waitcnt lgkmcnt(8)
  v_mfma_f32_32x32x16_bf16 v[32:47], v[84:87], v[180:183], v[32:47]
  ds_read_b128 v[200:203], v66 offset:0
  ds_read_b128 v[204:207], v67 offset:0
  ds_read_b128 v[208:211], v68 offset:0
  ds_read_b64_tr_b16 v[84:85], v10 offset:18432
  ds_read_b64_tr_b16 v[86:87], v10 offset:18944
  s_add_u32 m0, s61, 0x20000
  s_mul_i32 s89, s98, 393216
  s_add_u32 s89, s89, s6
  s_add_u32 s62, s89, 0x0
  buffer_load_dwordx4 v2, s[12:15], s62 offen lds
  s_add_u32 m0, s61, 0x20400
  s_add_u32 s62, s89, 0x6000
  buffer_load_dwordx4 v2, s[12:15], s62 offen lds
  s_waitcnt lgkmcnt(11)
  v_mfma_f32_32x32x16_bf16 v[32:47], v[88:91], v[184:187], v[32:47]
  ds_read_b128 v[212:215], v69 offset:0
  ds_read_b128 v[216:219], v70 offset:0
  ds_read_b128 v[220:223], v71 offset:0
  ds_read_b64_tr_b16 v[88:89], v11 offset:16384
  ds_read_b64_tr_b16 v[90:91], v11 offset:16896
  s_waitcnt lgkmcnt(14)
  v_mfma_f32_32x32x16_bf16 v[32:47], v[92:95], v[188:191], v[32:47]
  ds_read_b64_tr_b16 v[92:93], v11 offset:18432
  ds_read_b64_tr_b16 v[94:95], v11 offset:18944
  s_add_u32 m0, s61, 0x10000
  s_mul_i32 s89, s99, 393216
  s_add_u32 s89, s89, s6
  s_add_u32 s62, s89, 0x0
  buffer_load_dwordx4 v2, s[12:15], s62 offen lds
  s_add_u32 m0, s61, 0x10400
  s_add_u32 s62, s89, 0x6000
  buffer_load_dwordx4 v2, s[12:15], s62 offen lds
  s_waitcnt lgkmcnt(12)
  v_mfma_f32_32x32x16_bf16 v[32:47], v[80:83], v[192:195], v[32:47]
  v_mfma_f32_16x16x32_bf16 v[124:127], v[120:123], v[80:83], v[124:127]
  ds_read_b64_tr_b16 v[80:81], v12 offset:16384
  ds_read_b64_tr_b16 v[82:83], v12 offset:16896
  s_waitcnt lgkmcnt(9)
  v_mfma_f32_32x32x16_bf16 v[32:47], v[84:87], v[196:199], v[32:47]
  v_mfma_f32_16x16x32_bf16 v[124:127], v[120:123], v[84:87], v[124:127]
  ds_read_b64_tr_b16 v[84:85], v12 offset:18432
  ds_read_b64_tr_b16 v[86:87], v12 offset:18944
  v_dot2_f32_bf16 v96, v196, s60, v96
  v_dot2_f32_bf16 v98, v196, v196, v98
  v_dot2_f32_bf16 v97, v197, s60, v97
  v_dot2_f32_bf16 v99, v197, v197, v99
  v_dot2_f32_bf16 v96, v198, s60, v96
  v_dot2_f32_bf16 v98, v198, v198, v98
  v_dot2_f32_bf16 v97, v199, s60, v97
  v_dot2_f32_bf16 v99, v199, v199, v99
  v_dot2_f32_bf16 v96, v204, s60, v96
  v_dot2_f32_bf16 v98, v204, v204, v98
  v_dot2_f32_bf16 v97, v205, s60, v97
  v_dot2_f32_bf16 v99, v205, v205, v99
  v_dot2_f32_bf16 v96, v206, s60, v96
  v_dot2_f32_bf16 v98, v206, v206, v98
  v_dot2_f32_bf16 v97, v207, s60, v97
  v_dot2_f32_bf16 v99, v207, v207, v99
  s_waitcnt lgkmcnt(6)
  v_mfma_f32_32x32x16_bf16 v[32:47], v[88:91], v[200:203], v[32:47]
  ds_read_b64_tr_b16 v[88:89], v13 offset:16384
  ds_read_b64_tr_b16 v[90:91], v13 offset:16896
  s_waitcnt lgkmcnt(6)
  v_mfma_f32_32x32x16_bf16 v[32:47], v[92:95], v[204:207], v[32:47]
  ds_read_b64_tr_b16 v[92:93], v13 offset:18432
  ds_read_b64_tr_b16 v[94:95], v13 offset:18944
  v_dot2_f32_bf16 v96, v212, s60, v96
  v_dot2_f32_bf16 v98, v212, v212, v98
  v_dot2_f32_bf16 v97, v213, s60, v97
  v_dot2_f32_bf16 v99, v213, v213, v99
  v_dot2_f32_bf16 v96, v214, s60, v96
  v_dot2_f32_bf16 v98, v214, v214, v98
  v_dot2_f32_bf16 v97, v215, s60, v97
  v_dot2_f32_bf16 v99, v215, v215, v99
  v_dot2_f32_bf16 v96, v220, s60, v96
  v_dot2_f32_bf16 v98, v220, v220, v98
  v_dot2_f32_bf16 v97, v221, s60, v97
  v_dot2_f32_bf16 v99, v221, v221, v99
  v_dot2_f32_bf16 v96, v222, s60, v96
  v_dot2_f32_bf16 v98, v222, v222, v98
  v_dot2_f32_bf16 v97, v223, s60, v97
  v_dot2_f32_bf16 v99, v223, v223, v99
  s_waitcnt lgkmcnt(6)
  v_mfma_f32_32x32x16_bf16 v[32:47], v[80:83], v[208:211], v[32:47]
  s_waitcnt vmcnt(10)
  s_waitcnt vmcnt(8)
  s_waitcnt vmcnt(6)
  s_waitcnt vmcnt(4)
  s_waitcnt vmcnt(2)
  s_barrier
  ds_read_b128 v[224:227], v64 offset:32768
  ds_read_b128 v[228:231], v65 offset:32768
  ds_read_b64_tr_b16 v[80:81], v10 offset:32768
  ds_read_b64_tr_b16 v[82:83], v10 offset:33280
  s_waitcnt lgkmcnt(8)
  v_mfma_f32_32x32x16_bf16 v[32:47], v[84:87], v[212:215], v[32:47]
  ds_read_b128 v[232:235], v66 offset:32768
  ds_read_b128 v[236:239], v67 offset:32768
  ds_read_b128 v[240:243], v68 offset:32768
  ds_read_b64_tr_b16 v[84:85], v10 offset:34816
  ds_read_b64_tr_b16 v[86:87], v10 offset:35328
  s_add_u32 m0, s61, 0x14000
  s_mul_i32 s89, s100, 393216
  s_add_u32 s89, s89, s6
  s_add_u32 s62, s89, 0x0
  buffer_load_dwordx4 v2, s[12:15], s62 offen lds
  s_add_u32 m0, s61, 0x14400
  s_add_u32 s62, s89, 0x6000
  buffer_load_dwordx4 v2, s[12:15], s62 offen lds
  s_waitcnt lgkmcnt(11)
  v_mfma_f32_32x32x16_bf16 v[32:47], v[88:91], v[216:219], v[32:47]
  ds_read_b128 v[244:247], v69 offset:32768
  ds_read_b128 v[248:251], v70 offset:32768
  ds_read_b128 v[252:255], v71 offset:32768
  ds_read_b64_tr_b16 v[88:89], v11 offset:32768
  ds_read_b64_tr_b16 v[90:91], v11 offset:33280
  s_waitcnt lgkmcnt(14)
  v_mfma_f32_32x32x16_bf16 v[32:47], v[92:95], v[220:223], v[32:47]
  ds_read_b64_tr_b16 v[92:93], v11 offset:34816
  ds_read_b64_tr_b16 v[94:95], v11 offset:35328
  s_add_u32 m0, s61, 0x4000
  s_mul_i32 s89, s101, 393216
  s_add_u32 s89, s89, s6
  s_add_u32 s62, s89, 0x0
  buffer_load_dwordx4 v2, s[12:15], s62 offen lds
  s_add_u32 m0, s61, 0x4400
  s_add_u32 s62, s89, 0x6000
  buffer_load_dwordx4 v2, s[12:15], s62 offen lds
  s_waitcnt lgkmcnt(12)
  v_mfma_f32_32x32x16_bf16 v[32:47], v[80:83], v[224:227], v[32:47]
  v_mfma_f32_16x16x32_bf16 v[124:127], v[120:123], v[80:83], v[124:127]
  ds_read_b64_tr_b16 v[80:81], v12 offset:32768
  ds_read_b64_tr_b16 v[82:83], v12 offset:33280
  s_waitcnt lgkmcnt(9)
  v_mfma_f32_32x32x16_bf16 v[32:47], v[84:87], v[228:231], v[32:47]
  v_mfma_f32_16x16x32_bf16 v[124:127], v[120:123], v[84:87], v[124:127]
  ds_read_b64_tr_b16 v[84:85], v12 offset:34816
  ds_read_b64_tr_b16 v[86:87], v12 offset:35328
  v_dot2_f32_bf16 v96, v228, s60, v96
  v_dot2_f32_bf16 v98, v228, v228, v98
  v_dot2_f32_bf16 v97, v229, s60, v97
  v_dot2_f32_bf16 v99, v229, v229, v99
  v_dot2_f32_bf16 v96, v230, s60, v96
  v_dot2_f32_bf16 v98, v230, v230, v98
  v_dot2_f32_bf16 v97, v231, s60, v97
  v_dot2_f32_bf16 v99, v231, v231, v99
  v_dot2_f32_bf16 v96, v236, s60, v96
  v_dot2_f32_bf16 v98, v236, v236, v98
  v_dot2_f32_bf16 v97, v237, s60, v97
  v_dot2_f32_bf16 v99, v237, v237, v99
  v_dot2_f32_bf16 v96, v238, s60, v96
  v_dot2_f32_bf16 v98, v238, v238, v98
  v_dot2_f32_bf16 v97, v239, s60, v97
  v_dot2_f32_bf16 v99, v239, v239, v99
  s_waitcnt lgkmcnt(6)
  v_mfma_f32_32x32x16_bf16 v[32:47], v[88:91], v[232:235], v[32:47]
  ds_read_b64_tr_b16 v[88:89], v13 offset:32768
  ds_read_b64_tr_b16 v[90:91], v13 offset:33280
  s_waitcnt lgkmcnt(6)
  v_mfma_f32_32x32x16_bf16 v[32:47], v[92:95], v[236:239], v[32:47]
  ds_read_b64_tr_b16 v[92:93], v13 offset:34816
  ds_read_b64_tr_b16 v[94:95], v13 offset:35328
  s_add_u32 m0, s61, 0x0
  s_add_u32 s62, s68, 0x10000
  buffer_load_dwordx4 v4, s[20:23], s62 offen lds
  s_lshl_b32 s3, s49, 2
  s_add_u32 s3, s3, 155136
  v_add_u32 v125, s3, v1
  ds_write_b32 v125, v124
  v_dot2_f32_bf16 v96, v244, s60, v96
  v_dot2_f32_bf16 v98, v244, v244, v98
  v_dot2_f32_bf16 v97, v245, s60, v97
  v_dot2_f32_bf16 v99, v245, v245, v99
  v_dot2_f32_bf16 v96, v246, s60, v96
  v_dot2_f32_bf16 v98, v246, v246, v98
  v_dot2_f32_bf16 v97, v247, s60, v97
  v_dot2_f32_bf16 v99, v247, v247, v99
  v_dot2_f32_bf16 v96, v252, s60, v96
  v_dot2_f32_bf16 v98, v252, v252, v98
  v_dot2_f32_bf16 v97, v253, s60, v97
  v_dot2_f32_bf16 v99, v253, v253, v99
  v_dot2_f32_bf16 v96, v254, s60, v96
  v_dot2_f32_bf16 v98, v254, v254, v98
  v_dot2_f32_bf16 v97, v255, s60, v97
  v_dot2_f32_bf16 v99, v255, v255, v99
  s_nop 1
  v_add_f32 v96, v96, v97
  v_add_f32 v97, v98, v99
  v_lshrrev_b32 v98, 5, v0
  v_lshlrev_b32 v98, 3, v98
  v_lshl_add_u32 v98, v30, 3, v98
  s_lshl_b32 s3, s49, 10
  s_add_u32 s3, s3, 150032
  v_add_u32 v98, s3, v98
  ds_write_b64 v98, v[96:97]
  s_waitcnt lgkmcnt(8)
  v_mfma_f32_32x32x16_bf16 v[32:47], v[80:83], v[240:243], v[32:47]
  ds_read_b64_tr_b16 v[80:81], v10 offset:49152
  ds_read_b64_tr_b16 v[82:83], v10 offset:49664
  s_lshl_b32 s4, s75, 3
  s_add_u32 s4, s4, s48
  s_mul_i32 s5, s4, 896
  s_lshl_b32 s4, s4, 8
  s_mov_b32 m0, 162816
  v_min_u32 v31, 6, v0
  v_lshlrev_b32 v31, 7, v31
  buffer_load_dword v31, s[20:23], s5 offen lds
  v_min_u32 v31, 1, v0
  v_lshlrev_b32 v31, 7, v31
  buffer_load_dword v31, s[24:27], s4 offen lds
  s_waitcnt lgkmcnt(8)
  v_mfma_f32_32x32x16_bf16 v[32:47], v[84:87], v[244:247], v[32:47]
  ds_read_b64_tr_b16 v[84:85], v10 offset:51200
  ds_read_b64_tr_b16 v[86:87], v10 offset:51712
  s_add_u32 m0, s61, 0x400
  s_add_u32 s62, s68, 0x12000
  buffer_load_dwordx4 v4, s[20:23], s62 offen lds
  v_bfe_u32 v25, v0, 2, 2
  v_lshrrev_b32 v26, 5, v0
  v_lshl_add_u32 v25, v26, 2, v25
  v_lshlrev_b32 v25, 5, v25
  v_bfe_u32 v26, v0, 4, 1
  v_lshl_add_u32 v25, v26, 4, v25
  v_bfe_u32 v26, v0, 1, 1
  v_lshl_add_u32 v25, v26, 3, v25
  s_lshl_b32 s4, s50, 10
  s_add_u32 s4, s4, 147456
  v_add_u32 v25, s4, v25
  ds_read_b64_tr_b16 v[112:113], v25 offset:0
  ds_read_b64_tr_b16 v[114:115], v25 offset:256
  ds_read_b64_tr_b16 v[116:117], v25 offset:512
  ds_read_b64_tr_b16 v[118:119], v25 offset:768
  v_bfe_u32 v26, v0, 2, 1
  v_mul_u32_u24 v26, 0x8000, v26
  v_lshl_or_b32 v26, v26, 16, v26
  s_waitcnt lgkmcnt(3)
  v_xor_b32 v112, v26, v112
  v_xor_b32 v113, v26, v113
  s_waitcnt lgkmcnt(2)
  v_xor_b32 v114, v26, v114
  v_xor_b32 v115, v26, v115
  s_waitcnt lgkmcnt(1)
  v_xor_b32 v116, v26, v116
  v_xor_b32 v117, v26, v117
  s_waitcnt lgkmcnt(0)
  v_xor_b32 v118, v26, v118
  v_xor_b32 v119, v26, v119
  v_mfma_f32_32x32x16_bf16 v[32:47], v[88:91], v[248:251], v[32:47]
  ds_read_b64_tr_b16 v[88:89], v11 offset:49152
  ds_read_b64_tr_b16 v[90:91], v11 offset:49664
  v_mfma_f32_32x32x16_bf16 v[32:47], v[92:95], v[252:255], v[32:47]
  ds_read_b64_tr_b16 v[92:93], v11 offset:51200
  ds_read_b64_tr_b16 v[94:95], v11 offset:51712
  v_mfma_f32_32x32x16_bf16 v[48:63], v[128:131], v[80:83], 0
  v_mfma_f32_16x16x32_bf16 v[124:127], v[120:123], v[80:83], 0
  ds_read_b64_tr_b16 v[80:81], v12 offset:49152
  ds_read_b64_tr_b16 v[82:83], v12 offset:49664
  v_mfma_f32_32x32x16_bf16 v[48:63], v[132:135], v[84:87], v[48:63]
  v_mfma_f32_16x16x32_bf16 v[124:127], v[120:123], v[84:87], v[124:127]
  ds_read_b64_tr_b16 v[84:85], v12 offset:51200
  ds_read_b64_tr_b16 v[86:87], v12 offset:51712
  s_waitcnt lgkmcnt(6)
  v_mfma_f32_32x32x16_bf16 v[48:63], v[136:139], v[88:91], v[48:63]
  s_waitcnt vmcnt(8)
  s_waitcnt vmcnt(6)
  s_barrier
  ds_read_b64_tr_b16 v[88:89], v13 offset:49152
  ds_read_b64_tr_b16 v[90:91], v13 offset:49664
  s_lshl_b32 s4, s49, 10
  s_add_u32 s4, s4, 150016
  v_lshlrev_b32 v31, 3, v30
  v_add_u32 v31, s4, v31
  ds_read_b128 v[96:99], v31
  ds_read_b128 v[100:103], v31 offset:16
  v_lshlrev_b32 v104, 2, v30
  v_add_u32 v104, 155136, v104
  ds_read_b128 v[104:107], v104
  s_lshl_b32 s4, s49, 7
  s_add_u32 s4, s4, 149504
  v_add_u32 v31, s4, v30
  v_cmp_gt_u32 s[94:95], 32, v0
  s_waitcnt lgkmcnt(9)
  v_mfma_f32_32x32x16_bf16 v[48:63], v[140:143], v[92:95], v[48:63]
  ds_read_b64_tr_b16 v[92:93], v13 offset:51200
  ds_read_b64_tr_b16 v[94:95], v13 offset:51712
  s_add_u32 m0, s61, 0x1c000
  s_mul_i32 s89, s98, 458752
  s_add_u32 s89, s89, s7
  s_add_u32 s62, s89, 0x0
  buffer_load_dwordx4 v3, s[16:19], s62 offen lds
  s_add_u32 m0, s61, 0x1c400
  s_add_u32 s62, s89, 0x7000
  buffer_load_dwordx4 v3, s[16:19], s62 offen lds
  s_waitcnt lgkmcnt(4)
  v_add_f32 v96, v96, v98
  v_add_f32 v97, v97, v99
  s_waitcnt lgkmcnt(2)
  v_add_f32 v104, v104, v105
  v_add_f32 v100, v100, v102
  v_add_f32 v101, v101, v103
  v_add_f32 v106, v106, v107
  v_mfma_f32_32x32x16_bf16 v[48:63], v[144:147], v[80:83], v[48:63]
  ds_read_b64_tr_b16 v[80:81], v6 offset:49152
  ds_read_b64_tr_b16 v[82:83], v6 offset:49664
  v_add_f32 v96, v96, v100
  v_add_f32 v97, v97, v101
  v_add_f32 v104, v104, v106
  v_mul_f32 v96, 0xbb000000, v96
  v_mul_f32 v97, 0x3b000000, v97
  v_cvt_pk_bf16_f32 v105, v104, v104
  v_mfma_f32_32x32x16_bf16 v[48:63], v[148:151], v[84:87], v[48:63]
  ds_read_b64_tr_b16 v[84:85], v6 offset:51200
  ds_read_b64_tr_b16 v[86:87], v6 offset:51712
  s_add_u32 m0, s61, 0x18000
  s_mul_i32 s89, s99, 458752
  s_add_u32 s89, s89, s7
  s_add_u32 s62, s89, 0x0
  buffer_load_dwordx4 v3, s[16:19], s62 offen lds
  v_fma_f32 v97, -v96, v96, v97
  v_max_f32 v97, 0, v97
  v_and_b32 v16, 0xffff0000, v105
  v_cvt_pk_bf16_f32 v97, v97, v97
  v_lshlrev_b32 v97, 16, v97
  v_sub_f32 v104, v104, v16
  v_mfma_f32_32x32x16_bf16 v[48:63], v[152:155], v[88:91], v[48:63]
  ds_read_b64_tr_b16 v[88:89], v7 offset:49152
  ds_read_b64_tr_b16 v[90:91], v7 offset:49664
  v_add_f32 v97, 0x3727c5ac, v97
  v_cvt_pk_bf16_f32 v97, v97, v97
  v_cvt_pk_bf16_f32 v17, v104, v104
  v_lshlrev_b32 v97, 16, v97
  v_sqrt_f32 v97, v97
  s_waitcnt lgkmcnt(6)
  v_mfma_f32_32x32x16_bf16 v[48:63], v[156:159], v[92:95], v[48:63]
  ds_read_b64_tr_b16 v[92:93], v7 offset:51200
  ds_read_b64_tr_b16 v[94:95], v7 offset:51712
  s_add_u32 m0, s61, 0x18400
  s_add_u32 s62, s89, 0x7000
  buffer_load_dwordx4 v3, s[16:19], s62 offen lds
  v_cvt_pk_bf16_f32 v97, v97, v96
  v_lshlrev_b32 v14, 16, v97
  v_rcp_f32 v14, v14
  v_cndmask_b32 v18, 0, v97, s[94:95]
  v_lshrrev_b32 v19, 16, v18
  s_waitcnt lgkmcnt(6)
  v_mfma_f32_32x32x16_bf16 v[48:63], v[160:163], v[80:83], v[48:63]
  v_mfma_f32_16x16x32_bf16 v[124:127], v[120:123], v[80:83], v[124:127]
  ds_read_b64_tr_b16 v[80:81], v8 offset:49152
  ds_read_b64_tr_b16 v[82:83], v8 offset:49664
  v_mul_f32 v15, 0x3fb8aa3b, v14
  v_mul_f32 v22, -2.0, v14
  ds_write_b32 v31, v14
  v_mfma_f32_32x32x16_bf16 v[32:47], v[16:19], v[18:21], v[32:47]
  v_lshrrev_b32 v26, 5, v0
  v_lshlrev_b32 v26, 1, v26
  v_bfe_u32 v25, v0, 1, 2
  s_waitcnt lgkmcnt(7)
  v_mfma_f32_32x32x16_bf16 v[48:63], v[164:167], v[84:87], v[48:63]
  v_mfma_f32_16x16x32_bf16 v[124:127], v[120:123], v[84:87], v[124:127]
  ds_read_b64_tr_b16 v[84:85], v8 offset:51200
  ds_read_b64_tr_b16 v[86:87], v8 offset:51712
  v_xor_b32 v26, v25, v26
  v_lshlrev_b32 v25, 4, v30
  v_lshl_add_u32 v25, v26, 4, v25
  v_add_u32 v25, s72, v25
  v_xor_b32 v24, 16, v25
  v_cvt_pk_bf16_f32 v32, v32, v33
  s_waitcnt lgkmcnt(7)
  v_mfma_f32_32x32x16_bf16 v[48:63], v[168:171], v[88:91], v[48:63]
  ds_read_b64_tr_b16 v[88:89], v9 offset:49152
  ds_read_b64_tr_b16 v[90:91], v9 offset:49664
  v_cvt_pk_bf16_f32 v33, v34, v35
  v_cvt_pk_bf16_f32 v34, v36, v37
  v_cvt_pk_bf16_f32 v35, v38, v39
  v_cvt_pk_bf16_f32 v36, v40, v41
  v_cvt_pk_bf16_f32 v37, v42, v43
  v_cvt_pk_bf16_f32 v38, v44, v45
  s_waitcnt lgkmcnt(7)
  v_mfma_f32_32x32x16_bf16 v[48:63], v[172:175], v[92:95], v[48:63]
  ds_read_b64_tr_b16 v[92:93], v9 offset:51200
  ds_read_b64_tr_b16 v[94:95], v9 offset:51712
  v_cvt_pk_bf16_f32 v39, v46, v47
  v_mfma_f32_32x32x16_bf16 v[96:111], v[112:115], v[32:35], 0
  s_nop 0
  v_mfma_f32_32x32x16_bf16 v[64:79], v[116:119], v[36:39], 0
  s_waitcnt lgkmcnt(7)
  v_mfma_f32_32x32x16_bf16 v[48:63], v[176:179], v[80:83], v[48:63]
  ds_read_b64_tr_b16 v[80:81], v10 offset:0
  ds_read_b64_tr_b16 v[82:83], v10 offset:512
  s_waitcnt lgkmcnt(6)
  v_mfma_f32_32x32x16_bf16 v[48:63], v[180:183], v[84:87], v[48:63]
  ds_read_b64_tr_b16 v[84:85], v10 offset:2048
  ds_read_b64_tr_b16 v[86:87], v10 offset:2560
  s_waitcnt lgkmcnt(6)
  v_mfma_f32_32x32x16_bf16 v[48:63], v[184:187], v[88:91], v[48:63]
  ds_read_b64_tr_b16 v[88:89], v11 offset:0
  ds_read_b64_tr_b16 v[90:91], v11 offset:512
  v_max3_f32 v26, v96, v97, v98
  v_max3_f32 v31, v99, v100, v101
  v_max3_f32 v26, v26, v102, v103
  v_max3_f32 v31, v31, v104, v105
  v_max3_f32 v26, v26, v106, v107
  v_max3_f32 v31, v31, v108, v109
  s_waitcnt lgkmcnt(6)
  v_mfma_f32_32x32x16_bf16 v[48:63], v[188:191], v[92:95], v[48:63]
  ds_read_b64_tr_b16 v[92:93], v11 offset:2048
  ds_read_b64_tr_b16 v[94:95], v11 offset:2560
  v_max3_f32 v26, v26, v110, v111
  v_max_f32 v26, v26, v31
  v_mul_f32_e64 v26, -v26, v15
  v_fma_f32 v96, v96, v15, v26
  v_fma_f32 v97, v97, v15, v26
  v_fma_f32 v98, v98, v15, v26
  s_waitcnt lgkmcnt(6)
  v_mfma_f32_32x32x16_bf16 v[48:63], v[192:195], v[80:83], v[48:63]
  v_mfma_f32_16x16x32_bf16 v[124:127], v[120:123], v[80:83], v[124:127]
  ds_read_b64_tr_b16 v[80:81], v12 offset:0
  ds_read_b64_tr_b16 v[82:83], v12 offset:512
  v_fma_f32 v99, v99, v15, v26
  v_fma_f32 v100, v100, v15, v26
  v_fma_f32 v101, v101, v15, v26
  v_fma_f32 v102, v102, v15, v26
  v_fma_f32 v103, v103, v15, v26
  v_fma_f32 v104, v104, v15, v26
  s_waitcnt lgkmcnt(6)
  v_mfma_f32_32x32x16_bf16 v[48:63], v[196:199], v[84:87], v[48:63]
  v_mfma_f32_16x16x32_bf16 v[124:127], v[120:123], v[84:87], v[124:127]
  ds_read_b64_tr_b16 v[84:85], v12 offset:2048
  ds_read_b64_tr_b16 v[86:87], v12 offset:2560
  v_fma_f32 v105, v105, v15, v26
  v_fma_f32 v106, v106, v15, v26
  v_fma_f32 v107, v107, v15, v26
  v_fma_f32 v108, v108, v15, v26
  v_fma_f32 v109, v109, v15, v26
  v_fma_f32 v110, v110, v15, v26
  s_waitcnt lgkmcnt(6)
  v_mfma_f32_32x32x16_bf16 v[48:63], v[200:203], v[88:91], v[48:63]
  s_waitcnt vmcnt(8)
  s_waitcnt vmcnt(2)
  s_barrier
  ds_read_b64_tr_b16 v[88:89], v13 offset:0
  ds_read_b64_tr_b16 v[90:91], v13 offset:512
  v_fma_f32 v111, v111, v15, v26
  v_exp_f32 v96, v96
  v_exp_f32 v97, v97
  v_exp_f32 v98, v98
  s_waitcnt lgkmcnt(6)
  v_mfma_f32_32x32x16_bf16 v[48:63], v[204:207], v[92:95], v[48:63]
  ds_read_b64_tr_b16 v[92:93], v13 offset:2048
  ds_read_b64_tr_b16 v[94:95], v13 offset:2560
  s_add_u32 m0, s61, 0x20000
  s_mul_i32 s89, s100, 458752
  s_add_u32 s89, s89, s7
  s_add_u32 s62, s89, 0x0
  buffer_load_dwordx4 v3, s[16:19], s62 offen lds
  s_add_u32 m0, s61, 0x20400
  s_add_u32 s62, s89, 0x7000
  buffer_load_dwordx4 v3, s[16:19], s62 offen lds
  v_exp_f32 v99, v99
  v_exp_f32 v100, v100
  v_exp_f32 v101, v101
  s_waitcnt lgkmcnt(6)
  v_mfma_f32_32x32x16_bf16 v[48:63], v[208:211], v[80:83], v[48:63]
  ds_read_b64_tr_b16 v[80:81], v6 offset:0
  ds_read_b64_tr_b16 v[82:83], v6 offset:512
  v_exp_f32 v102, v102
  v_exp_f32 v103, v103
  v_exp_f32 v104, v104
  s_waitcnt lgkmcnt(6)
  v_mfma_f32_32x32x16_bf16 v[48:63], v[212:215], v[84:87], v[48:63]
  ds_read_b64_tr_b16 v[84:85], v6 offset:2048
  ds_read_b64_tr_b16 v[86:87], v6 offset:2560
  s_add_u32 m0, s61, 0x10000
  s_mul_i32 s89, s101, 458752
  s_add_u32 s89, s89, s7
  s_add_u32 s62, s89, 0x0
  buffer_load_dwordx4 v3, s[16:19], s62 offen lds
  v_exp_f32 v105, v105
  v_exp_f32 v106, v106
  v_exp_f32 v107, v107
  s_waitcnt lgkmcnt(6)
  v_mfma_f32_32x32x16_bf16 v[48:63], v[216:219], v[88:91], v[48:63]
  ds_read_b64_tr_b16 v[88:89], v7 offset:0
  ds_read_b64_tr_b16 v[90:91], v7 offset:512
  v_exp_f32 v108, v108
  v_exp_f32 v109, v109
  v_exp_f32 v110, v110
  s_waitcnt lgkmcnt(6)
  v_mfma_f32_32x32x16_bf16 v[48:63], v[220:223], v[92:95], v[48:63]
  ds_read_b64_tr_b16 v[92:93], v7 offset:2048
  ds_read_b64_tr_b16 v[94:95], v7 offset:2560
  s_add_u32 m0, s61, 0x10400
  s_add_u32 s62, s89, 0x7000
  buffer_load_dwordx4 v3, s[16:19], s62 offen lds
  v_exp_f32 v111, v111
  v_add_f32 v26, v96, v97
  v_add_f32 v31, v98, v99
  v_add_f32 v26, v26, v100
  v_add_f32 v31, v31, v101
  s_waitcnt lgkmcnt(6)
  v_mfma_f32_32x32x16_bf16 v[48:63], v[224:227], v[80:83], v[48:63]
  v_mfma_f32_16x16x32_bf16 v[124:127], v[120:123], v[80:83], v[124:127]
  ds_read_b64_tr_b16 v[80:81], v8 offset:0
  ds_read_b64_tr_b16 v[82:83], v8 offset:512
  v_add_f32 v26, v26, v102
  v_add_f32 v31, v31, v103
  v_add_f32 v26, v26, v104
  v_add_f32 v31, v31, v105
  v_add_f32 v26, v26, v106
  v_add_f32 v31, v31, v107
  s_waitcnt lgkmcnt(6)
  v_mfma_f32_32x32x16_bf16 v[48:63], v[228:231], v[84:87], v[48:63]
  v_mfma_f32_16x16x32_bf16 v[124:127], v[120:123], v[84:87], v[124:127]
  ds_read_b64_tr_b16 v[84:85], v8 offset:2048
  ds_read_b64_tr_b16 v[86:87], v8 offset:2560
  v_add_f32 v26, v26, v108
  v_add_f32 v31, v31, v109
  v_add_f32 v26, v26, v110
  v_add_f32 v31, v31, v111
  v_add_f32 v26, v26, v31
  v_rcp_f32 v26, v26
  s_waitcnt lgkmcnt(6)
  v_mfma_f32_32x32x16_bf16 v[48:63], v[232:235], v[88:91], v[48:63]
  ds_read_b64_tr_b16 v[88:89], v9 offset:0
  ds_read_b64_tr_b16 v[90:91], v9 offset:512
  v_mul_f32 v96, v96, v26
  v_mul_f32 v97, v97, v26
  v_mul_f32 v98, v98, v26
  v_mul_f32 v99, v99, v26
  v_mul_f32 v100, v100, v26
  v_mul_f32 v101, v101, v26
  s_waitcnt lgkmcnt(6)
  v_mfma_f32_32x32x16_bf16 v[48:63], v[236:239], v[92:95], v[48:63]
  ds_read_b64_tr_b16 v[92:93], v9 offset:2048
  ds_read_b64_tr_b16 v[94:95], v9 offset:2560
  s_lshl_b32 s3, s49, 2
  s_add_u32 s3, s3, 157184
  v_add_u32 v125, s3, v1
  ds_write_b32 v125, v124
  v_mul_f32 v102, v102, v26
  v_mul_f32 v103, v103, v26
  v_mul_f32 v104, v104, v26
  v_mul_f32 v105, v105, v26
  v_mul_f32 v106, v106, v26
  v_mul_f32 v107, v107, v26
  s_waitcnt lgkmcnt(7)
  v_mfma_f32_32x32x16_bf16 v[48:63], v[240:243], v[80:83], v[48:63]
  v_mul_f32 v108, v108, v26
  v_mul_f32 v109, v109, v26
  v_mul_f32 v110, v110, v26
  v_mul_f32 v111, v111, v26
  v_cvt_pk_bf16_f32 v40, v96, v97
  v_cvt_pk_bf16_f32 v41, v98, v99
  s_waitcnt lgkmcnt(5)
  v_mfma_f32_32x32x16_bf16 v[48:63], v[244:247], v[84:87], v[48:63]
  v_cvt_pk_bf16_f32 v42, v100, v101
  v_cvt_pk_bf16_f32 v43, v102, v103
  v_cvt_pk_bf16_f32 v44, v104, v105
  v_cvt_pk_bf16_f32 v45, v106, v107
  v_cvt_pk_bf16_f32 v46, v108, v109
  v_cvt_pk_bf16_f32 v47, v110, v111
  s_waitcnt lgkmcnt(3)
  v_mfma_f32_32x32x16_bf16 v[48:63], v[248:251], v[88:91], v[48:63]
  buffer_load_dword v27, v30, s[40:43], 0 offen offset:128 sc1
  ds_write_b128 v25, v[40:43] offset:0
  ds_write_b128 v24, v[44:47] offset:0
  v_max3_f32 v26, v64, v65, v66
  v_max3_f32 v31, v67, v68, v69
  v_max3_f32 v26, v26, v70, v71
  v_max3_f32 v31, v31, v72, v73
  v_max3_f32 v26, v26, v74, v75
  s_waitcnt lgkmcnt(3)
  v_mfma_f32_32x32x16_bf16 v[48:63], v[252:255], v[92:95], v[48:63]
  v_max3_f32 v31, v31, v76, v77
  v_max3_f32 v26, v26, v78, v79
  v_max_f32 v26, v26, v31
  v_mul_f32_e64 v26, -v26, v15
  s_waitcnt lgkmcnt(0)
  s_barrier
  v_lshlrev_b32 v80, 2, v30
  s_add_u32 m0, s61, 0x14000
  s_add_u32 s62, s68, 0xf0000
  buffer_load_dwordx4 v4, s[20:23], s62 offen lds
  s_add_u32 m0, s61, 0x14400
  s_add_u32 s62, s68, 0xf2000
  buffer_load_dwordx4 v4, s[20:23], s62 offen lds
  s_add_u32 m0, s61, 0x4000
  s_add_u32 s62, s68, 0x40000
  buffer_load_dwordx4 v4, s[20:23], s62 offen lds
  v_add_u32 v80, 157184, v80
  ds_read_b128 v[80:83], v80
  s_waitcnt lgkmcnt(0)
  v_add_f32 v80, v80, v81
  v_add_f32 v82, v82, v83
  v_add_f32 v80, v80, v82
  v_cvt_pk_bf16_f32 v81, v80, v80
  v_and_b32 v16, 0xffff0000, v81
  v_sub_f32 v80, v80, v16
  v_cvt_pk_bf16_f32 v17, v80, v80
  s_nop 1
  v_mfma_f32_32x32x16_bf16 v[48:63], v[18:21], v[16:19], v[48:63]
  s_waitcnt vmcnt(3)
  v_pk_fma_f32 v[64:65], v[64:65], v[14:15], v[26:27] op_sel:[0,1,0] op_sel_hi:[1,1,0]
  v_pk_fma_f32 v[66:67], v[66:67], v[14:15], v[26:27] op_sel:[0,1,0] op_sel_hi:[1,1,0]
  v_pk_fma_f32 v[68:69], v[68:69], v[14:15], v[26:27] op_sel:[0,1,0] op_sel_hi:[1,1,0]
  v_pk_fma_f32 v[70:71], v[70:71], v[14:15], v[26:27] op_sel:[0,1,0] op_sel_hi:[1,1,0]
  v_pk_fma_f32 v[72:73], v[72:73], v[14:15], v[26:27] op_sel:[0,1,0] op_sel_hi:[1,1,0]
  v_pk_fma_f32 v[74:75], v[74:75], v[14:15], v[26:27] op_sel:[0,1,0] op_sel_hi:[1,1,0]
  v_pk_fma_f32 v[76:77], v[76:77], v[14:15], v[26:27] op_sel:[0,1,0] op_sel_hi:[1,1,0]
  v_pk_fma_f32 v[78:79], v[78:79], v[14:15], v[26:27] op_sel:[0,1,0] op_sel_hi:[1,1,0]
  v_exp_f32 v64, v64
  v_exp_f32 v65, v65
  v_exp_f32 v66, v66
  v_exp_f32 v67, v67
  s_add_u32 m0, s61, 0x4400
  s_add_u32 s62, s68, 0x42000
  buffer_load_dwordx4 v4, s[20:23], s62 offen lds
  v_exp_f32 v68, v68
  v_exp_f32 v69, v69
  v_exp_f32 v70, v70
  v_exp_f32 v71, v71
  v_exp_f32 v72, v72
  v_exp_f32 v73, v73
  v_exp_f32 v74, v74
  v_exp_f32 v75, v75
  v_exp_f32 v76, v76
  v_exp_f32 v77, v77
  v_exp_f32 v78, v78
  v_exp_f32 v79, v79
  v_pk_add_f32 v[112:113], v[64:65], v[66:67] op_sel:[0,0] op_sel_hi:[1,1]
  v_pk_add_f32 v[114:115], v[68:69], v[70:71] op_sel:[0,0] op_sel_hi:[1,1]
  v_pk_add_f32 v[112:113], v[112:113], v[72:73] op_sel:[0,0] op_sel_hi:[1,1]
  v_pk_add_f32 v[114:115], v[114:115], v[74:75] op_sel:[0,0] op_sel_hi:[1,1]
  v_pk_add_f32 v[112:113], v[112:113], v[76:77] op_sel:[0,0] op_sel_hi:[1,1]
  v_pk_add_f32 v[114:115], v[114:115], v[78:79] op_sel:[0,0] op_sel_hi:[1,1]
  v_pk_add_f32 v[112:113], v[112:113], v[114:115] op_sel:[0,0] op_sel_hi:[1,1]
  v_add_f32 v26, v112, v113
  v_rcp_f32 v26, v26
  s_nop 0
  v_pk_mul_f32 v[64:65], v[64:65], v[26:27] op_sel:[0,0] op_sel_hi:[1,0]
  v_pk_mul_f32 v[66:67], v[66:67], v[26:27] op_sel:[0,0] op_sel_hi:[1,0]
  v_pk_mul_f32 v[68:69], v[68:69], v[26:27] op_sel:[0,0] op_sel_hi:[1,0]
  v_pk_mul_f32 v[70:71], v[70:71], v[26:27] op_sel:[0,0] op_sel_hi:[1,0]
  v_pk_mul_f32 v[72:73], v[72:73], v[26:27] op_sel:[0,0] op_sel_hi:[1,0]
  v_pk_mul_f32 v[74:75], v[74:75], v[26:27] op_sel:[0,0] op_sel_hi:[1,0]
  v_pk_mul_f32 v[76:77], v[76:77], v[26:27] op_sel:[0,0] op_sel_hi:[1,0]
  v_pk_mul_f32 v[78:79], v[78:79], v[26:27] op_sel:[0,0] op_sel_hi:[1,0]
  v_cvt_pk_bf16_f32 v40, v64, v65
  v_cvt_pk_bf16_f32 v41, v66, v67
  v_cvt_pk_bf16_f32 v42, v68, v69
  v_cvt_pk_bf16_f32 v43, v70, v71
  v_cvt_pk_bf16_f32 v44, v72, v73
  v_cvt_pk_bf16_f32 v45, v74, v75
  v_cvt_pk_bf16_f32 v46, v76, v77
  v_cvt_pk_bf16_f32 v47, v78, v79
  ds_write_b128 v25, v[40:43] offset:2048
  ds_write_b128 v24, v[44:47] offset:2048
  v_lshrrev_b32 v26, 5, v0
  v_lshlrev_b32 v26, 4, v26
  s_lshl_b32 s4, s49, 7
  s_add_u32 s4, s4, 149504
  v_add_u32 v31, s4, v26
  ds_read_b128 v[96:99], v31 offset:0
  ds_read_b128 v[100:103], v31 offset:32
  ds_read_b128 v[104:107], v31 offset:64
  ds_read_b128 v[108:111], v31 offset:96
  v_bfe_u32 v25, v0, 2, 2
  v_lshlrev_b32 v25, 6, v25
  v_lshl_add_u32 v25, v26, 4, v25
  v_bfe_u32 v31, v0, 4, 1
  v_cmp_eq_u32 s[94:95], 1, v31
  v_lshrrev_b32 v24, 5, v0
  v_xor_b32 v31, v24, v31
  v_lshl_add_u32 v25, v31, 5, v25
  v_lshrrev_b32 v24, 2, v0
  v_xor_b32 v24, v24, v0
  v_bfe_u32 v24, v24, 1, 1
  v_lshl_add_u32 v25, v24, 4, v25
  v_and_b32 v31, 1, v0
  v_lshl_add_u32 v25, v31, 3, v25
  v_add_u32 v25, s72, v25
  v_mov_b32 v31, s60
  ds_read_b64_tr_b16 v[112:113], v25 offset:2048
  ds_read_b64_tr_b16 v[114:115], v25 offset:2560
  ds_read_b64_tr_b16 v[116:117], v25 offset:3072
  ds_read_b64_tr_b16 v[118:119], v25 offset:3584
  s_waitcnt lgkmcnt(7)
  v_pk_mul_f32 v[48:49], v[48:49], v[96:97] op_sel:[0,0] op_sel_hi:[1,1]
  v_pk_mul_f32 v[50:51], v[50:51], v[98:99] op_sel:[0,0] op_sel_hi:[1,1]
  s_waitcnt lgkmcnt(6)
  v_pk_mul_f32 v[52:53], v[52:53], v[100:101] op_sel:[0,0] op_sel_hi:[1,1]
  v_pk_mul_f32 v[54:55], v[54:55], v[102:103] op_sel:[0,0] op_sel_hi:[1,1]
  s_waitcnt lgkmcnt(5)
  v_pk_mul_f32 v[56:57], v[56:57], v[104:105] op_sel:[0,0] op_sel_hi:[1,1]
  v_pk_mul_f32 v[58:59], v[58:59], v[106:107] op_sel:[0,0] op_sel_hi:[1,1]
  s_waitcnt lgkmcnt(4)
  v_pk_mul_f32 v[60:61], v[60:61], v[108:109] op_sel:[0,0] op_sel_hi:[1,1]
  v_pk_mul_f32 v[62:63], v[62:63], v[110:111] op_sel:[0,0] op_sel_hi:[1,1]
  v_cvt_pk_bf16_f32 v48, v48, v49
  v_cvt_pk_bf16_f32 v49, v50, v51
  v_cvt_pk_bf16_f32 v50, v52, v53
  v_cvt_pk_bf16_f32 v51, v54, v55
  v_cvt_pk_bf16_f32 v52, v56, v57
  v_cvt_pk_bf16_f32 v53, v58, v59
  v_cvt_pk_bf16_f32 v54, v60, v61
  v_cvt_pk_bf16_f32 v55, v62, v63
  ds_read_b64_tr_b16 v[56:57], v25 offset:0
  ds_read_b64_tr_b16 v[58:59], v25 offset:512
  ds_read_b64_tr_b16 v[60:61], v25 offset:1024
  ds_read_b64_tr_b16 v[62:63], v25 offset:1536
  v_cndmask_b32 v40, v31, v48, s[94:95]
  v_cndmask_b32 v41, v31, v49, s[94:95]
  v_cndmask_b32 v42, v31, v50, s[94:95]
  v_cndmask_b32 v43, v31, v51, s[94:95]
  v_cndmask_b32 v44, v31, v52, s[94:95]
  v_cndmask_b32 v45, v31, v53, s[94:95]
  v_cndmask_b32 v46, v31, v54, s[94:95]
  v_cndmask_b32 v47, v31, v55, s[94:95]
  v_cndmask_b32 v32, v48, v31, s[94:95]
  v_cndmask_b32 v33, v49, v31, s[94:95]
  v_cndmask_b32 v34, v50, v31, s[94:95]
  v_cndmask_b32 v35, v51, v31, s[94:95]
  v_cndmask_b32 v36, v52, v31, s[94:95]
  v_cndmask_b32 v37, v53, v31, s[94:95]
  v_cndmask_b32 v38, v54, v31, s[94:95]
  v_cndmask_b32 v39, v55, v31, s[94:95]
  s_waitcnt lgkmcnt(2)
  v_mfma_f32_32x32x16_bf16 v[96:111], v[32:35], v[56:59], 0
  s_waitcnt lgkmcnt(0)
  v_mfma_f32_32x32x16_bf16 v[96:111], v[36:39], v[60:63], v[96:111]
  v_mfma_f32_32x32x16_bf16 v[48:63], v[40:43], v[112:115], 0
  v_mfma_f32_32x32x16_bf16 v[48:63], v[44:47], v[116:119], v[48:63]
  v_add_u32 v25, s72, v1
  s_lshl_b32 s4, s48, 9
  s_add_u32 s4, s4, 158208
  v_lshlrev_b32 v26, 2, v0
  v_add_u32 v26, s4, v26
  s_nop 4
  ds_write_b128 v25, v[96:99]
  ds_write_b128 v25, v[100:103] offset:1024
  ds_write_b32 v26, v104
  ds_write_b128 v25, v[56:59] offset:2048
  ds_write_b128 v25, v[60:63] offset:3072
  ds_write_b32 v26, v48 offset:256
  s_lshl_b32 s4, s49, 10
  s_add_u32 s4, s4, 49152
  v_add_u32 v25, s4, v1
  s_lshr_b32 s4, s49, 1
  s_lshl_b32 s4, s4, 8
  s_add_u32 s4, s4, 160256
  v_add_u32 v26, s4, v30
  v_cmp_ne_u32 vcc, 0, v27
  s_nop 0
  s_andn2_b32 s3, 0xffffffff, vcc_lo
  s_cbranch_scc1 L43
L44:
  ds_read_b64_tr_b16 v[80:81], v10 offset:32768
  ds_read_b64_tr_b16 v[82:83], v10 offset:33280
  ds_read_b64_tr_b16 v[84:85], v10 offset:34816
  ds_read_b64_tr_b16 v[86:87], v10 offset:35328
  ds_read_b64_tr_b16 v[88:89], v11 offset:32768
  ds_read_b64_tr_b16 v[90:91], v11 offset:33280
  ds_read_b64_tr_b16 v[92:93], v11 offset:34816
  ds_read_b64_tr_b16 v[94:95], v11 offset:35328
  s_waitcnt vmcnt(2)
  s_waitcnt lgkmcnt(8)
  s_barrier
  s_waitcnt lgkmcnt(6)
  v_mfma_f32_32x32x16_bf16 v[64:79], v[80:83], v[128:131], 0
  v_mfma_f32_16x16x32_bf16 v[124:127], v[120:123], v[80:83], 0
  ds_read_b64_tr_b16 v[80:81], v12 offset:32768
  ds_read_b64_tr_b16 v[82:83], v12 offset:33280
  ds_read_b128 v[96:99], v25 offset:0
  ds_read_b128 v[100:103], v25 offset:4096
  ds_read_b128 v[104:107], v25 offset:8192
  ds_read_b128 v[108:111], v25 offset:12288
  ds_read_b32 v32, v26 offset:0
  ds_read_b32 v33, v26 offset:512
  ds_read_b32 v34, v26 offset:1024
  ds_read_b32 v35, v26 offset:1536
  v_lshrrev_b32 v25, 5, v0
  v_lshl_add_u32 v25, v25, 9, v30
  s_lshl_b32 s5, s57, 10
  v_add_u32 v25, s5, v25
  v_lshrrev_b32 v31, 4, v0
  s_waitcnt lgkmcnt(14)
  v_mfma_f32_32x32x16_bf16 v[64:79], v[84:87], v[132:135], v[64:79]
  v_mfma_f32_16x16x32_bf16 v[124:127], v[120:123], v[84:87], v[124:127]
  ds_read_b64_tr_b16 v[84:85], v12 offset:34816
  ds_read_b64_tr_b16 v[86:87], v12 offset:35328
  v_cmp_eq_u32 s[94:95], s57, v31
  v_mov_b32 v31, 1073741824
  s_and_b32 s5, s52, 1
  s_mul_i32 s5, s5, 10240
  s_add_u32 s5, s5, 2048
  s_add_u32 s2, s74, s5
  s_lshl_b32 s4, s51, 7
  s_add_u32 s71, s71, s4
  v_cndmask_b32 v26, v31, v30, s[94:95]
  s_waitcnt lgkmcnt(8)
  v_add_f32 v96, v96, v100
  s_waitcnt lgkmcnt(6)
  v_add_f32 v104, v104, v108
  v_mfma_f32_32x32x16_bf16 v[64:79], v[88:91], v[136:139], v[64:79]
  ds_read_b64_tr_b16 v[88:89], v13 offset:32768
  ds_read_b64_tr_b16 v[90:91], v13 offset:33280
  v_add_f32 v97, v97, v101
  v_add_f32 v105, v105, v109
  v_add_f32 v98, v98, v102
  v_add_f32 v106, v106, v110
  v_add_f32 v99, v99, v103
  v_add_f32 v107, v107, v111
  v_add_f32 v96, v96, v104
  v_add_f32 v97, v97, v105
  v_mfma_f32_32x32x16_bf16 v[64:79], v[92:95], v[140:143], v[64:79]
  ds_read_b64_tr_b16 v[92:93], v13 offset:34816
  ds_read_b64_tr_b16 v[94:95], v13 offset:35328
  v_add_f32 v98, v98, v106
  v_add_f32 v99, v99, v107
  s_waitcnt lgkmcnt(8)
  v_add_f32 v32, v32, v33
  s_waitcnt lgkmcnt(6)
  v_add_f32 v34, v34, v35
  v_add_f32 v32, v32, v34
  buffer_atomic_add_f32 v96, v25, s[44:47], s70 offen offset:0
  buffer_atomic_add_f32 v97, v25, s[44:47], s70 offen offset:128
  buffer_atomic_add_f32 v98, v25, s[44:47], s70 offen offset:256
  buffer_atomic_add_f32 v99, v25, s[44:47], s70 offen offset:384
  buffer_atomic_add_f32 v32, v26, s[44:47], s70 offen offset:2048
  v_mfma_f32_32x32x16_bf16 v[64:79], v[80:83], v[144:147], v[64:79]
  ds_read_b64_tr_b16 v[80:81], v10 offset:16384
  ds_read_b64_tr_b16 v[82:83], v10 offset:16896
  s_waitcnt lgkmcnt(6)
  v_mfma_f32_32x32x16_bf16 v[64:79], v[84:87], v[148:151], v[64:79]
  ds_read_b64_tr_b16 v[84:85], v10 offset:18432
  ds_read_b64_tr_b16 v[86:87], v10 offset:18944
  s_waitcnt lgkmcnt(6)
  v_mfma_f32_32x32x16_bf16 v[64:79], v[88:91], v[152:155], v[64:79]
  ds_read_b64_tr_b16 v[88:89], v11 offset:16384
  ds_read_b64_tr_b16 v[90:91], v11 offset:16896
  v_bfe_u32 v5, v0, 2, 3
  v_mul_u32_u24 v5, 640, v5
  v_and_b32 v24, 3, v0
  v_lshl_add_u32 v5, v24, 2, v5
  s_waitcnt lgkmcnt(6)
  v_mfma_f32_32x32x16_bf16 v[64:79], v[92:95], v[156:159], v[64:79]
  ds_read_b64_tr_b16 v[92:93], v11 offset:18432
  ds_read_b64_tr_b16 v[94:95], v11 offset:18944
  s_waitcnt lgkmcnt(6)
  v_mfma_f32_32x32x16_bf16 v[64:79], v[80:83], v[160:163], v[64:79]
  v_mfma_f32_16x16x32_bf16 v[124:127], v[120:123], v[80:83], v[124:127]
  ds_read_b64_tr_b16 v[80:81], v12 offset:16384
  ds_read_b64_tr_b16 v[82:83], v12 offset:16896
  s_waitcnt lgkmcnt(6)
  v_mfma_f32_32x32x16_bf16 v[64:79], v[84:87], v[164:167], v[64:79]
  v_mfma_f32_16x16x32_bf16 v[124:127], v[120:123], v[84:87], v[124:127]
  ds_read_b64_tr_b16 v[84:85], v12 offset:18432
  ds_read_b64_tr_b16 v[86:87], v12 offset:18944
  s_waitcnt lgkmcnt(6)
  v_mfma_f32_32x32x16_bf16 v[64:79], v[88:91], v[168:171], v[64:79]
  ds_read_b64_tr_b16 v[88:89], v13 offset:16384
  ds_read_b64_tr_b16 v[90:91], v13 offset:16896
  s_waitcnt lgkmcnt(6)
  v_mfma_f32_32x32x16_bf16 v[64:79], v[92:95], v[172:175], v[64:79]
  s_barrier
  ds_read_b64_tr_b16 v[92:93], v13 offset:18432
  ds_read_b64_tr_b16 v[94:95], v13 offset:18944
  s_add_u32 m0, s61, 0x0
  s_add_u32 s62, s68, 0x120000
  buffer_load_dwordx4 v4, s[20:23], s62 offen lds
  s_add_u32 m0, s61, 0x400
  s_add_u32 s62, s68, 0x122000
  buffer_load_dwordx4 v4, s[20:23], s62 offen lds
  s_waitcnt lgkmcnt(6)
  v_mfma_f32_32x32x16_bf16 v[64:79], v[80:83], v[176:179], v[64:79]
  ds_read_b64_tr_b16 v[80:81], v10 offset:49152
  ds_read_b64_tr_b16 v[82:83], v10 offset:49664
  s_waitcnt lgkmcnt(6)
  v_mfma_f32_32x32x16_bf16 v[64:79], v[84:87], v[180:183], v[64:79]
  ds_read_b64_tr_b16 v[84:85], v10 offset:51200
  ds_read_b64_tr_b16 v[86:87], v10 offset:51712
  s_add_u32 m0, s61, 0x1c000
  s_add_u32 s62, s68, 0x20000
  buffer_load_dwordx4 v4, s[20:23], s62 offen lds
  s_waitcnt lgkmcnt(6)
  v_mfma_f32_32x32x16_bf16 v[64:79], v[88:91], v[184:187], v[64:79]
  ds_read_b64_tr_b16 v[88:89], v11 offset:49152
  ds_read_b64_tr_b16 v[90:91], v11 offset:49664
  s_waitcnt lgkmcnt(6)
  v_mfma_f32_32x32x16_bf16 v[64:79], v[92:95], v[188:191], v[64:79]
  ds_read_b64_tr_b16 v[92:93], v11 offset:51200
  ds_read_b64_tr_b16 v[94:95], v11 offset:51712
  s_add_u32 m0, s61, 0x1c400
  s_add_u32 s62, s68, 0x22000
  buffer_load_dwordx4 v4, s[20:23], s62 offen lds
  s_waitcnt lgkmcnt(6)
  v_mfma_f32_32x32x16_bf16 v[64:79], v[80:83], v[192:195], v[64:79]
  v_mfma_f32_16x16x32_bf16 v[124:127], v[120:123], v[80:83], v[124:127]
  ds_read_b64_tr_b16 v[80:81], v12 offset:49152
  ds_read_b64_tr_b16 v[82:83], v12 offset:49664
  s_waitcnt lgkmcnt(6)
  v_mfma_f32_32x32x16_bf16 v[64:79], v[84:87], v[196:199], v[64:79]
  v_mfma_f32_16x16x32_bf16 v[124:127], v[120:123], v[84:87], v[124:127]
  ds_read_b64_tr_b16 v[84:85], v12 offset:51200
  ds_read_b64_tr_b16 v[86:87], v12 offset:51712
  s_add_u32 m0, s61, 0x8000
  s_add_u32 s62, s68, 0x100000
  buffer_load_dwordx4 v4, s[20:23], s62 offen lds
  s_waitcnt vmcnt(5)
  buffer_store_dword v10, v28, s[44:47], s71 offen offset:0 sc1
  s_waitcnt lgkmcnt(6)
  v_mfma_f32_32x32x16_bf16 v[64:79], v[88:91], v[200:203], v[64:79]
  ds_read_b64_tr_b16 v[88:89], v13 offset:49152
  ds_read_b64_tr_b16 v[90:91], v13 offset:49664
  s_waitcnt lgkmcnt(6)
  v_mfma_f32_32x32x16_bf16 v[64:79], v[92:95], v[204:207], v[64:79]
  ds_read_b64_tr_b16 v[92:93], v13 offset:51200
  ds_read_b64_tr_b16 v[94:95], v13 offset:51712
  s_add_u32 m0, s61, 0x8400
  s_add_u32 s62, s68, 0x102000
  buffer_load_dwordx4 v4, s[20:23], s62 offen lds
  s_waitcnt lgkmcnt(6)
  v_mfma_f32_32x32x16_bf16 v[64:79], v[80:83], v[208:211], v[64:79]
  s_barrier
  ds_read_b64_tr_b16 v[80:81], v6 offset:49152
  ds_read_b64_tr_b16 v[82:83], v6 offset:49664
  s_waitcnt lgkmcnt(6)
  v_mfma_f32_32x32x16_bf16 v[64:79], v[84:87], v[212:215], v[64:79]
  ds_read_b64_tr_b16 v[84:85], v6 offset:51200
  ds_read_b64_tr_b16 v[86:87], v6 offset:51712
  s_add_u32 m0, s61, 0xc000
  s_add_u32 s62, s68, 0x50000
  buffer_load_dwordx4 v4, s[20:23], s62 offen lds
  s_waitcnt lgkmcnt(6)
  v_mfma_f32_32x32x16_bf16 v[64:79], v[88:91], v[216:219], v[64:79]
  ds_read_b64_tr_b16 v[88:89], v7 offset:49152
  ds_read_b64_tr_b16 v[90:91], v7 offset:49664
  s_waitcnt lgkmcnt(6)
  v_mfma_f32_32x32x16_bf16 v[64:79], v[92:95], v[220:223], v[64:79]
  ds_read_b64_tr_b16 v[92:93], v7 offset:51200
  ds_read_b64_tr_b16 v[94:95], v7 offset:51712
  s_add_u32 m0, s61, 0xc400
  s_add_u32 s62, s68, 0x52000
  buffer_load_dwordx4 v4, s[20:23], s62 offen lds
  s_waitcnt lgkmcnt(6)
  v_mfma_f32_32x32x16_bf16 v[64:79], v[80:83], v[224:227], v[64:79]
  v_mfma_f32_16x16x32_bf16 v[124:127], v[120:123], v[80:83], v[124:127]
  ds_read_b64_tr_b16 v[80:81], v8 offset:49152
  ds_read_b64_tr_b16 v[82:83], v8 offset:49664
  s_waitcnt lgkmcnt(6)
  v_mfma_f32_32x32x16_bf16 v[64:79], v[84:87], v[228:231], v[64:79]
  v_mfma_f32_16x16x32_bf16 v[124:127], v[120:123], v[84:87], v[124:127]
  ds_read_b64_tr_b16 v[84:85], v8 offset:51200
  ds_read_b64_tr_b16 v[86:87], v8 offset:51712
  s_waitcnt lgkmcnt(6)
  v_mfma_f32_32x32x16_bf16 v[64:79], v[88:91], v[232:235], v[64:79]
  ds_read_b64_tr_b16 v[88:89], v9 offset:49152
  ds_read_b64_tr_b16 v[90:91], v9 offset:49664
  s_waitcnt lgkmcnt(6)
  v_mfma_f32_32x32x16_bf16 v[64:79], v[92:95], v[236:239], v[64:79]
  ds_read_b64_tr_b16 v[92:93], v9 offset:51200
  ds_read_b64_tr_b16 v[94:95], v9 offset:51712
  s_add_u32 m0, s61, 0x18000
  s_add_u32 s62, s68, 0x130000
  buffer_load_dwordx4 v4, s[20:23], s62 offen lds
  s_lshl_b32 s3, s49, 2
  s_add_u32 s3, s3, 155136
  v_add_u32 v125, s3, v1
  ds_write_b32 v125, v124
  buffer_load_dword v27, v5, s[44:47], s67 offen offset:0 sc1
  s_waitcnt lgkmcnt(7)
  v_mfma_f32_32x32x16_bf16 v[64:79], v[80:83], v[240:243], v[64:79]
  s_waitcnt lgkmcnt(5)
  v_mfma_f32_32x32x16_bf16 v[64:79], v[84:87], v[244:247], v[64:79]
  s_add_u32 m0, s61, 0x18400
  s_add_u32 s62, s68, 0x132000
  buffer_load_dwordx4 v4, s[20:23], s62 offen lds
  s_waitcnt lgkmcnt(3)
  v_mfma_f32_32x32x16_bf16 v[64:79], v[88:91], v[248:251], v[64:79]
  s_waitcnt lgkmcnt(1)
  v_mfma_f32_32x32x16_bf16 v[64:79], v[92:95], v[252:255], v[64:79]
  s_waitcnt lgkmcnt(0)
  s_barrier
  s_lshl_b32 s91, s54, 16
  s_lshl_b32 s4, s49, 14
  s_add_u32 s91, s91, s4
  s_lshl_b32 s4, s55, 7
  s_add_u32 s91, s91, s4
  buffer_load_dword v204, v5, s[44:47], s67 offen offset:128 sc1
  s_waitcnt vmcnt(2)
  v_cmp_ne_u32 vcc, 0, v27
  s_nop 0
  s_andn2_b32 s3, 0xffffffff, vcc_lo
  s_cbranch_scc1 L46
L47:
  s_add_u32 m0, s61, 0x14000
  s_add_u32 s62, s0, 0x1000
  buffer_load_dwordx4 v1, s[44:47], s62 offen sc1 lds
  v_lshlrev_b32 v112, 2, v30
  v_add_u32 v112, 155136, v112
  ds_read_b128 v[112:115], v112
  s_waitcnt lgkmcnt(0)
  v_add_f32 v112, v112, v113
  v_add_f32 v114, v114, v115
  s_add_u32 m0, s61, 0x14400
  s_add_u32 s62, s0, 0x25000
  buffer_load_dwordx4 v1, s[44:47], s62 offen sc1 lds
  v_add_f32 v112, v112, v114
  v_cvt_pk_bf16_f32 v113, v112, v112
  v_and_b32 v16, 0xffff0000, v113
  v_sub_f32 v112, v112, v16
  s_add_u32 m0, s61, 0x12000
  s_add_u32 s62, s0, 0xffffa000
  buffer_load_dwordx4 v1, s[44:47], s62 offen sc1 lds
  v_cvt_pk_bf16_f32 v17, v112, v112
  v_or_b32 v16, v16, v23
  s_nop 1
  v_mfma_f32_32x32x16_bf16 v[64:79], v[16:19], v[18:21], v[64:79]
  s_nop 11
  v_pk_mul_f32 v[104:105], v[64:65], v[14:15] op_sel:[0,1] op_sel_hi:[1,1]
  s_add_u32 m0, s61, 0x12400
  s_add_u32 s62, s0, 0x1e000
  buffer_load_dwordx4 v1, s[44:47], s62 offen sc1 lds
  v_pk_mul_f32 v[106:107], v[66:67], v[14:15] op_sel:[0,1] op_sel_hi:[1,1]
  v_pk_mul_f32 v[108:109], v[68:69], v[14:15] op_sel:[0,1] op_sel_hi:[1,1]
  v_pk_mul_f32 v[110:111], v[70:71], v[14:15] op_sel:[0,1] op_sel_hi:[1,1]
  v_exp_f32 v104, v104
  s_add_u32 m0, s61, 0x20000
  s_add_u32 s62, s0, 0xf000
  buffer_load_dwordx4 v1, s[44:47], s62 offen sc1 lds
  v_exp_f32 v105, v105
  v_exp_f32 v106, v106
  s_add_u32 m0, s61, 0x20400
  s_add_u32 s62, s0, 0x33000
  buffer_load_dwordx4 v1, s[44:47], s62 offen sc1 lds
  v_exp_f32 v107, v107
  v_exp_f32 v108, v108
  s_add_u32 m0, s61, 0x1e000
  s_add_u32 s62, s0, 0x8000
  buffer_load_dwordx4 v1, s[44:47], s62 offen sc1 lds
  v_exp_f32 v109, v109
  v_exp_f32 v110, v110
  s_add_u32 m0, s61, 0x1e400
  s_add_u32 s62, s0, 0x2c000
  buffer_load_dwordx4 v1, s[44:47], s62 offen sc1 lds
  v_exp_f32 v111, v111
  v_pk_add_f32 v[104:105], v[104:105], 1.0 op_sel:[0,0] op_sel_hi:[1,0]
  v_pk_add_f32 v[106:107], v[106:107], 1.0 op_sel:[0,0] op_sel_hi:[1,0]
  s_add_u32 m0, s61, 0x10000
  s_add_u32 s62, s0, 0x4000
  buffer_load_dwordx4 v1, s[44:47], s62 offen sc1 lds
  v_pk_add_f32 v[108:109], v[108:109], 1.0 op_sel:[0,0] op_sel_hi:[1,0]
  v_pk_add_f32 v[110:111], v[110:111], 1.0 op_sel:[0,0] op_sel_hi:[1,0]
  v_pk_fma_f32 v[104:105], v[104:105], v[104:105], 1.0 op_sel:[0,0,0] op_sel_hi:[1,1,0]
  v_pk_fma_f32 v[106:107], v[106:107], v[106:107], 1.0 op_sel:[0,0,0] op_sel_hi:[1,1,0]
  s_add_u32 m0, s61, 0x10400
  s_add_u32 s62, s0, 0x28000
  buffer_load_dwordx4 v1, s[44:47], s62 offen sc1 lds
  v_pk_fma_f32 v[108:109], v[108:109], v[108:109], 1.0 op_sel:[0,0,0] op_sel_hi:[1,1,0]
  v_pk_fma_f32 v[110:111], v[110:111], v[110:111], 1.0 op_sel:[0,0,0] op_sel_hi:[1,1,0]
  v_rcp_f32 v104, v104
  s_add_u32 m0, s61, 0xe000
  s_add_u32 s62, s0, 0xffffd000
  buffer_load_dwordx4 v1, s[44:47], s62 offen sc1 lds
  v_rcp_f32 v105, v105
  v_rcp_f32 v106, v106
  s_add_u32 m0, s61, 0xe400
  s_add_u32 s62, s0, 0x21000
  buffer_load_dwordx4 v1, s[44:47], s62 offen sc1 lds
  v_rcp_f32 v107, v107
  v_rcp_f32 v108, v108
  s_add_u32 m0, s61, 0x4000
  s_add_u32 s62, s0, 0x12000
  buffer_load_dwordx4 v1, s[44:47], s62 offen sc1 lds
  v_rcp_f32 v109, v109
  v_rcp_f32 v110, v110
  s_add_u32 m0, s61, 0x4400
  s_add_u32 s62, s0, 0x36000
  buffer_load_dwordx4 v1, s[44:47], s62 offen sc1 lds
  v_rcp_f32 v111, v111
  v_pk_fma_f32 v[104:105], v[104:105], v[22:23], v[14:15] op_sel:[0,0,0] op_sel_hi:[1,0,0]
  v_pk_fma_f32 v[106:107], v[106:107], v[22:23], v[14:15] op_sel:[0,0,0] op_sel_hi:[1,0,0]
  s_add_u32 m0, s61, 0x2000
  s_add_u32 s62, s0, 0xb000
  buffer_load_dwordx4 v1, s[44:47], s62 offen sc1 lds
  v_pk_fma_f32 v[108:109], v[108:109], v[22:23], v[14:15] op_sel:[0,0,0] op_sel_hi:[1,0,0]
  v_pk_fma_f32 v[110:111], v[110:111], v[22:23], v[14:15] op_sel:[0,0,0] op_sel_hi:[1,0,0]
  v_pk_mul_f32 v[104:105], v[104:105], v[64:65] op_sel:[0,0] op_sel_hi:[1,1]
  v_pk_mul_f32 v[106:107], v[106:107], v[66:67] op_sel:[0,0] op_sel_hi:[1,1]
  s_add_u32 m0, s61, 0x2400
  s_add_u32 s62, s0, 0x2f000
  buffer_load_dwordx4 v1, s[44:47], s62 offen sc1 lds
  v_pk_mul_f32 v[108:109], v[108:109], v[68:69] op_sel:[0,0] op_sel_hi:[1,1]
  v_pk_mul_f32 v[110:111], v[110:111], v[70:71] op_sel:[0,0] op_sel_hi:[1,1]
  v_cvt_pk_bf16_f32 v64, v104, v105
  v_cvt_pk_bf16_f32 v65, v106, v107
  v_cvt_pk_bf16_f32 v66, v108, v109
  v_cvt_pk_bf16_f32 v67, v110, v111
  buffer_store_dwordx4 v[64:67], v1, s[44:47], s2 offen offset:0 sc1
  v_pk_mul_f32 v[104:105], v[72:73], v[14:15] op_sel:[0,1] op_sel_hi:[1,1]
  v_pk_mul_f32 v[106:107], v[74:75], v[14:15] op_sel:[0,1] op_sel_hi:[1,1]
  v_pk_mul_f32 v[108:109], v[76:77], v[14:15] op_sel:[0,1] op_sel_hi:[1,1]
  v_pk_mul_f32 v[110:111], v[78:79], v[14:15] op_sel:[0,1] op_sel_hi:[1,1]
  v_exp_f32 v104, v104
  s_waitcnt vmcnt(13)
  s_barrier
  v_exp_f32 v105, v105
  v_exp_f32 v106, v106
  v_exp_f32 v107, v107
  v_exp_f32 v108, v108
  v_exp_f32 v109, v109
  v_exp_f32 v110, v110
  v_exp_f32 v111, v111
  v_pk_add_f32 v[104:105], v[104:105], 1.0 op_sel:[0,0] op_sel_hi:[1,0]
  v_pk_add_f32 v[106:107], v[106:107], 1.0 op_sel:[0,0] op_sel_hi:[1,0]
  v_pk_add_f32 v[108:109], v[108:109], 1.0 op_sel:[0,0] op_sel_hi:[1,0]
  v_pk_add_f32 v[110:111], v[110:111], 1.0 op_sel:[0,0] op_sel_hi:[1,0]
  v_pk_fma_f32 v[104:105], v[104:105], v[104:105], 1.0 op_sel:[0,0,0] op_sel_hi:[1,1,0]
  v_pk_fma_f32 v[106:107], v[106:107], v[106:107], 1.0 op_sel:[0,0,0] op_sel_hi:[1,1,0]
  v_pk_fma_f32 v[108:109], v[108:109], v[108:109], 1.0 op_sel:[0,0,0] op_sel_hi:[1,1,0]
  v_pk_fma_f32 v[110:111], v[110:111], v[110:111], 1.0 op_sel:[0,0,0] op_sel_hi:[1,1,0]
  v_rcp_f32 v104, v104
  v_rcp_f32 v105, v105
  v_rcp_f32 v106, v106
  v_rcp_f32 v107, v107
  v_rcp_f32 v108, v108
  v_rcp_f32 v109, v109
  v_rcp_f32 v110, v110
  v_rcp_f32 v111, v111
  v_pk_fma_f32 v[104:105], v[104:105], v[22:23], v[14:15] op_sel:[0,0,0] op_sel_hi:[1,0,0]
  v_pk_fma_f32 v[106:107], v[106:107], v[22:23], v[14:15] op_sel:[0,0,0] op_sel_hi:[1,0,0]
  v_pk_fma_f32 v[108:109], v[108:109], v[22:23], v[14:15] op_sel:[0,0,0] op_sel_hi:[1,0,0]
  v_pk_fma_f32 v[110:111], v[110:111], v[22:23], v[14:15] op_sel:[0,0,0] op_sel_hi:[1,0,0]
  v_pk_mul_f32 v[104:105], v[104:105], v[72:73] op_sel:[0,0] op_sel_hi:[1,1]
  v_pk_mul_f32 v[106:107], v[106:107], v[74:75] op_sel:[0,0] op_sel_hi:[1,1]
  v_pk_mul_f32 v[108:109], v[108:109], v[76:77] op_sel:[0,0] op_sel_hi:[1,1]
  v_pk_mul_f32 v[110:111], v[110:111], v[78:79] op_sel:[0,0] op_sel_hi:[1,1]
  v_cvt_pk_bf16_f32 v72, v104, v105
  v_cvt_pk_bf16_f32 v73, v106, v107
  v_cvt_pk_bf16_f32 v74, v108, v109
  v_cvt_pk_bf16_f32 v75, v110, v111
  buffer_store_dwordx4 v[72:75], v1, s[44:47], s2 offen offset:1024 sc1
  s_waitcnt vmcnt(10)
  s_barrier
  v_cmp_ne_u32 vcc, 0, v204
  s_nop 0
  s_andn2_b32 s3, 0xffffffff, vcc_lo
  s_cbranch_scc1 L49
L50:
  s_add_u32 m0, s61, 0x14000
  s_add_u32 s62, s0, 0x2000
  buffer_load_dwordx4 v1, s[44:47], s62 offen sc1 lds
  s_add_u32 m0, s61, 0x14400
  s_add_u32 s62, s0, 0x26000
  buffer_load_dwordx4 v1, s[44:47], s62 offen sc1 lds
  s_add_u32 m0, s61, 0x12000
  s_add_u32 s62, s0, 0xffffb000
  buffer_load_dwordx4 v1, s[44:47], s62 offen sc1 lds
  s_add_u32 m0, s61, 0x12400
  s_add_u32 s62, s0, 0x1f000
  buffer_load_dwordx4 v1, s[44:47], s62 offen sc1 lds
  s_waitcnt vmcnt(4)
  buffer_store_dword v10, v28, s[44:47], s65 offen offset:256 sc1
  s_barrier
  s_add_u32 m0, s61, 0x20000
  s_add_u32 s62, s0, 0x10000
  buffer_load_dwordx4 v1, s[44:47], s62 offen sc1 lds
  s_add_u32 m0, s61, 0x20400
  s_add_u32 s62, s0, 0x34000
  buffer_load_dwordx4 v1, s[44:47], s62 offen sc1 lds
  s_add_u32 m0, s61, 0x1e000
  s_add_u32 s62, s0, 0x9000
  buffer_load_dwordx4 v1, s[44:47], s62 offen sc1 lds
  s_add_u32 m0, s61, 0x1e400
  s_add_u32 s62, s0, 0x2d000
  buffer_load_dwordx4 v1, s[44:47], s62 offen sc1 lds
  s_add_u32 m0, s61, 0x0
  s_add_u32 s62, s0, 0x5000
  buffer_load_dwordx4 v1, s[44:47], s62 offen sc1 lds
  s_add_u32 m0, s61, 0x400
  s_add_u32 s62, s0, 0x29000
  buffer_load_dwordx4 v1, s[44:47], s62 offen sc1 lds
  s_add_u32 m0, s61, 0xffffe000
  s_add_u32 s62, s0, 0xffffe000
  buffer_load_dwordx4 v1, s[44:47], s62 offen sc1 lds
  s_add_u32 m0, s61, 0xffffe400
  s_add_u32 s62, s0, 0x22000
  buffer_load_dwordx4 v1, s[44:47], s62 offen sc1 lds
  s_barrier
  buffer_load_dword v208, v5, s[44:47], s67 offen offset:384 sc1
  s_add_u32 m0, s61, 0x10000
  s_add_u32 s62, s68, 0x30000
  buffer_load_dwordx4 v4, s[20:23], s62 offen lds
  s_add_u32 m0, s61, 0x10400
  s_add_u32 s62, s68, 0x32000
  buffer_load_dwordx4 v4, s[20:23], s62 offen lds
  s_add_u32 m0, s61, 0xe000
  s_add_u32 s62, s68, 0xfffc0000
  buffer_load_dwordx4 v4, s[20:23], s62 offen lds
  s_add_u32 m0, s61, 0xe400
  s_add_u32 s62, s68, 0xfffc2000
  buffer_load_dwordx4 v4, s[20:23], s62 offen lds
  s_add_u32 m0, s61, 0x1c000
  s_add_u32 s62, s0, 0x13000
  buffer_load_dwordx4 v1, s[44:47], s62 offen sc1 lds
  s_add_u32 m0, s61, 0x1c400
  s_add_u32 s62, s0, 0x37000
  buffer_load_dwordx4 v1, s[44:47], s62 offen sc1 lds
  s_add_u32 m0, s61, 0x1a000
  s_add_u32 s62, s0, 0xc000
  buffer_load_dwordx4 v1, s[44:47], s62 offen sc1 lds
  s_add_u32 m0, s61, 0x1a400
  s_add_u32 s62, s0, 0x30000
  buffer_load_dwordx4 v1, s[44:47], s62 offen sc1 lds
  s_waitcnt vmcnt(18)
  s_barrier
  s_add_u32 m0, s61, 0x4000
  s_add_u32 s62, s68, 0x110000
  buffer_load_dwordx4 v4, s[20:23], s62 offen lds
  s_add_u32 m0, s61, 0x4400
  s_add_u32 s62, s68, 0x112000
  buffer_load_dwordx4 v4, s[20:23], s62 offen lds
  s_add_u32 m0, s61, 0x2000
  s_add_u32 s62, s68, 0xa0000
  buffer_load_dwordx4 v4, s[20:23], s62 offen lds
  s_add_u32 m0, s61, 0x2400
  s_add_u32 s62, s68, 0xa2000
  buffer_load_dwordx4 v4, s[20:23], s62 offen lds
  s_waitcnt vmcnt(12)
  v_cmp_ne_u32 vcc, 0, v208
  s_nop 0
  s_andn2_b32 s3, 0x55555555, vcc_lo
  s_cbranch_scc1 L52
L53:
  s_add_u32 m0, s61, 0x8000
  s_add_u32 s62, s0, 0x3000
  buffer_load_dwordx4 v1, s[44:47], s62 offen sc1 lds
  s_add_u32 m0, s61, 0x8400
  s_add_u32 s62, s0, 0x27000
  buffer_load_dwordx4 v1, s[44:47], s62 offen sc1 lds
  s_add_u32 m0, s61, 0x6000
  s_add_u32 s62, s0, 0xffffc000
  buffer_load_dwordx4 v1, s[44:47], s62 offen sc1 lds
  s_add_u32 m0, s61, 0x6400
  s_add_u32 s62, s0, 0x20000
  buffer_load_dwordx4 v1, s[44:47], s62 offen sc1 lds
  s_barrier
  s_add_u32 m0, s61, 0x24000
  s_add_u32 s62, s68, 0x0
  buffer_load_dwordx4 v4, s[20:23], s62 offen lds
  s_add_u32 m0, s61, 0x24400
  s_add_u32 s62, s68, 0x2000
  buffer_load_dwordx4 v4, s[20:23], s62 offen lds
  s_add_u32 m0, s61, 0x22000
  s_add_u32 s62, s68, 0xfff90000
  buffer_load_dwordx4 v4, s[20:23], s62 offen lds
  s_add_u32 m0, s61, 0x22400
  s_add_u32 s62, s68, 0xfff92000
  buffer_load_dwordx4 v4, s[20:23], s62 offen lds
  s_add_u32 m0, s61, 0x14000
  s_add_u32 s62, s0, 0x11000
  buffer_load_dwordx4 v1, s[44:47], s62 offen sc1 lds
  s_add_u32 m0, s61, 0x14400
  s_add_u32 s62, s0, 0x35000
  buffer_load_dwordx4 v1, s[44:47], s62 offen sc1 lds
  s_add_u32 m0, s61, 0x12000
  s_add_u32 s62, s0, 0xa000
  buffer_load_dwordx4 v1, s[44:47], s62 offen sc1 lds
  buffer_load_dword v210, v5, s[44:47], s67 offen offset:256 sc1
  s_waitcnt vmcnt(20)
  s_barrier
  s_add_u32 m0, s61, 0x12400
  s_add_u32 s62, s0, 0x2e000
  buffer_load_dwordx4 v1, s[44:47], s62 offen sc1 lds
  s_add_u32 m0, s61, 0xc000
  s_add_u32 s62, s68, 0xe0000
  buffer_load_dwordx4 v4, s[20:23], s62 offen lds
  s_add_u32 m0, s61, 0xc400
  s_add_u32 s62, s68, 0xe2000
  buffer_load_dwordx4 v4, s[20:23], s62 offen lds
  s_add_u32 m0, s61, 0xa000
  s_add_u32 s62, s68, 0x70000
  buffer_load_dwordx4 v4, s[20:23], s62 offen lds
  s_add_u32 m0, s61, 0xa400
  s_add_u32 s62, s68, 0x72000
  buffer_load_dwordx4 v4, s[20:23], s62 offen lds
  s_waitcnt vmcnt(5)
  v_cmp_ne_u32 vcc, 0, v210
  s_nop 0
  s_andn2_b32 s3, 0xffffffff, vcc_lo
  s_cbranch_scc1 L55
L56:
  s_add_u32 m0, s61, 0x20000
  s_add_u32 s62, s0, 0x0
  buffer_load_dwordx4 v1, s[44:47], s62 offen sc1 lds
  s_add_u32 m0, s61, 0x20400
  s_add_u32 s62, s0, 0x24000
  buffer_load_dwordx4 v1, s[44:47], s62 offen sc1 lds
  s_barrier
  s_add_u32 m0, s61, 0x1e000
  s_add_u32 s62, s0, 0xffff9000
  buffer_load_dwordx4 v1, s[44:47], s62 offen sc1 lds
  s_add_u32 m0, s61, 0x1e400
  s_add_u32 s62, s0, 0x1d000
  buffer_load_dwordx4 v1, s[44:47], s62 offen sc1 lds
  s_add_u32 m0, s61, 0x18000
  s_add_u32 s62, s68, 0x60000
  buffer_load_dwordx4 v4, s[20:23], s62 offen lds
  s_add_u32 m0, s61, 0x18400
  s_add_u32 s62, s68, 0x62000
  buffer_load_dwordx4 v4, s[20:23], s62 offen lds
  s_add_u32 m0, s61, 0x16000
  s_add_u32 s62, s68, 0xffff0000
  buffer_load_dwordx4 v4, s[20:23], s62 offen lds
  s_add_u32 m0, s61, 0x16400
  s_add_u32 s62, s68, 0xffff2000
  buffer_load_dwordx4 v4, s[20:23], s62 offen lds
  s_add_u32 m0, s61, 0x0
  s_add_u32 s62, s0, 0xe000
  buffer_load_dwordx4 v1, s[44:47], s62 offen sc1 lds
  s_barrier
  s_add_u32 m0, s61, 0x400
  s_add_u32 s62, s0, 0x32000
  buffer_load_dwordx4 v1, s[44:47], s62 offen sc1 lds
  s_add_u32 m0, s61, 0xffffe000
  s_add_u32 s62, s0, 0x7000
  buffer_load_dwordx4 v1, s[44:47], s62 offen sc1 lds
  s_add_u32 m0, s61, 0xffffe400
  s_add_u32 s62, s0, 0x2b000
  buffer_load_dwordx4 v1, s[44:47], s62 offen sc1 lds
  s_add_u32 m0, s61, 0x10000
  s_add_u32 s62, s68, 0x140000
  buffer_load_dwordx4 v4, s[20:23], s62 offen lds
  s_add_u32 m0, s61, 0x10400
  s_add_u32 s62, s68, 0x142000
  buffer_load_dwordx4 v4, s[20:23], s62 offen lds
  s_add_u32 m0, s61, 0xe000
  s_add_u32 s62, s68, 0xd0000
  buffer_load_dwordx4 v4, s[20:23], s62 offen lds
  s_add_u32 m0, s61, 0xe400
  s_add_u32 s62, s68, 0xd2000
  buffer_load_dwordx4 v4, s[20:23], s62 offen lds
  s_waitcnt vmcnt(20)
  s_waitcnt vmcnt(16)
  s_barrier
  s_add_u32 m0, s61, 0x1c000
  s_add_u32 s62, s0, 0x6000
  buffer_load_dwordx4 v1, s[44:47], s62 offen sc1 lds
  s_add_u32 m0, s61, 0x1c400
  s_add_u32 s62, s0, 0x2a000
  buffer_load_dwordx4 v1, s[44:47], s62 offen sc1 lds
  s_add_u32 m0, s61, 0x1a000
  s_add_u32 s62, s0, 0xfffff000
  buffer_load_dwordx4 v1, s[44:47], s62 offen sc1 lds
  s_add_u32 m0, s61, 0x1a400
  s_add_u32 s62, s0, 0x23000
  buffer_load_dwordx4 v1, s[44:47], s62 offen sc1 lds
  s_add_u32 m0, s61, 0x4000
  s_add_u32 s62, s69, 0x0
  buffer_load_dwordx4 v4, s[24:27], s62 offen lds
  s_add_u32 m0, s61, 0x4400
  s_add_u32 s62, s69, 0x2000
  buffer_load_dwordx4 v4, s[24:27], s62 offen lds
  s_add_u32 m0, s61, 0x2000
  s_add_u32 s62, s69, 0xfffe0000
  buffer_load_dwordx4 v4, s[24:27], s62 offen lds
  s_waitcnt vmcnt(19)
  s_waitcnt vmcnt(15)
  s_barrier
  buffer_load_dword v214, v5, s[44:47], s67 offen offset:512 sc1
  s_add_u32 m0, s61, 0x2400
  s_add_u32 s62, s69, 0xfffe2000
  buffer_load_dwordx4 v4, s[24:27], s62 offen lds
  s_add_u32 m0, s61, 0x8000
  s_add_u32 s62, s0, 0x14000
  buffer_load_dwordx4 v1, s[44:47], s62 offen sc1 lds
  s_add_u32 m0, s61, 0x8400
  s_add_u32 s62, s0, 0x38000
  buffer_load_dwordx4 v1, s[44:47], s62 offen sc1 lds
  s_add_u32 m0, s61, 0x6000
  s_add_u32 s62, s0, 0xd000
  buffer_load_dwordx4 v1, s[44:47], s62 offen sc1 lds
  s_add_u32 m0, s61, 0x6400
  s_add_u32 s62, s0, 0x31000
  buffer_load_dwordx4 v1, s[44:47], s62 offen sc1 lds
  s_add_u32 m0, s61, 0x24000
  s_add_u32 s62, s69, 0x40000
  buffer_load_dwordx4 v4, s[24:27], s62 offen lds
  s_add_u32 m0, s61, 0x24400
  s_add_u32 s62, s69, 0x42000
  buffer_load_dwordx4 v4, s[24:27], s62 offen lds
  s_waitcnt vmcnt(19)
  s_waitcnt vmcnt(15)
  s_barrier
  s_add_u32 m0, s61, 0x22000
  s_add_u32 s62, s69, 0x20000
  buffer_load_dwordx4 v4, s[24:27], s62 offen lds
  s_add_u32 m0, s61, 0x22400
  s_add_u32 s62, s69, 0x22000
  buffer_load_dwordx4 v4, s[24:27], s62 offen lds
  s_waitcnt vmcnt(9)
  v_cmp_ne_u32 vcc, 0, v214
  s_nop 0
  s_andn2_b32 s3, 0xffffffff, vcc_lo
  s_cbranch_scc1 L58
L59:
  s_add_u32 m0, s61, 0x14000
  s_add_u32 s62, s1, 0x0
  buffer_load_dwordx4 v1, s[44:47], s62 offen sc1 lds
  s_add_u32 m0, s61, 0x14400
  s_add_u32 s62, s1, 0x24000
  buffer_load_dwordx4 v1, s[44:47], s62 offen sc1 lds
  s_add_u32 m0, s61, 0x12000
  s_add_u32 s62, s1, 0xffffe000
  buffer_load_dwordx4 v1, s[44:47], s62 offen sc1 lds
  s_add_u32 m0, s61, 0x12400
  s_add_u32 s62, s1, 0x22000
  buffer_load_dwordx4 v1, s[44:47], s62 offen sc1 lds
  s_add_u32 m0, s61, 0xc000
  s_add_u32 s62, s69, 0x10000
  buffer_load_dwordx4 v4, s[24:27], s62 offen lds
  s_waitcnt vmcnt(13)
  s_barrier
  s_add_u32 m0, s61, 0xc400
  s_add_u32 s62, s69, 0x12000
  buffer_load_dwordx4 v4, s[24:27], s62 offen lds
  s_add_u32 m0, s61, 0xa000
  s_add_u32 s62, s69, 0xffff0000
  buffer_load_dwordx4 v4, s[24:27], s62 offen lds
  s_add_u32 m0, s61, 0xa400
  s_add_u32 s62, s69, 0xffff2000
  buffer_load_dwordx4 v4, s[24:27], s62 offen lds
  s_add_u32 m0, s61, 0x20000
  s_add_u32 s62, s1, 0x4000
  buffer_load_dwordx4 v1, s[44:47], s62 offen sc1 lds
  s_add_u32 m0, s61, 0x20400
  s_add_u32 s62, s1, 0x28000
  buffer_load_dwordx4 v1, s[44:47], s62 offen sc1 lds
  s_add_u32 m0, s61, 0x1e000
  s_add_u32 s62, s1, 0x2000
  buffer_load_dwordx4 v1, s[44:47], s62 offen sc1 lds
  s_add_u32 m0, s61, 0x1e400
  s_add_u32 s62, s1, 0x26000
  buffer_load_dwordx4 v1, s[44:47], s62 offen sc1 lds
  s_waitcnt vmcnt(16)
  s_waitcnt vmcnt(12)
  s_barrier
  s_add_u32 m0, s61, 0x18000
  s_add_u32 s62, s69, 0x50000
  buffer_load_dwordx4 v4, s[24:27], s62 offen lds
  s_add_u32 m0, s61, 0x18400
  s_add_u32 s62, s69, 0x52000
  buffer_load_dwordx4 v4, s[24:27], s62 offen lds
  s_add_u32 m0, s61, 0x16000
  s_add_u32 s62, s69, 0x30000
  buffer_load_dwordx4 v4, s[24:27], s62 offen lds
  s_add_u32 m0, s61, 0x16400
  s_add_u32 s62, s69, 0x32000
  buffer_load_dwordx4 v4, s[24:27], s62 offen lds
  s_add_u32 m0, s61, 0x0
  s_add_u32 s62, s91, 0x0
  buffer_load_dwordx4 v4, s[8:11], s62 offen lds
  s_add_u32 m0, s61, 0x400
  s_add_u32 s62, s91, 0x2000
  buffer_load_dwordx4 v4, s[8:11], s62 offen lds
  s_add_u32 m0, s61, 0x10000
  s_add_u32 s62, s1, 0x1000
  buffer_load_dwordx4 v1, s[44:47], s62 offen sc1 lds
  s_waitcnt vmcnt(15)
  s_waitcnt vmcnt(11)
  s_barrier
  s_add_u32 m0, s61, 0x10400
  s_add_u32 s62, s1, 0x25000
  buffer_load_dwordx4 v1, s[44:47], s62 offen sc1 lds
  s_add_u32 m0, s61, 0xe000
  s_add_u32 s62, s1, 0xfffff000
  buffer_load_dwordx4 v1, s[44:47], s62 offen sc1 lds
  s_add_u32 m0, s61, 0xe400
  s_add_u32 s62, s1, 0x23000
  buffer_load_dwordx4 v1, s[44:47], s62 offen sc1 lds
  s_add_u32 m0, s61, 0x1c000
  s_add_u32 s62, s1, 0x5000
  buffer_load_dwordx4 v1, s[44:47], s62 offen sc1 lds
  s_add_u32 m0, s61, 0x1c400
  s_add_u32 s62, s1, 0x29000
  buffer_load_dwordx4 v1, s[44:47], s62 offen sc1 lds
  s_add_u32 m0, s61, 0x1a000
  s_add_u32 s62, s1, 0x3000
  buffer_load_dwordx4 v1, s[44:47], s62 offen sc1 lds
  s_add_u32 m0, s61, 0x1a400
  s_add_u32 s62, s1, 0x27000
  buffer_load_dwordx4 v1, s[44:47], s62 offen sc1 lds
  s_waitcnt vmcnt(14)
  s_waitcnt vmcnt(10)
  s_barrier
  s_waitcnt vmcnt(4)
  s_barrier
  s_waitcnt vmcnt(0)
  s_barrier
  s_endpgm
L9:
  s_mov_b32 s73, 0x100000
L11:
  s_sleep 4
  buffer_load_dword v27, v30, s[40:43], 0 offen offset:128 sc1
  s_waitcnt vmcnt(0)
  v_cmp_ne_u32 vcc, 0, v27
  s_nop 1
  s_andn2_b32 s3, 0xffffffff, vcc_lo
  s_cbranch_scc0 L10
  s_sub_u32 s73, s73, 1
  s_cmp_lg_u32 s73, 0
  s_cbranch_scc1 L11
  s_branch L10
L12:
  s_mov_b32 s73, 0x100000
L14:
  s_sleep 4
  buffer_load_dword v9, v21, s[44:47], s71 offen offset:0 sc1
  s_waitcnt vmcnt(0)
  v_cmp_ne_u32 vcc, 0, v9
  s_nop 1
  s_andn2_b32 s3, 0xffff, vcc_lo
  s_cbranch_scc0 L13
  s_sub_u32 s73, s73, 1
  s_cmp_lg_u32 s73, 0
  s_cbranch_scc1 L14
  s_branch L13
L15:
  s_mov_b32 s73, 0x100000
L17:
  s_sleep 4
  buffer_load_dword v27, v30, s[40:43], 0 offen offset:128 sc1
  s_waitcnt vmcnt(0)
  v_cmp_ne_u32 vcc, 0, v27
  s_nop 1
  s_andn2_b32 s3, 0xffffffff, vcc_lo
  s_cbranch_scc0 L16
  s_sub_u32 s73, s73, 1
  s_cmp_lg_u32 s73, 0
  s_cbranch_scc1 L17
  s_branch L16
L18:
  s_mov_b32 s73, 0x100000
L20:
  s_sleep 4
  buffer_load_dword v27, v5, s[44:47], s67 offen offset:0 sc1
  s_waitcnt vmcnt(0)
  v_cmp_ne_u32 vcc, 0, v27
  s_nop 1
  s_andn2_b32 s3, 0xffffffff, vcc_lo
  s_cbranch_scc0 L19
  s_sub_u32 s73, s73, 1
  s_cmp_lg_u32 s73, 0
  s_cbranch_scc1 L20
  s_branch L19
L21:
  s_mov_b32 s73, 0x100000
L23:
  s_sleep 4
  buffer_load_dword v9, v21, s[44:47], s71 offen offset:0 sc1
  s_waitcnt vmcnt(0)
  v_cmp_ne_u32 vcc, 0, v9
  s_nop 1
  s_andn2_b32 s3, 0xffff, vcc_lo
  s_cbranch_scc0 L22
  s_sub_u32 s73, s73, 1
  s_cmp_lg_u32 s73, 0
  s_cbranch_scc1 L23
  s_branch L22
L24:
  s_mov_b32 s73, 0x100000
L26:
  s_sleep 4
  buffer_load_dword v204, v5, s[44:47], s67 offen offset:128 sc1
  s_waitcnt vmcnt(0)
  v_cmp_ne_u32 vcc, 0, v204
  s_nop 1
  s_andn2_b32 s3, 0xffffffff, vcc_lo
  s_cbranch_scc0 L25
  s_sub_u32 s73, s73, 1
  s_cmp_lg_u32 s73, 0
  s_cbranch_scc1 L26
  s_branch L25
L27:
  s_mov_b32 s73, 0x100000
L29:
  s_sleep 4
  buffer_load_dword v208, v5, s[44:47], s67 offen offset:384 sc1
  s_waitcnt vmcnt(0)
  v_cmp_ne_u32 vcc, 0, v208
  s_nop 1
  s_andn2_b32 s3, 0x55555555, vcc_lo
  s_cbranch_scc0 L28
  s_sub_u32 s73, s73, 1
  s_cmp_lg_u32 s73, 0
  s_cbranch_scc1 L29
  s_branch L28
L30:
  s_mov_b32 s73, 0x100000
L32:
  s_sleep 4
  buffer_load_dword v210, v5, s[44:47], s67 offen offset:256 sc1
  s_waitcnt vmcnt(0)
  v_cmp_ne_u32 vcc, 0, v210
  s_nop 1
  s_andn2_b32 s3, 0xffffffff, vcc_lo
  s_cbranch_scc0 L31
  s_sub_u32 s73, s73, 1
  s_cmp_lg_u32 s73, 0
  s_cbranch_scc1 L32
  s_branch L31
L33:
  s_mov_b32 s73, 0x100000
L35:
  s_sleep 4
  buffer_load_dword v214, v5, s[44:47], s67 offen offset:512 sc1
  s_waitcnt vmcnt(0)
  v_cmp_ne_u32 vcc, 0, v214
  s_nop 1
  s_andn2_b32 s3, 0xffffffff, vcc_lo
  s_cbranch_scc0 L34
  s_sub_u32 s73, s73, 1
  s_cmp_lg_u32 s73, 0
  s_cbranch_scc1 L35
  s_branch L34
L40:
  s_mov_b32 s73, 0x100000
L42:
  s_sleep 4
  buffer_load_dword v27, v30, s[40:43], 0 offen offset:128 sc1
  s_waitcnt vmcnt(0)
  v_cmp_ne_u32 vcc, 0, v27
  s_nop 1
  s_andn2_b32 s3, 0xffffffff, vcc_lo
  s_cbranch_scc0 L41
  s_sub_u32 s73, s73, 1
  s_cmp_lg_u32 s73, 0
  s_cbranch_scc1 L42
  s_branch L41
L43:
  s_mov_b32 s73, 0x100000
L45:
  s_sleep 4
  buffer_load_dword v27, v30, s[40:43], 0 offen offset:128 sc1
  s_waitcnt vmcnt(0)
  v_cmp_ne_u32 vcc, 0, v27
  s_nop 1
  s_andn2_b32 s3, 0xffffffff, vcc_lo
  s_cbranch_scc0 L44
  s_sub_u32 s73, s73, 1
  s_cmp_lg_u32 s73, 0
  s_cbranch_scc1 L45
  s_branch L44
L46:
  s_mov_b32 s73, 0x100000
L48:
  s_sleep 4
  buffer_load_dword v27, v5, s[44:47], s67 offen offset:0 sc1
  s_waitcnt vmcnt(0)
  v_cmp_ne_u32 vcc, 0, v27
  s_nop 1
  s_andn2_b32 s3, 0xffffffff, vcc_lo
  s_cbranch_scc0 L47
  s_sub_u32 s73, s73, 1
  s_cmp_lg_u32 s73, 0
  s_cbranch_scc1 L48
  s_branch L47
L49:
  s_mov_b32 s73, 0x100000
L51:
  s_sleep 4
  buffer_load_dword v204, v5, s[44:47], s67 offen offset:128 sc1
  s_waitcnt vmcnt(0)
  v_cmp_ne_u32 vcc, 0, v204
  s_nop 1
  s_andn2_b32 s3, 0xffffffff, vcc_lo
  s_cbranch_scc0 L50
  s_sub_u32 s73, s73, 1
  s_cmp_lg_u32 s73, 0
  s_cbranch_scc1 L51
  s_branch L50
L52:
  s_mov_b32 s73, 0x100000
L54:
  s_sleep 4
  buffer_load_dword v208, v5, s[44:47], s67 offen offset:384 sc1
  s_waitcnt vmcnt(0)
  v_cmp_ne_u32 vcc, 0, v208
  s_nop 1
  s_andn2_b32 s3, 0x55555555, vcc_lo
  s_cbranch_scc0 L53
  s_sub_u32 s73, s73, 1
  s_cmp_lg_u32 s73, 0
  s_cbranch_scc1 L54
  s_branch L53
L55:
  s_mov_b32 s73, 0x100000
L57:
  s_sleep 4
  buffer_load_dword v210, v5, s[44:47], s67 offen offset:256 sc1
  s_waitcnt vmcnt(0)
  v_cmp_ne_u32 vcc, 0, v210
  s_nop 1
  s_andn2_b32 s3, 0xffffffff, vcc_lo
  s_cbranch_scc0 L56
  s_sub_u32 s73, s73, 1
  s_cmp_lg_u32 s73, 0
  s_cbranch_scc1 L57
  s_branch L56
L58:
  s_mov_b32 s73, 0x100000
L60:
  s_sleep 4
  buffer_load_dword v214, v5, s[44:47], s67 offen offset:512 sc1
  s_waitcnt vmcnt(0)
  v_cmp_ne_u32 vcc, 0, v214
  s_nop 1
  s_andn2_b32 s3, 0xffffffff, vcc_lo
  s_cbranch_scc0 L59
  s_sub_u32 s73, s73, 1
  s_cmp_lg_u32 s73, 0
  s_cbranch_scc1 L60
  s_branch L59
L_end:
  s_endpgm
.fill 2048, 4, 0xbf810000
.section .rodata,"a"
.p2align 6
.amdhsa_kernel recurrent_scan__linear_kernel_hedgehog__dense_activation_mish__prompt_kernel
  .amdhsa_next_free_vgpr 256
  .amdhsa_next_free_sgpr 102
  .amdhsa_accum_offset 256
  .amdhsa_group_segment_fixed_size 0
  .amdhsa_kernarg_size 88
  .amdhsa_user_sgpr_count 2
  .amdhsa_user_sgpr_kernarg_segment_ptr 1
  .amdhsa_system_sgpr_workgroup_id_x 1
.end_amdhsa_kernel
```
